```python
import torch

def _softmax(x, axis=-1):
    return torch.softmax(x, dim=axis)

def _gelu(x):
    return torch.nn.functional.gelu(x, approximate='tanh')

def _silu(x):
    return torch.nn.functional.silu(x)

def _sigmoid(x):
    return torch.sigmoid(x)

def _layernorm(x, axis=-1, eps=1e-05):
    m = x.mean(dim=axis, keepdim=True)
    v = x.var(dim=axis, keepdim=True, unbiased=False)
    return (x - m) / torch.sqrt(v + eps)

def _scatter_add(tgt, idx, src, axis=0):
    return tgt.clone().index_add_(axis, idx, src)

def _segment_sum(src, seg, n):
    out = torch.zeros((n,) + src.shape[1:], dtype=src.dtype)
    return out.index_add_(0, seg, src)

def _pad(x, pw):
    flat = tuple((v for pair in reversed(pw) for v in pair))
    return torch.nn.functional.pad(x, flat)
kernel_name = 'adaLN_cond__spectral_gfnet__dense_activation_silu__prompt'

def setup_inputs():

    _w = lambda a: (lambda t: t.to(torch.bfloat16) if t.is_floating_point() else t)(torch.as_tensor(a))

    def _A_setup():
        B, S, D = (1, 2048, 576)
        Df = D // 2 + 1
        return {'x': _w((lambda *s: torch.randn(*s, dtype=torch.bfloat16) * 0.05)(B, S, D)), 'w_r': _w((lambda *s: torch.randn(*s, dtype=torch.bfloat16) * 1.6)(S, Df) * 0.02), 'w_i': _w((lambda *s: torch.randn(*s, dtype=torch.bfloat16) * 1.6)(S, Df) * 0.02)}
    _A_in = _A_setup()

    def _B_setup():
        B, S, D, F = (1, 2048, 576, 4608)
        return {'x': _w((lambda *s: torch.randn(*s, dtype=torch.bfloat16) * 0.05)(B, S, D)), 'w1': _w((lambda *s: torch.randn(*s, dtype=torch.bfloat16) * 0.8)(D, F) * D ** (-0.5)), 'w2': _w((lambda *s: torch.randn(*s, dtype=torch.bfloat16) * 0.2)(F, D) * F ** (-0.5))}
    _B_in = _B_setup()
    return {'A_x': _A_in['x'], 'A_w_r': _A_in['w_r'], 'A_w_i': _A_in['w_i'], 'B_x': _B_in['x'], 'B_w1': _B_in['w1'], 'B_w2': _B_in['w2'], 'c': _w((lambda *s: torch.randn(*s, dtype=torch.bfloat16) * 0.2)(1, 576) * 8.0), 'w_mod': _w((lambda *s: torch.randn(*s, dtype=torch.bfloat16) * 0.2)(576, 6 * 576) * 576 ** (-0.5) * 8.0)}

def reference(A_x, A_w_r, A_w_i, B_x, B_w1, B_w2, c, w_mod):

    def _A_ref(x, w_r, w_i):
        B, S, D = x.shape
        X = (lambda x, axes=(-2, -1): torch.fft.rfft2(x.float(), dim=axes))(x, axes=(-2, -1))
        W = w_r + 1j * w_i
        X = X * W
        y = (lambda x, s, axes=(-2, -1): torch.fft.irfft2(x, s=s, dim=axes).to(torch.bfloat16))(X, (S, D), axes=(-2, -1))
        return y

    def _B_ref(x, w1, w2):
        h = torch.einsum('bsd,df->bsf', x, w1)
        h = _silu(h)
        out = torch.einsum('bsf,fd->bsd', h, w2)
        return out
    x = A_x
    mod = (_silu(c) @ w_mod).reshape(c.shape[0], 6, 1, -1)
    sa, ca, ga, sb, cb, gb = (mod[:, 0].clone(), mod[:, 1].clone(), mod[:, 2].clone(), mod[:, 3].clone(), mod[:, 4].clone(), mod[:, 5].clone())
    h = _layernorm(x, axis=-1) * (1 + ca) + sa
    x = x + ga * _A_ref(h, A_w_r, A_w_i)
    h = _layernorm(x, axis=-1) * (1 + cb) + sb
    x = x + gb * _B_ref(h, B_w1, B_w2)
    return x
```

```asm
; @launch kernel=prep_kernel grid=(268,1,1) block=(256,1,1) lds=22784
; @launch kernel=ln_rfft_kernel grid=(256,1,1) block=(192,1,1) lds=57664
; @launch kernel=col_fft_kernel grid=(289,1,1) block=(256,1,1) lds=40960
; @launch kernel=irfft_ln_kernel grid=(256,1,1) block=(192,1,1) lds=57664
; @launch kernel=gemm1_kernel grid=(256,1,1) block=(512,1,1) lds=40000
; @launch kernel=gemm2_kernel grid=(256,1,1) block=(256,1,1) lds=40000
; @launch kernel=final_kernel grid=(576,1,1) block=(256,1,1) lds=0
.amdgcn_target "amdgcn-amd-amdhsa--gfx950"
.text
.globl prep_kernel
.p2align 8
.type prep_kernel,@function
prep_kernel:
    s_cmp_ge_u32 s2, 268
    s_cbranch_scc1 PREP_END
    s_cmp_ge_u32 s2, 108
    s_cbranch_scc1 PREP_TR
    s_load_dwordx2 s[4:5], s[0:1], 48
    s_load_dwordx2 s[6:7], s[0:1], 56
    s_load_dwordx2 s[8:9], s[0:1], 80
    s_waitcnt lgkmcnt(0)
    s_mov_b32 s12, s4
    s_and_b32 s13, s5, 0xffff
    s_mov_b32 s14, 1152
    s_mov_b32 s15, 0x20000
    s_mov_b32 s16, s6
    s_and_b32 s17, s7, 0xffff
    s_mov_b32 s18, 3981312
    s_mov_b32 s19, 0x20000
    s_mov_b32 s20, s8
    s_and_b32 s21, s9, 0xffff
    s_mov_b32 s22, 13824
    s_mov_b32 s23, 0x20000
    v_add_u32 v1, 0, v0
    v_lshlrev_b32 v2, 1, v1
    buffer_load_ushort v3, v2, s[12:15], 0 offen
    s_waitcnt vmcnt(0)
    v_lshlrev_b32 v3, 16, v3
    v_mul_f32 v5, 0xbfb8aa3b, v3
    v_exp_f32 v5, v5
    s_nop 0
    v_add_f32 v5, 1.0, v5
    v_rcp_f32 v5, v5
    s_nop 0
    v_mul_f32 v4, v5, v3
    v_cvt_pk_bf16_f32 v4, v4, v4
    v_lshlrev_b32 v4, 16, v4
    v_lshlrev_b32 v2, 2, v1
    ds_write_b32 v2, v4
    v_add_u32 v1, 256, v0
    v_lshlrev_b32 v2, 1, v1
    buffer_load_ushort v3, v2, s[12:15], 0 offen
    s_waitcnt vmcnt(0)
    v_lshlrev_b32 v3, 16, v3
    v_mul_f32 v5, 0xbfb8aa3b, v3
    v_exp_f32 v5, v5
    s_nop 0
    v_add_f32 v5, 1.0, v5
    v_rcp_f32 v5, v5
    s_nop 0
    v_mul_f32 v4, v5, v3
    v_cvt_pk_bf16_f32 v4, v4, v4
    v_lshlrev_b32 v4, 16, v4
    v_lshlrev_b32 v2, 2, v1
    ds_write_b32 v2, v4
    v_add_u32 v1, 512, v0
    v_lshlrev_b32 v2, 1, v1
    buffer_load_ushort v3, v2, s[12:15], 0 offen
    s_waitcnt vmcnt(0)
    v_lshlrev_b32 v3, 16, v3
    v_mul_f32 v5, 0xbfb8aa3b, v3
    v_exp_f32 v5, v5
    s_nop 0
    v_add_f32 v5, 1.0, v5
    v_rcp_f32 v5, v5
    s_nop 0
    v_mul_f32 v4, v5, v3
    v_cvt_pk_bf16_f32 v4, v4, v4
    v_lshlrev_b32 v4, 16, v4
    v_lshlrev_b32 v2, 2, v1
    ds_write_b32 v2, v4
    s_waitcnt lgkmcnt(0)
    s_barrier
    v_lshrrev_b32 v1, 4, v0
    v_and_b32 v2, 15, v0
    s_mov_b32 s24, 248832
    v_mul_lo_u32 v3, v1, s24
    v_lshlrev_b32 v4, 2, v2
    s_lshl_b32 s25, s2, 6
    v_add3_u32 v3, v3, v4, s25
    s_mov_b32 s26, 0
    buffer_load_dword v16, v3, s[16:19], s26 offen
    s_mov_b32 s26, 6912
    buffer_load_dword v17, v3, s[16:19], s26 offen
    s_mov_b32 s26, 13824
    buffer_load_dword v18, v3, s[16:19], s26 offen
    s_mov_b32 s26, 20736
    buffer_load_dword v19, v3, s[16:19], s26 offen
    s_mov_b32 s26, 27648
    buffer_load_dword v20, v3, s[16:19], s26 offen
    s_mov_b32 s26, 34560
    buffer_load_dword v21, v3, s[16:19], s26 offen
    s_mov_b32 s26, 41472
    buffer_load_dword v22, v3, s[16:19], s26 offen
    s_mov_b32 s26, 48384
    buffer_load_dword v23, v3, s[16:19], s26 offen
    s_mov_b32 s26, 55296
    buffer_load_dword v24, v3, s[16:19], s26 offen
    s_mov_b32 s26, 62208
    buffer_load_dword v25, v3, s[16:19], s26 offen
    s_mov_b32 s26, 69120
    buffer_load_dword v26, v3, s[16:19], s26 offen
    s_mov_b32 s26, 76032
    buffer_load_dword v27, v3, s[16:19], s26 offen
    s_mov_b32 s26, 82944
    buffer_load_dword v28, v3, s[16:19], s26 offen
    s_mov_b32 s26, 89856
    buffer_load_dword v29, v3, s[16:19], s26 offen
    s_mov_b32 s26, 96768
    buffer_load_dword v30, v3, s[16:19], s26 offen
    s_mov_b32 s26, 103680
    buffer_load_dword v31, v3, s[16:19], s26 offen
    s_mov_b32 s26, 110592
    buffer_load_dword v32, v3, s[16:19], s26 offen
    s_mov_b32 s26, 117504
    buffer_load_dword v33, v3, s[16:19], s26 offen
    s_mov_b32 s26, 124416
    buffer_load_dword v34, v3, s[16:19], s26 offen
    s_mov_b32 s26, 131328
    buffer_load_dword v35, v3, s[16:19], s26 offen
    s_mov_b32 s26, 138240
    buffer_load_dword v36, v3, s[16:19], s26 offen
    s_mov_b32 s26, 145152
    buffer_load_dword v37, v3, s[16:19], s26 offen
    s_mov_b32 s26, 152064
    buffer_load_dword v38, v3, s[16:19], s26 offen
    s_mov_b32 s26, 158976
    buffer_load_dword v39, v3, s[16:19], s26 offen
    s_mov_b32 s26, 165888
    buffer_load_dword v40, v3, s[16:19], s26 offen
    s_mov_b32 s26, 172800
    buffer_load_dword v41, v3, s[16:19], s26 offen
    s_mov_b32 s26, 179712
    buffer_load_dword v42, v3, s[16:19], s26 offen
    s_mov_b32 s26, 186624
    buffer_load_dword v43, v3, s[16:19], s26 offen
    s_mov_b32 s26, 193536
    buffer_load_dword v44, v3, s[16:19], s26 offen
    s_mov_b32 s26, 200448
    buffer_load_dword v45, v3, s[16:19], s26 offen
    s_mov_b32 s26, 207360
    buffer_load_dword v46, v3, s[16:19], s26 offen
    s_mov_b32 s26, 214272
    buffer_load_dword v47, v3, s[16:19], s26 offen
    s_mov_b32 s26, 221184
    buffer_load_dword v48, v3, s[16:19], s26 offen
    s_mov_b32 s26, 228096
    buffer_load_dword v49, v3, s[16:19], s26 offen
    s_mov_b32 s26, 235008
    buffer_load_dword v50, v3, s[16:19], s26 offen
    s_mov_b32 s26, 241920
    buffer_load_dword v51, v3, s[16:19], s26 offen
    v_mul_u32_u24 v5, 144, v1
    ds_read_b128 v[52:55], v5 offset:0
    ds_read_b128 v[56:59], v5 offset:16
    ds_read_b128 v[60:63], v5 offset:32
    ds_read_b128 v[64:67], v5 offset:48
    ds_read_b128 v[68:71], v5 offset:64
    ds_read_b128 v[72:75], v5 offset:80
    ds_read_b128 v[76:79], v5 offset:96
    ds_read_b128 v[80:83], v5 offset:112
    ds_read_b128 v[84:87], v5 offset:128
    v_mov_b32 v6, 0
    v_mov_b32 v7, 0
    s_waitcnt lgkmcnt(0)
    s_waitcnt vmcnt(35)
    v_lshlrev_b32 v8, 16, v16
    v_and_b32 v9, 0xffff0000, v16
    v_fmac_f32 v6, v52, v8
    v_fmac_f32 v7, v52, v9
    s_waitcnt vmcnt(34)
    v_lshlrev_b32 v8, 16, v17
    v_and_b32 v9, 0xffff0000, v17
    v_fmac_f32 v6, v53, v8
    v_fmac_f32 v7, v53, v9
    s_waitcnt vmcnt(33)
    v_lshlrev_b32 v8, 16, v18
    v_and_b32 v9, 0xffff0000, v18
    v_fmac_f32 v6, v54, v8
    v_fmac_f32 v7, v54, v9
    s_waitcnt vmcnt(32)
    v_lshlrev_b32 v8, 16, v19
    v_and_b32 v9, 0xffff0000, v19
    v_fmac_f32 v6, v55, v8
    v_fmac_f32 v7, v55, v9
    s_waitcnt vmcnt(31)
    v_lshlrev_b32 v8, 16, v20
    v_and_b32 v9, 0xffff0000, v20
    v_fmac_f32 v6, v56, v8
    v_fmac_f32 v7, v56, v9
    s_waitcnt vmcnt(30)
    v_lshlrev_b32 v8, 16, v21
    v_and_b32 v9, 0xffff0000, v21
    v_fmac_f32 v6, v57, v8
    v_fmac_f32 v7, v57, v9
    s_waitcnt vmcnt(29)
    v_lshlrev_b32 v8, 16, v22
    v_and_b32 v9, 0xffff0000, v22
    v_fmac_f32 v6, v58, v8
    v_fmac_f32 v7, v58, v9
    s_waitcnt vmcnt(28)
    v_lshlrev_b32 v8, 16, v23
    v_and_b32 v9, 0xffff0000, v23
    v_fmac_f32 v6, v59, v8
    v_fmac_f32 v7, v59, v9
    s_waitcnt vmcnt(27)
    v_lshlrev_b32 v8, 16, v24
    v_and_b32 v9, 0xffff0000, v24
    v_fmac_f32 v6, v60, v8
    v_fmac_f32 v7, v60, v9
    s_waitcnt vmcnt(26)
    v_lshlrev_b32 v8, 16, v25
    v_and_b32 v9, 0xffff0000, v25
    v_fmac_f32 v6, v61, v8
    v_fmac_f32 v7, v61, v9
    s_waitcnt vmcnt(25)
    v_lshlrev_b32 v8, 16, v26
    v_and_b32 v9, 0xffff0000, v26
    v_fmac_f32 v6, v62, v8
    v_fmac_f32 v7, v62, v9
    s_waitcnt vmcnt(24)
    v_lshlrev_b32 v8, 16, v27
    v_and_b32 v9, 0xffff0000, v27
    v_fmac_f32 v6, v63, v8
    v_fmac_f32 v7, v63, v9
    s_waitcnt vmcnt(23)
    v_lshlrev_b32 v8, 16, v28
    v_and_b32 v9, 0xffff0000, v28
    v_fmac_f32 v6, v64, v8
    v_fmac_f32 v7, v64, v9
    s_waitcnt vmcnt(22)
    v_lshlrev_b32 v8, 16, v29
    v_and_b32 v9, 0xffff0000, v29
    v_fmac_f32 v6, v65, v8
    v_fmac_f32 v7, v65, v9
    s_waitcnt vmcnt(21)
    v_lshlrev_b32 v8, 16, v30
    v_and_b32 v9, 0xffff0000, v30
    v_fmac_f32 v6, v66, v8
    v_fmac_f32 v7, v66, v9
    s_waitcnt vmcnt(20)
    v_lshlrev_b32 v8, 16, v31
    v_and_b32 v9, 0xffff0000, v31
    v_fmac_f32 v6, v67, v8
    v_fmac_f32 v7, v67, v9
    s_waitcnt vmcnt(19)
    v_lshlrev_b32 v8, 16, v32
    v_and_b32 v9, 0xffff0000, v32
    v_fmac_f32 v6, v68, v8
    v_fmac_f32 v7, v68, v9
    s_waitcnt vmcnt(18)
    v_lshlrev_b32 v8, 16, v33
    v_and_b32 v9, 0xffff0000, v33
    v_fmac_f32 v6, v69, v8
    v_fmac_f32 v7, v69, v9
    s_waitcnt vmcnt(17)
    v_lshlrev_b32 v8, 16, v34
    v_and_b32 v9, 0xffff0000, v34
    v_fmac_f32 v6, v70, v8
    v_fmac_f32 v7, v70, v9
    s_waitcnt vmcnt(16)
    v_lshlrev_b32 v8, 16, v35
    v_and_b32 v9, 0xffff0000, v35
    v_fmac_f32 v6, v71, v8
    v_fmac_f32 v7, v71, v9
    s_waitcnt vmcnt(15)
    v_lshlrev_b32 v8, 16, v36
    v_and_b32 v9, 0xffff0000, v36
    v_fmac_f32 v6, v72, v8
    v_fmac_f32 v7, v72, v9
    s_waitcnt vmcnt(14)
    v_lshlrev_b32 v8, 16, v37
    v_and_b32 v9, 0xffff0000, v37
    v_fmac_f32 v6, v73, v8
    v_fmac_f32 v7, v73, v9
    s_waitcnt vmcnt(13)
    v_lshlrev_b32 v8, 16, v38
    v_and_b32 v9, 0xffff0000, v38
    v_fmac_f32 v6, v74, v8
    v_fmac_f32 v7, v74, v9
    s_waitcnt vmcnt(12)
    v_lshlrev_b32 v8, 16, v39
    v_and_b32 v9, 0xffff0000, v39
    v_fmac_f32 v6, v75, v8
    v_fmac_f32 v7, v75, v9
    s_waitcnt vmcnt(11)
    v_lshlrev_b32 v8, 16, v40
    v_and_b32 v9, 0xffff0000, v40
    v_fmac_f32 v6, v76, v8
    v_fmac_f32 v7, v76, v9
    s_waitcnt vmcnt(10)
    v_lshlrev_b32 v8, 16, v41
    v_and_b32 v9, 0xffff0000, v41
    v_fmac_f32 v6, v77, v8
    v_fmac_f32 v7, v77, v9
    s_waitcnt vmcnt(9)
    v_lshlrev_b32 v8, 16, v42
    v_and_b32 v9, 0xffff0000, v42
    v_fmac_f32 v6, v78, v8
    v_fmac_f32 v7, v78, v9
    s_waitcnt vmcnt(8)
    v_lshlrev_b32 v8, 16, v43
    v_and_b32 v9, 0xffff0000, v43
    v_fmac_f32 v6, v79, v8
    v_fmac_f32 v7, v79, v9
    s_waitcnt vmcnt(7)
    v_lshlrev_b32 v8, 16, v44
    v_and_b32 v9, 0xffff0000, v44
    v_fmac_f32 v6, v80, v8
    v_fmac_f32 v7, v80, v9
    s_waitcnt vmcnt(6)
    v_lshlrev_b32 v8, 16, v45
    v_and_b32 v9, 0xffff0000, v45
    v_fmac_f32 v6, v81, v8
    v_fmac_f32 v7, v81, v9
    s_waitcnt vmcnt(5)
    v_lshlrev_b32 v8, 16, v46
    v_and_b32 v9, 0xffff0000, v46
    v_fmac_f32 v6, v82, v8
    v_fmac_f32 v7, v82, v9
    s_waitcnt vmcnt(4)
    v_lshlrev_b32 v8, 16, v47
    v_and_b32 v9, 0xffff0000, v47
    v_fmac_f32 v6, v83, v8
    v_fmac_f32 v7, v83, v9
    s_waitcnt vmcnt(3)
    v_lshlrev_b32 v8, 16, v48
    v_and_b32 v9, 0xffff0000, v48
    v_fmac_f32 v6, v84, v8
    v_fmac_f32 v7, v84, v9
    s_waitcnt vmcnt(2)
    v_lshlrev_b32 v8, 16, v49
    v_and_b32 v9, 0xffff0000, v49
    v_fmac_f32 v6, v85, v8
    v_fmac_f32 v7, v85, v9
    s_waitcnt vmcnt(1)
    v_lshlrev_b32 v8, 16, v50
    v_and_b32 v9, 0xffff0000, v50
    v_fmac_f32 v6, v86, v8
    v_fmac_f32 v7, v86, v9
    s_waitcnt vmcnt(0)
    v_lshlrev_b32 v8, 16, v51
    v_and_b32 v9, 0xffff0000, v51
    v_fmac_f32 v6, v87, v8
    v_fmac_f32 v7, v87, v9
    s_barrier
    v_lshlrev_b32 v10, 7, v1
    v_lshlrev_b32 v11, 3, v2
    v_add_u32 v10, v10, v11
    ds_write_b64 v10, v[6:7] offset:4096
    s_waitcnt lgkmcnt(0)
    s_barrier
    v_readfirstlane_b32 s27, v0
    s_nop 0
    s_cmp_lg_u32 s27, 0
    s_cbranch_scc1 PREP_END
    v_and_b32 v12, 31, v0
    v_lshlrev_b32 v12, 2, v12
    ds_read_b32 v16, v12 offset:4096
    ds_read_b32 v17, v12 offset:4224
    ds_read_b32 v18, v12 offset:4352
    ds_read_b32 v19, v12 offset:4480
    ds_read_b32 v20, v12 offset:4608
    ds_read_b32 v21, v12 offset:4736
    ds_read_b32 v22, v12 offset:4864
    ds_read_b32 v23, v12 offset:4992
    ds_read_b32 v24, v12 offset:5120
    ds_read_b32 v25, v12 offset:5248
    ds_read_b32 v26, v12 offset:5376
    ds_read_b32 v27, v12 offset:5504
    ds_read_b32 v28, v12 offset:5632
    ds_read_b32 v29, v12 offset:5760
    ds_read_b32 v30, v12 offset:5888
    ds_read_b32 v31, v12 offset:6016
    s_waitcnt lgkmcnt(0)
    v_mov_b32 v13, v16
    v_add_f32 v13, v13, v17
    v_add_f32 v13, v13, v18
    v_add_f32 v13, v13, v19
    v_add_f32 v13, v13, v20
    v_add_f32 v13, v13, v21
    v_add_f32 v13, v13, v22
    v_add_f32 v13, v13, v23
    v_add_f32 v13, v13, v24
    v_add_f32 v13, v13, v25
    v_add_f32 v13, v13, v26
    v_add_f32 v13, v13, v27
    v_add_f32 v13, v13, v28
    v_add_f32 v13, v13, v29
    v_add_f32 v13, v13, v30
    v_add_f32 v13, v13, v31
    v_cvt_pk_bf16_f32 v13, v13, v13
    v_lshlrev_b32 v13, 16, v13
    s_sub_u32 s28, s2, 18
    s_cmp_lt_u32 s28, 18
    s_cselect_b32 s29, 1, 0
    s_sub_u32 s28, s2, 72
    s_cmp_lt_u32 s28, 18
    s_cselect_b32 s30, 1, 0
    s_or_b32 s29, s29, s30
    s_cmp_eq_u32 s29, 1
    s_cselect_b32 s29, 0x3f800000, 0
    v_add_f32 v13, s29, v13
    v_cvt_pk_bf16_f32 v13, v13, v13
    v_lshlrev_b32 v13, 16, v13
    v_cmp_gt_u32 vcc, 32, v0
    s_nop 0
    s_and_saveexec_b64 s[32:33], vcc
    s_lshl_b32 s25, s2, 7
    v_lshlrev_b32 v12, 2, v0
    v_add_u32 v12, s25, v12
    buffer_store_dword v13, v12, s[20:23], 0 offen
    s_endpgm
PREP_TR:
    s_load_dwordx2 s[4:5], s[0:1], 8
    s_load_dwordx2 s[6:7], s[0:1], 16
    s_load_dwordx2 s[8:9], s[0:1], 80
    s_waitcnt lgkmcnt(0)
    s_mov_b32 s12, s4
    s_and_b32 s13, s5, 0xffff
    s_mov_b32 s14, 1183744
    s_mov_b32 s15, 0x20000
    s_mov_b32 s16, s6
    s_and_b32 s17, s7, 0xffff
    s_mov_b32 s18, 1183744
    s_mov_b32 s19, 0x20000
    s_add_u32 s20, s8, 65536
    s_addc_u32 s21, s9, 0
    s_and_b32 s21, s21, 0xffff
    s_mov_b32 s22, 2367488
    s_mov_b32 s23, 0x20000
    s_sub_u32 s24, s2, 108
    s_and_b32 s25, s24, 31
    s_lshr_b32 s26, s24, 5
    v_and_b32 v1, 63, v0
    v_lshrrev_b32 v2, 6, v0
    s_lshl_b32 s27, s25, 6
    v_add_u32 v3, s27, v2
    v_mul_u32_u24 v3, 289, v3
    s_lshl_b32 s28, s26, 6
    v_add3_u32 v3, v3, s28, v1
    v_lshlrev_b32 v3, 1, v3
    s_mov_b32 s29, 0
    buffer_load_ushort v16, v3, s[12:15], s29 offen
    buffer_load_ushort v32, v3, s[16:19], s29 offen
    s_mov_b32 s29, 2312
    buffer_load_ushort v17, v3, s[12:15], s29 offen
    buffer_load_ushort v33, v3, s[16:19], s29 offen
    s_mov_b32 s29, 4624
    buffer_load_ushort v18, v3, s[12:15], s29 offen
    buffer_load_ushort v34, v3, s[16:19], s29 offen
    s_mov_b32 s29, 6936
    buffer_load_ushort v19, v3, s[12:15], s29 offen
    buffer_load_ushort v35, v3, s[16:19], s29 offen
    s_mov_b32 s29, 9248
    buffer_load_ushort v20, v3, s[12:15], s29 offen
    buffer_load_ushort v36, v3, s[16:19], s29 offen
    s_mov_b32 s29, 11560
    buffer_load_ushort v21, v3, s[12:15], s29 offen
    buffer_load_ushort v37, v3, s[16:19], s29 offen
    s_mov_b32 s29, 13872
    buffer_load_ushort v22, v3, s[12:15], s29 offen
    buffer_load_ushort v38, v3, s[16:19], s29 offen
    s_mov_b32 s29, 16184
    buffer_load_ushort v23, v3, s[12:15], s29 offen
    buffer_load_ushort v39, v3, s[16:19], s29 offen
    s_mov_b32 s29, 18496
    buffer_load_ushort v24, v3, s[12:15], s29 offen
    buffer_load_ushort v40, v3, s[16:19], s29 offen
    s_mov_b32 s29, 20808
    buffer_load_ushort v25, v3, s[12:15], s29 offen
    buffer_load_ushort v41, v3, s[16:19], s29 offen
    s_mov_b32 s29, 23120
    buffer_load_ushort v26, v3, s[12:15], s29 offen
    buffer_load_ushort v42, v3, s[16:19], s29 offen
    s_mov_b32 s29, 25432
    buffer_load_ushort v27, v3, s[12:15], s29 offen
    buffer_load_ushort v43, v3, s[16:19], s29 offen
    s_mov_b32 s29, 27744
    buffer_load_ushort v28, v3, s[12:15], s29 offen
    buffer_load_ushort v44, v3, s[16:19], s29 offen
    s_mov_b32 s29, 30056
    buffer_load_ushort v29, v3, s[12:15], s29 offen
    buffer_load_ushort v45, v3, s[16:19], s29 offen
    s_mov_b32 s29, 32368
    buffer_load_ushort v30, v3, s[12:15], s29 offen
    buffer_load_ushort v46, v3, s[16:19], s29 offen
    s_mov_b32 s29, 34680
    buffer_load_ushort v31, v3, s[12:15], s29 offen
    buffer_load_ushort v47, v3, s[16:19], s29 offen
    v_mul_u32_u24 v4, 65, v1
    v_add_u32 v4, v4, v2
    v_lshlrev_b32 v4, 2, v4
    s_waitcnt vmcnt(30)
    v_lshlrev_b32 v32, 16, v32
    v_or_b32 v16, v16, v32
    ds_write_b32 v4, v16 offset:0
    s_waitcnt vmcnt(28)
    v_lshlrev_b32 v33, 16, v33
    v_or_b32 v17, v17, v33
    ds_write_b32 v4, v17 offset:16
    s_waitcnt vmcnt(26)
    v_lshlrev_b32 v34, 16, v34
    v_or_b32 v18, v18, v34
    ds_write_b32 v4, v18 offset:32
    s_waitcnt vmcnt(24)
    v_lshlrev_b32 v35, 16, v35
    v_or_b32 v19, v19, v35
    ds_write_b32 v4, v19 offset:48
    s_waitcnt vmcnt(22)
    v_lshlrev_b32 v36, 16, v36
    v_or_b32 v20, v20, v36
    ds_write_b32 v4, v20 offset:64
    s_waitcnt vmcnt(20)
    v_lshlrev_b32 v37, 16, v37
    v_or_b32 v21, v21, v37
    ds_write_b32 v4, v21 offset:80
    s_waitcnt vmcnt(18)
    v_lshlrev_b32 v38, 16, v38
    v_or_b32 v22, v22, v38
    ds_write_b32 v4, v22 offset:96
    s_waitcnt vmcnt(16)
    v_lshlrev_b32 v39, 16, v39
    v_or_b32 v23, v23, v39
    ds_write_b32 v4, v23 offset:112
    s_waitcnt vmcnt(14)
    v_lshlrev_b32 v40, 16, v40
    v_or_b32 v24, v24, v40
    ds_write_b32 v4, v24 offset:128
    s_waitcnt vmcnt(12)
    v_lshlrev_b32 v41, 16, v41
    v_or_b32 v25, v25, v41
    ds_write_b32 v4, v25 offset:144
    s_waitcnt vmcnt(10)
    v_lshlrev_b32 v42, 16, v42
    v_or_b32 v26, v26, v42
    ds_write_b32 v4, v26 offset:160
    s_waitcnt vmcnt(8)
    v_lshlrev_b32 v43, 16, v43
    v_or_b32 v27, v27, v43
    ds_write_b32 v4, v27 offset:176
    s_waitcnt vmcnt(6)
    v_lshlrev_b32 v44, 16, v44
    v_or_b32 v28, v28, v44
    ds_write_b32 v4, v28 offset:192
    s_waitcnt vmcnt(4)
    v_lshlrev_b32 v45, 16, v45
    v_or_b32 v29, v29, v45
    ds_write_b32 v4, v29 offset:208
    s_waitcnt vmcnt(2)
    v_lshlrev_b32 v46, 16, v46
    v_or_b32 v30, v30, v46
    ds_write_b32 v4, v30 offset:224
    s_waitcnt vmcnt(0)
    v_lshlrev_b32 v47, 16, v47
    v_or_b32 v31, v31, v47
    ds_write_b32 v4, v31 offset:240
    s_waitcnt lgkmcnt(0)
    s_barrier
    v_mul_u32_u24 v5, 65, v2
    v_add_u32 v5, v5, v1
    v_lshlrev_b32 v5, 2, v5
    ds_read_b32 v16, v5 offset:0
    ds_read_b32 v17, v5 offset:1040
    ds_read_b32 v18, v5 offset:2080
    ds_read_b32 v19, v5 offset:3120
    ds_read_b32 v20, v5 offset:4160
    ds_read_b32 v21, v5 offset:5200
    ds_read_b32 v22, v5 offset:6240
    ds_read_b32 v23, v5 offset:7280
    ds_read_b32 v24, v5 offset:8320
    ds_read_b32 v25, v5 offset:9360
    ds_read_b32 v26, v5 offset:10400
    ds_read_b32 v27, v5 offset:11440
    ds_read_b32 v28, v5 offset:12480
    ds_read_b32 v29, v5 offset:13520
    ds_read_b32 v30, v5 offset:14560
    ds_read_b32 v31, v5 offset:15600
    v_add_u32 v6, s28, v2
    v_lshlrev_b32 v6, 11, v6
    v_add3_u32 v6, v6, s27, v1
    v_lshlrev_b32 v6, 2, v6
    s_waitcnt lgkmcnt(15)
    s_mov_b32 s29, 0
    buffer_store_dword v16, v6, s[20:23], s29 offen
    s_waitcnt lgkmcnt(14)
    s_mov_b32 s29, 32768
    buffer_store_dword v17, v6, s[20:23], s29 offen
    s_waitcnt lgkmcnt(13)
    s_mov_b32 s29, 65536
    buffer_store_dword v18, v6, s[20:23], s29 offen
    s_waitcnt lgkmcnt(12)
    s_mov_b32 s29, 98304
    buffer_store_dword v19, v6, s[20:23], s29 offen
    s_waitcnt lgkmcnt(11)
    s_mov_b32 s29, 131072
    buffer_store_dword v20, v6, s[20:23], s29 offen
    s_waitcnt lgkmcnt(10)
    s_mov_b32 s29, 163840
    buffer_store_dword v21, v6, s[20:23], s29 offen
    s_waitcnt lgkmcnt(9)
    s_mov_b32 s29, 196608
    buffer_store_dword v22, v6, s[20:23], s29 offen
    s_waitcnt lgkmcnt(8)
    s_mov_b32 s29, 229376
    buffer_store_dword v23, v6, s[20:23], s29 offen
    s_waitcnt lgkmcnt(7)
    s_mov_b32 s29, 262144
    buffer_store_dword v24, v6, s[20:23], s29 offen
    s_waitcnt lgkmcnt(6)
    s_mov_b32 s29, 294912
    buffer_store_dword v25, v6, s[20:23], s29 offen
    s_waitcnt lgkmcnt(5)
    s_mov_b32 s29, 327680
    buffer_store_dword v26, v6, s[20:23], s29 offen
    s_waitcnt lgkmcnt(4)
    s_mov_b32 s29, 360448
    buffer_store_dword v27, v6, s[20:23], s29 offen
    s_waitcnt lgkmcnt(3)
    s_mov_b32 s29, 393216
    buffer_store_dword v28, v6, s[20:23], s29 offen
    s_waitcnt lgkmcnt(2)
    s_mov_b32 s29, 425984
    buffer_store_dword v29, v6, s[20:23], s29 offen
    s_waitcnt lgkmcnt(1)
    s_mov_b32 s29, 458752
    buffer_store_dword v30, v6, s[20:23], s29 offen
    s_waitcnt lgkmcnt(0)
    s_mov_b32 s29, 491520
    buffer_store_dword v31, v6, s[20:23], s29 offen
PREP_END:
    s_endpgm
.globl ln_rfft_kernel
.p2align 8
.type ln_rfft_kernel,@function
ln_rfft_kernel:
    s_cmp_ge_u32 s2, 256
    s_cbranch_scc1 K1_END
    s_load_dwordx2 s[4:5], s[0:1], 0
    s_load_dwordx2 s[6:7], s[0:1], 80
    s_waitcnt lgkmcnt(0)
    s_mov_b32 s8, s4
    s_and_b32 s9, s5, 0xffff
    s_mov_b32 s10, 2359296
    s_mov_b32 s11, 0x20000
    s_mov_b32 s12, s6
    s_and_b32 s13, s7, 0xffff
    s_mov_b32 s14, 13824
    s_mov_b32 s15, 0x20000
    s_add_u32 s16, s6, 3145728
    s_addc_u32 s17, s7, 0
    s_and_b32 s17, s17, 0xffff
    s_mov_b32 s18, 4734976
    s_mov_b32 s19, 0x20000
    s_lshl_b32 s20, s2, 3
    v_mul_u32_u24 v3, 2731, v0
    v_lshrrev_b32 v1, 16, v3
    v_mul_u32_u24 v3, 24, v1
    v_sub_u32 v2, v0, v3
    v_add_u32 v4, s20, v1
    v_mul_u32_u24 v4, 1152, v4
    v_mul_u32_u24 v5, 48, v2
    v_add_u32 v4, v4, v5
    buffer_load_dwordx4 v[8:11], v4, s[8:11], 0 offen offset:0
    buffer_load_dwordx4 v[12:15], v4, s[8:11], 0 offen offset:16
    buffer_load_dwordx4 v[16:19], v4, s[8:11], 0 offen offset:32
    v_mul_u32_u24 v5, 96, v2
    buffer_load_dwordx4 v[104:107], v5, s[12:15], 0 offen offset:0
    buffer_load_dwordx4 v[108:111], v5, s[12:15], 0 offen offset:16
    buffer_load_dwordx4 v[112:115], v5, s[12:15], 0 offen offset:32
    buffer_load_dwordx4 v[116:119], v5, s[12:15], 0 offen offset:48
    buffer_load_dwordx4 v[120:123], v5, s[12:15], 0 offen offset:64
    buffer_load_dwordx4 v[124:127], v5, s[12:15], 0 offen offset:80
    buffer_load_dwordx4 v[80:83], v5, s[12:15], 0 offen offset:2304
    buffer_load_dwordx4 v[84:87], v5, s[12:15], 0 offen offset:2320
    buffer_load_dwordx4 v[88:91], v5, s[12:15], 0 offen offset:2336
    buffer_load_dwordx4 v[92:95], v5, s[12:15], 0 offen offset:2352
    buffer_load_dwordx4 v[96:99], v5, s[12:15], 0 offen offset:2368
    buffer_load_dwordx4 v[100:103], v5, s[12:15], 0 offen offset:2384
    s_waitcnt vmcnt(12)
    v_lshlrev_b32 v20, 16, v8
    v_and_b32 v21, 0xffff0000, v8
    v_lshlrev_b32 v22, 16, v9
    v_and_b32 v23, 0xffff0000, v9
    v_lshlrev_b32 v24, 16, v10
    v_and_b32 v25, 0xffff0000, v10
    v_lshlrev_b32 v26, 16, v11
    v_and_b32 v27, 0xffff0000, v11
    v_lshlrev_b32 v28, 16, v12
    v_and_b32 v29, 0xffff0000, v12
    v_lshlrev_b32 v30, 16, v13
    v_and_b32 v31, 0xffff0000, v13
    v_lshlrev_b32 v32, 16, v14
    v_and_b32 v33, 0xffff0000, v14
    v_lshlrev_b32 v34, 16, v15
    v_and_b32 v35, 0xffff0000, v15
    v_lshlrev_b32 v36, 16, v16
    v_and_b32 v37, 0xffff0000, v16
    v_lshlrev_b32 v38, 16, v17
    v_and_b32 v39, 0xffff0000, v17
    v_lshlrev_b32 v40, 16, v18
    v_and_b32 v41, 0xffff0000, v18
    v_lshlrev_b32 v42, 16, v19
    v_and_b32 v43, 0xffff0000, v19
    v_add_f32 v44, v20, v24
    v_add_f32 v45, v21, v25
    v_add_f32 v46, v22, v26
    v_add_f32 v47, v23, v27
    v_add_f32 v44, v44, v28
    v_add_f32 v45, v45, v29
    v_add_f32 v46, v46, v30
    v_add_f32 v47, v47, v31
    v_add_f32 v44, v44, v32
    v_add_f32 v45, v45, v33
    v_add_f32 v46, v46, v34
    v_add_f32 v47, v47, v35
    v_add_f32 v44, v44, v36
    v_add_f32 v45, v45, v37
    v_add_f32 v46, v46, v38
    v_add_f32 v47, v47, v39
    v_add_f32 v44, v44, v40
    v_add_f32 v45, v45, v41
    v_add_f32 v46, v46, v42
    v_add_f32 v47, v47, v43
    v_add_f32 v44, v44, v45
    v_add_f32 v46, v46, v47
    v_add_f32 v44, v44, v46
    v_lshlrev_b32 v6, 2, v0
    ds_write_b32 v6, v44 offset:0
    s_waitcnt lgkmcnt(0)
    s_barrier
    v_mul_u32_u24 v6, 96, v1
    ds_read_b128 v[48:51], v6 offset:0
    ds_read_b128 v[52:55], v6 offset:16
    ds_read_b128 v[56:59], v6 offset:32
    ds_read_b128 v[60:63], v6 offset:48
    ds_read_b128 v[64:67], v6 offset:64
    ds_read_b128 v[68:71], v6 offset:80
    s_waitcnt lgkmcnt(0)
    v_add_f32 v76, v48, v52
    v_add_f32 v72, v49, v53
    v_add_f32 v73, v50, v54
    v_add_f32 v74, v51, v55
    v_add_f32 v76, v76, v56
    v_add_f32 v72, v72, v57
    v_add_f32 v73, v73, v58
    v_add_f32 v74, v74, v59
    v_add_f32 v76, v76, v60
    v_add_f32 v72, v72, v61
    v_add_f32 v73, v73, v62
    v_add_f32 v74, v74, v63
    v_add_f32 v76, v76, v64
    v_add_f32 v72, v72, v65
    v_add_f32 v73, v73, v66
    v_add_f32 v74, v74, v67
    v_add_f32 v76, v76, v68
    v_add_f32 v72, v72, v69
    v_add_f32 v73, v73, v70
    v_add_f32 v74, v74, v71
    v_add_f32 v76, v76, v72
    v_add_f32 v73, v73, v74
    v_add_f32 v76, v76, v73
    v_mul_f32 v76, 0x3ae38e39, v76
    v_sub_f32 v7, v20, v76
    v_mul_f32 v44, v7, v7
    v_sub_f32 v7, v21, v76
    v_mul_f32 v45, v7, v7
    v_sub_f32 v7, v22, v76
    v_mul_f32 v46, v7, v7
    v_sub_f32 v7, v23, v76
    v_mul_f32 v47, v7, v7
    v_sub_f32 v7, v24, v76
    v_fmac_f32 v44, v7, v7
    v_sub_f32 v7, v25, v76
    v_fmac_f32 v45, v7, v7
    v_sub_f32 v7, v26, v76
    v_fmac_f32 v46, v7, v7
    v_sub_f32 v7, v27, v76
    v_fmac_f32 v47, v7, v7
    v_sub_f32 v7, v28, v76
    v_fmac_f32 v44, v7, v7
    v_sub_f32 v7, v29, v76
    v_fmac_f32 v45, v7, v7
    v_sub_f32 v7, v30, v76
    v_fmac_f32 v46, v7, v7
    v_sub_f32 v7, v31, v76
    v_fmac_f32 v47, v7, v7
    v_sub_f32 v7, v32, v76
    v_fmac_f32 v44, v7, v7
    v_sub_f32 v7, v33, v76
    v_fmac_f32 v45, v7, v7
    v_sub_f32 v7, v34, v76
    v_fmac_f32 v46, v7, v7
    v_sub_f32 v7, v35, v76
    v_fmac_f32 v47, v7, v7
    v_sub_f32 v7, v36, v76
    v_fmac_f32 v44, v7, v7
    v_sub_f32 v7, v37, v76
    v_fmac_f32 v45, v7, v7
    v_sub_f32 v7, v38, v76
    v_fmac_f32 v46, v7, v7
    v_sub_f32 v7, v39, v76
    v_fmac_f32 v47, v7, v7
    v_sub_f32 v7, v40, v76
    v_fmac_f32 v44, v7, v7
    v_sub_f32 v7, v41, v76
    v_fmac_f32 v45, v7, v7
    v_sub_f32 v7, v42, v76
    v_fmac_f32 v46, v7, v7
    v_sub_f32 v7, v43, v76
    v_fmac_f32 v47, v7, v7
    v_add_f32 v44, v44, v45
    v_add_f32 v46, v46, v47
    v_add_f32 v44, v44, v46
    v_lshlrev_b32 v6, 2, v0
    ds_write_b32 v6, v44 offset:768
    s_waitcnt lgkmcnt(0)
    s_barrier
    v_mul_u32_u24 v6, 96, v1
    ds_read_b128 v[48:51], v6 offset:768
    ds_read_b128 v[52:55], v6 offset:784
    ds_read_b128 v[56:59], v6 offset:800
    ds_read_b128 v[60:63], v6 offset:816
    ds_read_b128 v[64:67], v6 offset:832
    ds_read_b128 v[68:71], v6 offset:848
    s_waitcnt lgkmcnt(0)
    v_add_f32 v77, v48, v52
    v_add_f32 v72, v49, v53
    v_add_f32 v73, v50, v54
    v_add_f32 v74, v51, v55
    v_add_f32 v77, v77, v56
    v_add_f32 v72, v72, v57
    v_add_f32 v73, v73, v58
    v_add_f32 v74, v74, v59
    v_add_f32 v77, v77, v60
    v_add_f32 v72, v72, v61
    v_add_f32 v73, v73, v62
    v_add_f32 v74, v74, v63
    v_add_f32 v77, v77, v64
    v_add_f32 v72, v72, v65
    v_add_f32 v73, v73, v66
    v_add_f32 v74, v74, v67
    v_add_f32 v77, v77, v68
    v_add_f32 v72, v72, v69
    v_add_f32 v73, v73, v70
    v_add_f32 v74, v74, v71
    v_add_f32 v77, v77, v72
    v_add_f32 v73, v73, v74
    v_add_f32 v77, v77, v73
    v_mul_f32 v77, 0x3ae38e39, v77
    v_cvt_pk_bf16_f32 v77, v77, v77
    v_lshlrev_b32 v77, 16, v77
    v_add_f32 v77, 0x3727c5ac, v77
    v_cvt_pk_bf16_f32 v77, v77, v77
    v_lshlrev_b32 v77, 16, v77
    v_sqrt_f32 v77, v77
    s_nop 0
    v_cvt_pk_bf16_f32 v77, v77, v77
    v_lshlrev_b32 v77, 16, v77
    v_rcp_f32 v77, v77
    v_cvt_pk_bf16_f32 v76, v76, v76
    v_lshlrev_b32 v76, 16, v76
    s_waitcnt vmcnt(0)
    v_sub_f32 v20, v20, v76
    v_sub_f32 v21, v21, v76
    v_cvt_pk_bf16_f32 v21, v20, v21
    v_lshlrev_b32 v20, 16, v21
    v_and_b32 v21, 0xffff0000, v21
    v_mul_f32 v20, v20, v77
    v_mul_f32 v21, v21, v77
    v_cvt_pk_bf16_f32 v21, v20, v21
    v_lshlrev_b32 v20, 16, v21
    v_and_b32 v21, 0xffff0000, v21
    v_mul_f32 v20, v20, v80
    v_mul_f32 v21, v21, v81
    v_cvt_pk_bf16_f32 v21, v20, v21
    v_lshlrev_b32 v20, 16, v21
    v_and_b32 v21, 0xffff0000, v21
    v_add_f32 v20, v20, v104
    v_add_f32 v21, v21, v105
    v_cvt_pk_bf16_f32 v21, v20, v21
    v_lshlrev_b32 v20, 16, v21
    v_and_b32 v21, 0xffff0000, v21
    v_sub_f32 v22, v22, v76
    v_sub_f32 v23, v23, v76
    v_cvt_pk_bf16_f32 v23, v22, v23
    v_lshlrev_b32 v22, 16, v23
    v_and_b32 v23, 0xffff0000, v23
    v_mul_f32 v22, v22, v77
    v_mul_f32 v23, v23, v77
    v_cvt_pk_bf16_f32 v23, v22, v23
    v_lshlrev_b32 v22, 16, v23
    v_and_b32 v23, 0xffff0000, v23
    v_mul_f32 v22, v22, v82
    v_mul_f32 v23, v23, v83
    v_cvt_pk_bf16_f32 v23, v22, v23
    v_lshlrev_b32 v22, 16, v23
    v_and_b32 v23, 0xffff0000, v23
    v_add_f32 v22, v22, v106
    v_add_f32 v23, v23, v107
    v_cvt_pk_bf16_f32 v23, v22, v23
    v_lshlrev_b32 v22, 16, v23
    v_and_b32 v23, 0xffff0000, v23
    v_sub_f32 v24, v24, v76
    v_sub_f32 v25, v25, v76
    v_cvt_pk_bf16_f32 v25, v24, v25
    v_lshlrev_b32 v24, 16, v25
    v_and_b32 v25, 0xffff0000, v25
    v_mul_f32 v24, v24, v77
    v_mul_f32 v25, v25, v77
    v_cvt_pk_bf16_f32 v25, v24, v25
    v_lshlrev_b32 v24, 16, v25
    v_and_b32 v25, 0xffff0000, v25
    v_mul_f32 v24, v24, v84
    v_mul_f32 v25, v25, v85
    v_cvt_pk_bf16_f32 v25, v24, v25
    v_lshlrev_b32 v24, 16, v25
    v_and_b32 v25, 0xffff0000, v25
    v_add_f32 v24, v24, v108
    v_add_f32 v25, v25, v109
    v_cvt_pk_bf16_f32 v25, v24, v25
    v_lshlrev_b32 v24, 16, v25
    v_and_b32 v25, 0xffff0000, v25
    v_sub_f32 v26, v26, v76
    v_sub_f32 v27, v27, v76
    v_cvt_pk_bf16_f32 v27, v26, v27
    v_lshlrev_b32 v26, 16, v27
    v_and_b32 v27, 0xffff0000, v27
    v_mul_f32 v26, v26, v77
    v_mul_f32 v27, v27, v77
    v_cvt_pk_bf16_f32 v27, v26, v27
    v_lshlrev_b32 v26, 16, v27
    v_and_b32 v27, 0xffff0000, v27
    v_mul_f32 v26, v26, v86
    v_mul_f32 v27, v27, v87
    v_cvt_pk_bf16_f32 v27, v26, v27
    v_lshlrev_b32 v26, 16, v27
    v_and_b32 v27, 0xffff0000, v27
    v_add_f32 v26, v26, v110
    v_add_f32 v27, v27, v111
    v_cvt_pk_bf16_f32 v27, v26, v27
    v_lshlrev_b32 v26, 16, v27
    v_and_b32 v27, 0xffff0000, v27
    v_sub_f32 v28, v28, v76
    v_sub_f32 v29, v29, v76
    v_cvt_pk_bf16_f32 v29, v28, v29
    v_lshlrev_b32 v28, 16, v29
    v_and_b32 v29, 0xffff0000, v29
    v_mul_f32 v28, v28, v77
    v_mul_f32 v29, v29, v77
    v_cvt_pk_bf16_f32 v29, v28, v29
    v_lshlrev_b32 v28, 16, v29
    v_and_b32 v29, 0xffff0000, v29
    v_mul_f32 v28, v28, v88
    v_mul_f32 v29, v29, v89
    v_cvt_pk_bf16_f32 v29, v28, v29
    v_lshlrev_b32 v28, 16, v29
    v_and_b32 v29, 0xffff0000, v29
    v_add_f32 v28, v28, v112
    v_add_f32 v29, v29, v113
    v_cvt_pk_bf16_f32 v29, v28, v29
    v_lshlrev_b32 v28, 16, v29
    v_and_b32 v29, 0xffff0000, v29
    v_sub_f32 v30, v30, v76
    v_sub_f32 v31, v31, v76
    v_cvt_pk_bf16_f32 v31, v30, v31
    v_lshlrev_b32 v30, 16, v31
    v_and_b32 v31, 0xffff0000, v31
    v_mul_f32 v30, v30, v77
    v_mul_f32 v31, v31, v77
    v_cvt_pk_bf16_f32 v31, v30, v31
    v_lshlrev_b32 v30, 16, v31
    v_and_b32 v31, 0xffff0000, v31
    v_mul_f32 v30, v30, v90
    v_mul_f32 v31, v31, v91
    v_cvt_pk_bf16_f32 v31, v30, v31
    v_lshlrev_b32 v30, 16, v31
    v_and_b32 v31, 0xffff0000, v31
    v_add_f32 v30, v30, v114
    v_add_f32 v31, v31, v115
    v_cvt_pk_bf16_f32 v31, v30, v31
    v_lshlrev_b32 v30, 16, v31
    v_and_b32 v31, 0xffff0000, v31
    v_sub_f32 v32, v32, v76
    v_sub_f32 v33, v33, v76
    v_cvt_pk_bf16_f32 v33, v32, v33
    v_lshlrev_b32 v32, 16, v33
    v_and_b32 v33, 0xffff0000, v33
    v_mul_f32 v32, v32, v77
    v_mul_f32 v33, v33, v77
    v_cvt_pk_bf16_f32 v33, v32, v33
    v_lshlrev_b32 v32, 16, v33
    v_and_b32 v33, 0xffff0000, v33
    v_mul_f32 v32, v32, v92
    v_mul_f32 v33, v33, v93
    v_cvt_pk_bf16_f32 v33, v32, v33
    v_lshlrev_b32 v32, 16, v33
    v_and_b32 v33, 0xffff0000, v33
    v_add_f32 v32, v32, v116
    v_add_f32 v33, v33, v117
    v_cvt_pk_bf16_f32 v33, v32, v33
    v_lshlrev_b32 v32, 16, v33
    v_and_b32 v33, 0xffff0000, v33
    v_sub_f32 v34, v34, v76
    v_sub_f32 v35, v35, v76
    v_cvt_pk_bf16_f32 v35, v34, v35
    v_lshlrev_b32 v34, 16, v35
    v_and_b32 v35, 0xffff0000, v35
    v_mul_f32 v34, v34, v77
    v_mul_f32 v35, v35, v77
    v_cvt_pk_bf16_f32 v35, v34, v35
    v_lshlrev_b32 v34, 16, v35
    v_and_b32 v35, 0xffff0000, v35
    v_mul_f32 v34, v34, v94
    v_mul_f32 v35, v35, v95
    v_cvt_pk_bf16_f32 v35, v34, v35
    v_lshlrev_b32 v34, 16, v35
    v_and_b32 v35, 0xffff0000, v35
    v_add_f32 v34, v34, v118
    v_add_f32 v35, v35, v119
    v_cvt_pk_bf16_f32 v35, v34, v35
    v_lshlrev_b32 v34, 16, v35
    v_and_b32 v35, 0xffff0000, v35
    v_sub_f32 v36, v36, v76
    v_sub_f32 v37, v37, v76
    v_cvt_pk_bf16_f32 v37, v36, v37
    v_lshlrev_b32 v36, 16, v37
    v_and_b32 v37, 0xffff0000, v37
    v_mul_f32 v36, v36, v77
    v_mul_f32 v37, v37, v77
    v_cvt_pk_bf16_f32 v37, v36, v37
    v_lshlrev_b32 v36, 16, v37
    v_and_b32 v37, 0xffff0000, v37
    v_mul_f32 v36, v36, v96
    v_mul_f32 v37, v37, v97
    v_cvt_pk_bf16_f32 v37, v36, v37
    v_lshlrev_b32 v36, 16, v37
    v_and_b32 v37, 0xffff0000, v37
    v_add_f32 v36, v36, v120
    v_add_f32 v37, v37, v121
    v_cvt_pk_bf16_f32 v37, v36, v37
    v_lshlrev_b32 v36, 16, v37
    v_and_b32 v37, 0xffff0000, v37
    v_sub_f32 v38, v38, v76
    v_sub_f32 v39, v39, v76
    v_cvt_pk_bf16_f32 v39, v38, v39
    v_lshlrev_b32 v38, 16, v39
    v_and_b32 v39, 0xffff0000, v39
    v_mul_f32 v38, v38, v77
    v_mul_f32 v39, v39, v77
    v_cvt_pk_bf16_f32 v39, v38, v39
    v_lshlrev_b32 v38, 16, v39
    v_and_b32 v39, 0xffff0000, v39
    v_mul_f32 v38, v38, v98
    v_mul_f32 v39, v39, v99
    v_cvt_pk_bf16_f32 v39, v38, v39
    v_lshlrev_b32 v38, 16, v39
    v_and_b32 v39, 0xffff0000, v39
    v_add_f32 v38, v38, v122
    v_add_f32 v39, v39, v123
    v_cvt_pk_bf16_f32 v39, v38, v39
    v_lshlrev_b32 v38, 16, v39
    v_and_b32 v39, 0xffff0000, v39
    v_sub_f32 v40, v40, v76
    v_sub_f32 v41, v41, v76
    v_cvt_pk_bf16_f32 v41, v40, v41
    v_lshlrev_b32 v40, 16, v41
    v_and_b32 v41, 0xffff0000, v41
    v_mul_f32 v40, v40, v77
    v_mul_f32 v41, v41, v77
    v_cvt_pk_bf16_f32 v41, v40, v41
    v_lshlrev_b32 v40, 16, v41
    v_and_b32 v41, 0xffff0000, v41
    v_mul_f32 v40, v40, v100
    v_mul_f32 v41, v41, v101
    v_cvt_pk_bf16_f32 v41, v40, v41
    v_lshlrev_b32 v40, 16, v41
    v_and_b32 v41, 0xffff0000, v41
    v_add_f32 v40, v40, v124
    v_add_f32 v41, v41, v125
    v_cvt_pk_bf16_f32 v41, v40, v41
    v_lshlrev_b32 v40, 16, v41
    v_and_b32 v41, 0xffff0000, v41
    v_sub_f32 v42, v42, v76
    v_sub_f32 v43, v43, v76
    v_cvt_pk_bf16_f32 v43, v42, v43
    v_lshlrev_b32 v42, 16, v43
    v_and_b32 v43, 0xffff0000, v43
    v_mul_f32 v42, v42, v77
    v_mul_f32 v43, v43, v77
    v_cvt_pk_bf16_f32 v43, v42, v43
    v_lshlrev_b32 v42, 16, v43
    v_and_b32 v43, 0xffff0000, v43
    v_mul_f32 v42, v42, v102
    v_mul_f32 v43, v43, v103
    v_cvt_pk_bf16_f32 v43, v42, v43
    v_lshlrev_b32 v42, 16, v43
    v_and_b32 v43, 0xffff0000, v43
    v_add_f32 v42, v42, v126
    v_add_f32 v43, v43, v127
    v_cvt_pk_bf16_f32 v43, v42, v43
    v_lshlrev_b32 v42, 16, v43
    v_and_b32 v43, 0xffff0000, v43
    v_and_b32 v6, 1, v1
    v_lshlrev_b32 v6, 2, v6
    v_lshrrev_b32 v7, 1, v1
    v_add_u32 v6, v6, v7
    v_mul_u32_u24 v6, 2336, v6
    v_add_u32 v6, v6, v5
    ds_write_b128 v6, v[20:23] offset:20224
    ds_write_b128 v6, v[24:27] offset:20240
    ds_write_b128 v6, v[28:31] offset:20256
    ds_write_b128 v6, v[32:35] offset:20272
    ds_write_b128 v6, v[36:39] offset:20288
    ds_write_b128 v6, v[40:43] offset:20304
    s_waitcnt lgkmcnt(0)
    s_barrier
    v_lshrrev_b32 v1, 2, v0
    v_and_b32 v2, 3, v0
    v_mul_u32_u24 v3, 4672, v2
    v_mul_u32_u24 v4, 96, v1
    v_add_u32 v8, v3, v4
    v_lshlrev_b32 v4, 3, v1
    v_add_u32 v9, v3, v4
    v_mul_u32_u24 v4, 21846, v1
    v_lshrrev_b32 v4, 18, v4
    v_mul_u32_u24 v5, 12, v4
    v_sub_u32 v5, v1, v5
    v_mul_u32_u24 v4, 1152, v4
    v_lshlrev_b32 v5, 3, v5
    v_add3_u32 v4, v3, v4, v5
    v_mov_b32 v10, v4
    v_mul_u32_u24 v4, 21846, v1
    v_lshrrev_b32 v4, 18, v4
    v_mul_u32_u24 v4, 12, v4
    v_sub_u32 v4, v1, v4
    v_cvt_f32_u32 v4, v4
    v_mul_f32 v11, 0x3be38e39, v4
    v_cvt_f32_u32 v4, v1
    v_mul_f32 v12, 0x3ae38e39, v4
    v_add_f32 v4, 0x42400000, v4
    v_mul_f32 v13, 0x3ae38e39, v4
    v_add_f32 v4, 0x42400000, v4
    v_mul_f32 v14, 0x3ae38e39, v4
    v_mul_u32_u24 v15, 2336, v2
    v_lshlrev_b32 v4, 2, v1
    v_add_u32 v15, v15, v4
    ds_read_b32 v16, v15 offset:20224
    ds_read_b32 v17, v15 offset:29568
    ds_read_b32 v18, v15 offset:20416
    ds_read_b32 v19, v15 offset:29760
    ds_read_b32 v20, v15 offset:20608
    ds_read_b32 v21, v15 offset:29952
    ds_read_b32 v22, v15 offset:20800
    ds_read_b32 v23, v15 offset:30144
    ds_read_b32 v24, v15 offset:20992
    ds_read_b32 v25, v15 offset:30336
    ds_read_b32 v26, v15 offset:21184
    ds_read_b32 v27, v15 offset:30528
    ds_read_b32 v28, v15 offset:21376
    ds_read_b32 v29, v15 offset:30720
    ds_read_b32 v30, v15 offset:21568
    ds_read_b32 v31, v15 offset:30912
    ds_read_b32 v32, v15 offset:21760
    ds_read_b32 v33, v15 offset:31104
    ds_read_b32 v34, v15 offset:21952
    ds_read_b32 v35, v15 offset:31296
    ds_read_b32 v36, v15 offset:22144
    ds_read_b32 v37, v15 offset:31488
    ds_read_b32 v38, v15 offset:22336
    ds_read_b32 v39, v15 offset:31680
    s_waitcnt lgkmcnt(0)
    v_add_f32 v40, v16, v28
    v_sub_f32 v28, v16, v28
    v_add_f32 v16, v17, v29
    v_sub_f32 v29, v17, v29
    v_add_f32 v17, v22, v34
    v_sub_f32 v34, v22, v34
    v_add_f32 v22, v23, v35
    v_sub_f32 v35, v23, v35
    v_add_f32 v23, v40, v17
    v_sub_f32 v17, v40, v17
    v_add_f32 v40, v16, v22
    v_sub_f32 v22, v16, v22
    v_add_f32 v16, v28, v35
    v_sub_f32 v41, v29, v34
    v_sub_f32 v42, v28, v35
    v_add_f32 v43, v29, v34
    v_add_f32 v28, v24, v36
    v_sub_f32 v36, v24, v36
    v_add_f32 v24, v25, v37
    v_sub_f32 v37, v25, v37
    v_add_f32 v25, v30, v18
    v_sub_f32 v18, v30, v18
    v_add_f32 v29, v31, v19
    v_sub_f32 v19, v31, v19
    v_add_f32 v30, v28, v25
    v_sub_f32 v25, v28, v25
    v_add_f32 v28, v24, v29
    v_sub_f32 v29, v24, v29
    v_add_f32 v24, v36, v19
    v_sub_f32 v31, v37, v18
    v_sub_f32 v34, v36, v19
    v_add_f32 v35, v37, v18
    v_add_f32 v18, v32, v20
    v_sub_f32 v20, v32, v20
    v_add_f32 v19, v33, v21
    v_sub_f32 v21, v33, v21
    v_add_f32 v32, v38, v26
    v_sub_f32 v26, v38, v26
    v_add_f32 v33, v39, v27
    v_sub_f32 v27, v39, v27
    v_add_f32 v36, v18, v32
    v_sub_f32 v32, v18, v32
    v_add_f32 v18, v19, v33
    v_sub_f32 v33, v19, v33
    v_add_f32 v19, v20, v27
    v_sub_f32 v37, v21, v26
    v_sub_f32 v38, v20, v27
    v_add_f32 v39, v21, v26
    v_add_f32 v20, v30, v36
    v_sub_f32 v36, v30, v36
    v_add_f32 v21, v28, v18
    v_sub_f32 v18, v28, v18
    v_add_f32 v26, v23, v20
    v_fma_f32 v28, -0.5, v20, v23
    v_mul_f32 v36, 0x3f5db3d7, v36
    v_add_f32 v27, v40, v21
    v_fma_f32 v30, -0.5, v21, v40
    v_mul_f32 v18, 0x3f5db3d7, v18
    v_add_f32 v20, v28, v18
    v_sub_f32 v21, v30, v36
    v_sub_f32 v23, v28, v18
    v_add_f32 v40, v30, v36
    v_add_f32 v18, v24, v19
    v_sub_f32 v19, v24, v19
    v_add_f32 v24, v31, v37
    v_sub_f32 v37, v31, v37
    v_add_f32 v28, v16, v18
    v_fma_f32 v31, -0.5, v18, v16
    v_mul_f32 v19, 0x3f5db3d7, v19
    v_add_f32 v30, v41, v24
    v_fma_f32 v36, -0.5, v24, v41
    v_mul_f32 v37, 0x3f5db3d7, v37
    v_add_f32 v16, v31, v37
    v_sub_f32 v18, v36, v19
    v_sub_f32 v24, v31, v37
    v_add_f32 v41, v36, v19
    v_add_f32 v19, v25, v32
    v_sub_f32 v32, v25, v32
    v_add_f32 v25, v29, v33
    v_sub_f32 v33, v29, v33
    v_add_f32 v29, v17, v19
    v_fma_f32 v36, -0.5, v19, v17
    v_mul_f32 v32, 0x3f5db3d7, v32
    v_add_f32 v31, v22, v25
    v_fma_f32 v37, -0.5, v25, v22
    v_mul_f32 v33, 0x3f5db3d7, v33
    v_add_f32 v17, v36, v33
    v_sub_f32 v19, v37, v32
    v_sub_f32 v22, v36, v33
    v_add_f32 v25, v37, v32
    v_add_f32 v32, v34, v38
    v_sub_f32 v38, v34, v38
    v_add_f32 v33, v35, v39
    v_sub_f32 v39, v35, v39
    v_add_f32 v34, v42, v32
    v_fma_f32 v36, -0.5, v32, v42
    v_mul_f32 v38, 0x3f5db3d7, v38
    v_add_f32 v35, v43, v33
    v_fma_f32 v37, -0.5, v33, v43
    v_mul_f32 v39, 0x3f5db3d7, v39
    v_add_f32 v32, v36, v39
    v_sub_f32 v33, v37, v38
    v_sub_f32 v42, v36, v39
    v_add_f32 v43, v37, v38
    ds_write_b32 v8, v26 offset:1536
    ds_write_b32 v8, v27 offset:1540
    ds_write_b32 v8, v16 offset:1544
    ds_write_b32 v8, v18 offset:1548
    ds_write_b32 v8, v22 offset:1552
    ds_write_b32 v8, v25 offset:1556
    ds_write_b32 v8, v34 offset:1560
    ds_write_b32 v8, v35 offset:1564
    ds_write_b32 v8, v20 offset:1568
    ds_write_b32 v8, v21 offset:1572
    ds_write_b32 v8, v24 offset:1576
    ds_write_b32 v8, v41 offset:1580
    ds_write_b32 v8, v29 offset:1584
    ds_write_b32 v8, v31 offset:1588
    ds_write_b32 v8, v32 offset:1592
    ds_write_b32 v8, v33 offset:1596
    ds_write_b32 v8, v23 offset:1600
    ds_write_b32 v8, v40 offset:1604
    ds_write_b32 v8, v28 offset:1608
    ds_write_b32 v8, v30 offset:1612
    ds_write_b32 v8, v17 offset:1616
    ds_write_b32 v8, v19 offset:1620
    ds_write_b32 v8, v42 offset:1624
    ds_write_b32 v8, v43 offset:1628
    s_waitcnt lgkmcnt(0)
    s_barrier
    ds_read_b64 v[16:17], v9 offset:1536
    ds_read_b64 v[18:19], v9 offset:1920
    ds_read_b64 v[20:21], v9 offset:2304
    ds_read_b64 v[22:23], v9 offset:2688
    ds_read_b64 v[24:25], v9 offset:3072
    ds_read_b64 v[26:27], v9 offset:3456
    ds_read_b64 v[28:29], v9 offset:3840
    ds_read_b64 v[30:31], v9 offset:4224
    ds_read_b64 v[32:33], v9 offset:4608
    ds_read_b64 v[34:35], v9 offset:4992
    ds_read_b64 v[36:37], v9 offset:5376
    ds_read_b64 v[38:39], v9 offset:5760
    s_waitcnt lgkmcnt(0)
    v_sin_f32 v42, v11
    v_cos_f32 v41, v11
    v_mul_f32 v40, 0x40000000, v11
    v_sin_f32 v44, v40
    v_cos_f32 v43, v40
    v_mul_f32 v40, v18, v41
    v_mul_f32 v45, v19, v41
    v_fmac_f32 v40, v19, v42
    v_fma_f32 v45, -v18, v42, v45
    v_mul_f32 v18, 0x40400000, v11
    v_sin_f32 v41, v18
    v_cos_f32 v19, v18
    v_mul_f32 v18, v20, v43
    v_mul_f32 v42, v21, v43
    v_fmac_f32 v18, v21, v44
    v_fma_f32 v42, -v20, v44, v42
    v_mul_f32 v20, 0x40800000, v11
    v_sin_f32 v43, v20
    v_cos_f32 v21, v20
    v_mul_f32 v20, v22, v19
    v_mul_f32 v44, v23, v19
    v_fmac_f32 v20, v23, v41
    v_fma_f32 v44, -v22, v41, v44
    v_mul_f32 v19, 0x40a00000, v11
    v_sin_f32 v23, v19
    v_cos_f32 v22, v19
    v_mul_f32 v19, v24, v21
    v_mul_f32 v41, v25, v21
    v_fmac_f32 v19, v25, v43
    v_fma_f32 v41, -v24, v43, v41
    v_mul_f32 v21, 0x40c00000, v11
    v_sin_f32 v25, v21
    v_cos_f32 v24, v21
    v_mul_f32 v21, v26, v22
    v_mul_f32 v43, v27, v22
    v_fmac_f32 v21, v27, v23
    v_fma_f32 v43, -v26, v23, v43
    v_mul_f32 v22, 0x40e00000, v11
    v_sin_f32 v26, v22
    v_cos_f32 v23, v22
    v_mul_f32 v22, v28, v24
    v_mul_f32 v27, v29, v24
    v_fmac_f32 v22, v29, v25
    v_fma_f32 v27, -v28, v25, v27
    v_mul_f32 v24, 0x41000000, v11
    v_sin_f32 v28, v24
    v_cos_f32 v25, v24
    v_mul_f32 v24, v30, v23
    v_mul_f32 v29, v31, v23
    v_fmac_f32 v24, v31, v26
    v_fma_f32 v29, -v30, v26, v29
    v_mul_f32 v23, 0x41100000, v11
    v_sin_f32 v30, v23
    v_cos_f32 v26, v23
    v_mul_f32 v23, v32, v25
    v_mul_f32 v31, v33, v25
    v_fmac_f32 v23, v33, v28
    v_fma_f32 v31, -v32, v28, v31
    v_mul_f32 v25, 0x41200000, v11
    v_sin_f32 v32, v25
    v_cos_f32 v28, v25
    v_mul_f32 v25, v34, v26
    v_mul_f32 v33, v35, v26
    v_fmac_f32 v25, v35, v30
    v_fma_f32 v33, -v34, v30, v33
    v_mul_f32 v26, 0x41300000, v11
    v_sin_f32 v34, v26
    v_cos_f32 v30, v26
    v_mul_f32 v26, v36, v28
    v_mul_f32 v35, v37, v28
    v_fmac_f32 v26, v37, v32
    v_fma_f32 v35, -v36, v32, v35
    v_mul_f32 v28, v38, v30
    v_mul_f32 v32, v39, v30
    v_fmac_f32 v28, v39, v34
    v_fma_f32 v32, -v38, v34, v32
    v_add_f32 v30, v16, v22
    v_sub_f32 v22, v16, v22
    v_add_f32 v16, v17, v27
    v_sub_f32 v27, v17, v27
    v_add_f32 v17, v20, v25
    v_sub_f32 v25, v20, v25
    v_add_f32 v20, v44, v33
    v_sub_f32 v33, v44, v33
    v_add_f32 v34, v30, v17
    v_sub_f32 v17, v30, v17
    v_add_f32 v30, v16, v20
    v_sub_f32 v20, v16, v20
    v_add_f32 v16, v22, v33
    v_sub_f32 v36, v27, v25
    v_sub_f32 v37, v22, v33
    v_add_f32 v38, v27, v25
    v_add_f32 v22, v19, v26
    v_sub_f32 v26, v19, v26
    v_add_f32 v19, v41, v35
    v_sub_f32 v35, v41, v35
    v_add_f32 v25, v24, v40
    v_sub_f32 v40, v24, v40
    v_add_f32 v24, v29, v45
    v_sub_f32 v45, v29, v45
    v_add_f32 v27, v22, v25
    v_sub_f32 v25, v22, v25
    v_add_f32 v22, v19, v24
    v_sub_f32 v24, v19, v24
    v_add_f32 v19, v26, v45
    v_sub_f32 v29, v35, v40
    v_sub_f32 v33, v26, v45
    v_add_f32 v39, v35, v40
    v_add_f32 v26, v23, v18
    v_sub_f32 v18, v23, v18
    v_add_f32 v23, v31, v42
    v_sub_f32 v42, v31, v42
    v_add_f32 v31, v28, v21
    v_sub_f32 v21, v28, v21
    v_add_f32 v28, v32, v43
    v_sub_f32 v43, v32, v43
    v_add_f32 v32, v26, v31
    v_sub_f32 v31, v26, v31
    v_add_f32 v26, v23, v28
    v_sub_f32 v28, v23, v28
    v_add_f32 v23, v18, v43
    v_sub_f32 v35, v42, v21
    v_sub_f32 v40, v18, v43
    v_add_f32 v41, v42, v21
    v_add_f32 v18, v27, v32
    v_sub_f32 v32, v27, v32
    v_add_f32 v21, v22, v26
    v_sub_f32 v26, v22, v26
    v_add_f32 v22, v34, v18
    v_fma_f32 v42, -0.5, v18, v34
    v_mul_f32 v32, 0x3f5db3d7, v32
    v_add_f32 v27, v30, v21
    v_fma_f32 v43, -0.5, v21, v30
    v_mul_f32 v26, 0x3f5db3d7, v26
    v_add_f32 v18, v42, v26
    v_sub_f32 v21, v43, v32
    v_sub_f32 v30, v42, v26
    v_add_f32 v34, v43, v32
    v_add_f32 v26, v19, v23
    v_sub_f32 v23, v19, v23
    v_add_f32 v19, v29, v35
    v_sub_f32 v35, v29, v35
    v_add_f32 v29, v16, v26
    v_fma_f32 v42, -0.5, v26, v16
    v_mul_f32 v23, 0x3f5db3d7, v23
    v_add_f32 v32, v36, v19
    v_fma_f32 v43, -0.5, v19, v36
    v_mul_f32 v35, 0x3f5db3d7, v35
    v_add_f32 v16, v42, v35
    v_sub_f32 v19, v43, v23
    v_sub_f32 v26, v42, v35
    v_add_f32 v36, v43, v23
    v_add_f32 v23, v25, v31
    v_sub_f32 v31, v25, v31
    v_add_f32 v25, v24, v28
    v_sub_f32 v28, v24, v28
    v_add_f32 v24, v17, v23
    v_fma_f32 v42, -0.5, v23, v17
    v_mul_f32 v31, 0x3f5db3d7, v31
    v_add_f32 v35, v20, v25
    v_fma_f32 v43, -0.5, v25, v20
    v_mul_f32 v28, 0x3f5db3d7, v28
    v_add_f32 v17, v42, v28
    v_sub_f32 v20, v43, v31
    v_sub_f32 v23, v42, v28
    v_add_f32 v25, v43, v31
    v_add_f32 v28, v33, v40
    v_sub_f32 v40, v33, v40
    v_add_f32 v31, v39, v41
    v_sub_f32 v41, v39, v41
    v_add_f32 v33, v37, v28
    v_fma_f32 v42, -0.5, v28, v37
    v_mul_f32 v40, 0x3f5db3d7, v40
    v_add_f32 v39, v38, v31
    v_fma_f32 v43, -0.5, v31, v38
    v_mul_f32 v41, 0x3f5db3d7, v41
    v_add_f32 v28, v42, v41
    v_sub_f32 v31, v43, v40
    v_sub_f32 v37, v42, v41
    v_add_f32 v38, v43, v40
    ds_write_b32 v10, v22 offset:38912
    ds_write_b32 v10, v27 offset:38916
    ds_write_b32 v10, v16 offset:39008
    ds_write_b32 v10, v19 offset:39012
    ds_write_b32 v10, v23 offset:39104
    ds_write_b32 v10, v25 offset:39108
    ds_write_b32 v10, v33 offset:39200
    ds_write_b32 v10, v39 offset:39204
    ds_write_b32 v10, v18 offset:39296
    ds_write_b32 v10, v21 offset:39300
    ds_write_b32 v10, v26 offset:39392
    ds_write_b32 v10, v36 offset:39396
    ds_write_b32 v10, v24 offset:39488
    ds_write_b32 v10, v35 offset:39492
    ds_write_b32 v10, v28 offset:39584
    ds_write_b32 v10, v31 offset:39588
    ds_write_b32 v10, v30 offset:39680
    ds_write_b32 v10, v34 offset:39684
    ds_write_b32 v10, v29 offset:39776
    ds_write_b32 v10, v32 offset:39780
    ds_write_b32 v10, v17 offset:39872
    ds_write_b32 v10, v20 offset:39876
    ds_write_b32 v10, v37 offset:39968
    ds_write_b32 v10, v38 offset:39972
    s_waitcnt lgkmcnt(0)
    s_barrier
    ds_read_b64 v[16:17], v9 offset:38912
    ds_read_b64 v[18:19], v9 offset:39296
    ds_read_b64 v[20:21], v9 offset:39680
    ds_read_b64 v[22:23], v9 offset:40064
    ds_read_b64 v[24:25], v9 offset:40448
    ds_read_b64 v[26:27], v9 offset:40832
    ds_read_b64 v[28:29], v9 offset:41216
    ds_read_b64 v[30:31], v9 offset:41600
    ds_read_b64 v[32:33], v9 offset:41984
    ds_read_b64 v[34:35], v9 offset:42368
    ds_read_b64 v[36:37], v9 offset:42752
    ds_read_b64 v[38:39], v9 offset:43136
    s_waitcnt lgkmcnt(0)
    v_sin_f32 v42, v12
    v_cos_f32 v41, v12
    v_mul_f32 v40, 0x40000000, v12
    v_sin_f32 v44, v40
    v_cos_f32 v43, v40
    v_mul_f32 v40, v22, v41
    v_mul_f32 v45, v23, v41
    v_fmac_f32 v40, v23, v42
    v_fma_f32 v45, -v22, v42, v45
    v_mul_f32 v22, 0x40400000, v12
    v_sin_f32 v41, v22
    v_cos_f32 v23, v22
    v_mul_f32 v22, v28, v43
    v_mul_f32 v42, v29, v43
    v_fmac_f32 v22, v29, v44
    v_fma_f32 v42, -v28, v44, v42
    v_mul_f32 v28, v34, v23
    v_mul_f32 v29, v35, v23
    v_fmac_f32 v28, v35, v41
    v_fma_f32 v29, -v34, v41, v29
    v_add_f32 v23, v16, v22
    v_sub_f32 v22, v16, v22
    v_add_f32 v16, v17, v42
    v_sub_f32 v42, v17, v42
    v_add_f32 v17, v40, v28
    v_sub_f32 v28, v40, v28
    v_add_f32 v34, v45, v29
    v_sub_f32 v29, v45, v29
    v_add_f32 v35, v23, v17
    v_sub_f32 v17, v23, v17
    v_add_f32 v23, v16, v34
    v_sub_f32 v34, v16, v34
    v_add_f32 v16, v22, v29
    v_sub_f32 v40, v42, v28
    v_sub_f32 v41, v22, v29
    v_add_f32 v43, v42, v28
    v_sin_f32 v29, v13
    v_cos_f32 v28, v13
    v_mul_f32 v22, 0x40000000, v13
    v_sin_f32 v44, v22
    v_cos_f32 v42, v22
    v_mul_f32 v22, v24, v28
    v_mul_f32 v45, v25, v28
    v_fmac_f32 v22, v25, v29
    v_fma_f32 v45, -v24, v29, v45
    v_mul_f32 v24, 0x40400000, v13
    v_sin_f32 v28, v24
    v_cos_f32 v25, v24
    v_mul_f32 v24, v30, v42
    v_mul_f32 v29, v31, v42
    v_fmac_f32 v24, v31, v44
    v_fma_f32 v29, -v30, v44, v29
    v_mul_f32 v30, v36, v25
    v_mul_f32 v31, v37, v25
    v_fmac_f32 v30, v37, v28
    v_fma_f32 v31, -v36, v28, v31
    v_add_f32 v25, v18, v24
    v_sub_f32 v24, v18, v24
    v_add_f32 v18, v19, v29
    v_sub_f32 v29, v19, v29
    v_add_f32 v19, v22, v30
    v_sub_f32 v30, v22, v30
    v_add_f32 v22, v45, v31
    v_sub_f32 v31, v45, v31
    v_add_f32 v28, v25, v19
    v_sub_f32 v19, v25, v19
    v_add_f32 v25, v18, v22
    v_sub_f32 v22, v18, v22
    v_add_f32 v18, v24, v31
    v_sub_f32 v36, v29, v30
    v_sub_f32 v37, v24, v31
    v_add_f32 v42, v29, v30
    v_sin_f32 v30, v14
    v_cos_f32 v29, v14
    v_mul_f32 v24, 0x40000000, v14
    v_sin_f32 v44, v24
    v_cos_f32 v31, v24
    v_mul_f32 v24, v26, v29
    v_mul_f32 v45, v27, v29
    v_fmac_f32 v24, v27, v30
    v_fma_f32 v45, -v26, v30, v45
    v_mul_f32 v26, 0x40400000, v14
    v_sin_f32 v29, v26
    v_cos_f32 v27, v26
    v_mul_f32 v26, v32, v31
    v_mul_f32 v30, v33, v31
    v_fmac_f32 v26, v33, v44
    v_fma_f32 v30, -v32, v44, v30
    v_mul_f32 v31, v38, v27
    v_mul_f32 v32, v39, v27
    v_fmac_f32 v31, v39, v29
    v_fma_f32 v32, -v38, v29, v32
    v_add_f32 v27, v20, v26
    v_sub_f32 v26, v20, v26
    v_add_f32 v20, v21, v30
    v_sub_f32 v30, v21, v30
    v_add_f32 v21, v24, v31
    v_sub_f32 v31, v24, v31
    v_add_f32 v24, v45, v32
    v_sub_f32 v32, v45, v32
    v_add_f32 v29, v27, v21
    v_sub_f32 v21, v27, v21
    v_add_f32 v27, v20, v24
    v_sub_f32 v24, v20, v24
    v_add_f32 v20, v26, v32
    v_sub_f32 v33, v30, v31
    v_sub_f32 v38, v26, v32
    v_add_f32 v39, v30, v31
    v_mul_u32_u24 v26, 2688, v2
    v_lshlrev_b32 v4, 3, v1
    v_add_u32 v26, v26, v4
    ds_write_b32 v26, v17 offset:20224
    ds_write_b32 v26, v34 offset:20228
    ds_write_b32 v26, v19 offset:20608
    ds_write_b32 v26, v22 offset:20612
    ds_write_b32 v26, v21 offset:20992
    ds_write_b32 v26, v24 offset:20996
    ds_write_b32 v26, v41 offset:21376
    ds_write_b32 v26, v43 offset:21380
    ds_write_b32 v26, v37 offset:21760
    ds_write_b32 v26, v42 offset:21764
    ds_write_b32 v26, v38 offset:22144
    ds_write_b32 v26, v39 offset:22148
    ds_write_b32 v26, v35 offset:22528
    ds_write_b32 v26, v23 offset:22532
    s_waitcnt lgkmcnt(0)
    s_barrier
    v_mul_u32_u24 v19, 2688, v2
    v_lshlrev_b32 v4, 3, v1
    v_sub_u32 v19, v19, v4
    v_add_u32 v19, 20224, v19
    ds_read_b64 v[30:31], v19 offset:2304
    ds_read_b64 v[38:39], v19 offset:1920
    ds_read_b64 v[42:43], v19 offset:1536
    ds_read_b64 v[44:45], v19 offset:1152
    ds_read_b64 v[46:47], v19 offset:768
    ds_read_b64 v[48:49], v19 offset:384
    ds_read_b64 v[50:51], v19 offset:0
    v_lshlrev_b32 v21, 14, v1
    v_lshlrev_b32 v4, 4, v2
    v_add_u32 v21, v21, v4
    s_lshl_b32 s21, s20, 3
    v_add_u32 v21, s21, v21
    s_waitcnt lgkmcnt(6)
    v_add_f32 v52, v35, v30
    v_sub_f32 v53, v23, v31
    v_add_f32 v54, v23, v31
    v_sub_f32 v55, v30, v35
    s_mov_b32 s22, 0
    buffer_store_dwordx4 v[52:55], v21, s[16:19], s22 offen
    s_waitcnt lgkmcnt(5)
    v_add_f32 v56, v28, v38
    v_sub_f32 v57, v25, v39
    v_add_f32 v58, v25, v39
    v_sub_f32 v59, v38, v28
    s_mov_b32 s22, 786432
    buffer_store_dwordx4 v[56:59], v21, s[16:19], s22 offen
    s_waitcnt lgkmcnt(4)
    v_add_f32 v60, v29, v42
    v_sub_f32 v61, v27, v43
    v_add_f32 v62, v27, v43
    v_sub_f32 v63, v42, v29
    s_mov_b32 s22, 1572864
    buffer_store_dwordx4 v[60:63], v21, s[16:19], s22 offen
    s_waitcnt lgkmcnt(3)
    v_add_f32 v28, v16, v44
    v_sub_f32 v29, v40, v45
    v_add_f32 v30, v40, v45
    v_sub_f32 v31, v44, v16
    s_mov_b32 s22, 2359296
    buffer_store_dwordx4 v[28:31], v21, s[16:19], s22 offen
    s_waitcnt lgkmcnt(2)
    v_add_f32 v40, v18, v46
    v_sub_f32 v41, v36, v47
    v_add_f32 v42, v36, v47
    v_sub_f32 v43, v46, v18
    s_mov_b32 s22, 3145728
    buffer_store_dwordx4 v[40:43], v21, s[16:19], s22 offen
    s_waitcnt lgkmcnt(1)
    v_add_f32 v36, v20, v48
    v_sub_f32 v37, v33, v49
    v_add_f32 v38, v33, v49
    v_sub_f32 v39, v48, v20
    s_mov_b32 s22, 3932160
    buffer_store_dwordx4 v[36:39], v21, s[16:19], s22 offen
    s_waitcnt lgkmcnt(0)
    v_add_f32 v44, v17, v50
    v_sub_f32 v45, v34, v51
    v_add_f32 v46, v34, v51
    v_sub_f32 v47, v50, v17
    s_mov_b32 s22, 4718592
    buffer_store_dwordx4 v[44:47], v21, s[16:19], s22 offen
K1_END:
    s_endpgm
.globl col_fft_kernel
.p2align 8
.type col_fft_kernel,@function
col_fft_kernel:
    s_cmp_ge_u32 s2, 289
    s_cbranch_scc1 K2_END
    s_load_dwordx2 s[6:7], s[0:1], 80
    s_waitcnt lgkmcnt(0)
    s_add_u32 s8, s6, 3145728
    s_addc_u32 s9, s7, 0
    s_and_b32 s9, s9, 0xffff
    s_mov_b32 s10, 4734976
    s_mov_b32 s11, 0x20000
    s_add_u32 s12, s6, 65536
    s_addc_u32 s13, s7, 0
    s_and_b32 s13, s13, 0xffff
    s_mov_b32 s14, 2367488
    s_mov_b32 s15, 0x20000
    s_lshl_b32 s20, s2, 14
    v_lshlrev_b32 v1, 3, v0
    v_add_u32 v1, s20, v1
    s_mov_b32 s21, 0
    buffer_load_dwordx2 v[24:25], v1, s[8:11], s21 offen
    s_mov_b32 s21, 2048
    buffer_load_dwordx2 v[26:27], v1, s[8:11], s21 offen
    s_mov_b32 s21, 4096
    buffer_load_dwordx2 v[28:29], v1, s[8:11], s21 offen
    s_mov_b32 s21, 6144
    buffer_load_dwordx2 v[30:31], v1, s[8:11], s21 offen
    s_mov_b32 s21, 8192
    buffer_load_dwordx2 v[32:33], v1, s[8:11], s21 offen
    s_mov_b32 s21, 10240
    buffer_load_dwordx2 v[34:35], v1, s[8:11], s21 offen
    s_mov_b32 s21, 12288
    buffer_load_dwordx2 v[36:37], v1, s[8:11], s21 offen
    s_mov_b32 s21, 14336
    buffer_load_dwordx2 v[38:39], v1, s[8:11], s21 offen
    s_lshl_b32 s20, s2, 13
    v_lshlrev_b32 v2, 2, v0
    v_add_u32 v2, s20, v2
    s_mov_b32 s21, 0
    buffer_load_dword v40, v2, s[12:15], s21 offen
    s_mov_b32 s21, 1024
    buffer_load_dword v41, v2, s[12:15], s21 offen
    s_mov_b32 s21, 2048
    buffer_load_dword v42, v2, s[12:15], s21 offen
    s_mov_b32 s21, 3072
    buffer_load_dword v43, v2, s[12:15], s21 offen
    s_mov_b32 s21, 4096
    buffer_load_dword v44, v2, s[12:15], s21 offen
    s_mov_b32 s21, 5120
    buffer_load_dword v45, v2, s[12:15], s21 offen
    s_mov_b32 s21, 6144
    buffer_load_dword v46, v2, s[12:15], s21 offen
    s_mov_b32 s21, 7168
    buffer_load_dword v47, v2, s[12:15], s21 offen
    v_mul_u32_u24 v48, 80, v0
    v_lshrrev_b32 v3, 3, v0
    v_lshlrev_b32 v3, 4, v3
    v_lshl_add_u32 v49, v0, 3, v3
    v_lshrrev_b32 v3, 3, v0
    v_mul_u32_u24 v3, 576, v3
    v_and_b32 v4, 7, v0
    v_lshl_add_u32 v50, v4, 3, v3
    v_lshrrev_b32 v3, 6, v0
    v_lshlrev_b32 v3, 6, v3
    v_lshl_add_u32 v51, v0, 3, v3
    v_lshrrev_b32 v3, 6, v0
    v_lshlrev_b32 v3, 12, v3
    v_and_b32 v4, 63, v0
    v_lshl_add_u32 v52, v4, 3, v3
    v_lshlrev_b32 v53, 3, v0
    v_and_b32 v3, 7, v0
    v_cvt_f32_u32 v3, v3
    v_mul_f32 v54, 0x3c800000, v3
    v_and_b32 v3, 63, v0
    v_cvt_f32_u32 v3, v3
    v_mul_f32 v55, 0x3b000000, v3
    v_cvt_f32_u32 v3, v0
    v_mul_f32 v56, 0x3a000000, v3
    v_add_f32 v3, 0x43800000, v3
    v_mul_f32 v57, 0x3a000000, v3
    s_waitcnt vmcnt(8)
    v_add_f32 v58, v24, v32
    v_sub_f32 v32, v24, v32
    v_add_f32 v24, v25, v33
    v_sub_f32 v33, v25, v33
    v_add_f32 v25, v26, v34
    v_sub_f32 v34, v26, v34
    v_add_f32 v26, v27, v35
    v_sub_f32 v35, v27, v35
    v_add_f32 v27, v28, v36
    v_sub_f32 v36, v28, v36
    v_add_f32 v28, v29, v37
    v_sub_f32 v37, v29, v37
    v_add_f32 v29, v30, v38
    v_sub_f32 v38, v30, v38
    v_add_f32 v30, v31, v39
    v_sub_f32 v39, v31, v39
    v_add_f32 v31, v58, v27
    v_sub_f32 v27, v58, v27
    v_add_f32 v58, v24, v28
    v_sub_f32 v28, v24, v28
    v_add_f32 v24, v25, v29
    v_sub_f32 v29, v25, v29
    v_add_f32 v25, v26, v30
    v_sub_f32 v30, v26, v30
    v_add_f32 v26, v31, v24
    v_sub_f32 v24, v31, v24
    v_add_f32 v31, v58, v25
    v_sub_f32 v25, v58, v25
    v_add_f32 v58, v27, v30
    v_sub_f32 v59, v28, v29
    v_sub_f32 v60, v27, v30
    v_add_f32 v61, v28, v29
    v_add_f32 v27, v34, v35
    v_sub_f32 v28, v35, v34
    v_mul_f32 v27, 0x3f3504f3, v27
    v_mul_f32 v28, 0x3f3504f3, v28
    v_sub_f32 v29, v39, v38
    v_add_f32 v30, v38, v39
    v_mul_f32 v29, 0x3f3504f3, v29
    v_mul_f32 v30, 0xbf3504f3, v30
    v_add_f32 v34, v32, v37
    v_sub_f32 v35, v33, v36
    v_sub_f32 v38, v32, v37
    v_add_f32 v39, v33, v36
    v_add_f32 v32, v27, v29
    v_sub_f32 v29, v27, v29
    v_add_f32 v27, v28, v30
    v_sub_f32 v30, v28, v30
    v_add_f32 v28, v34, v32
    v_sub_f32 v32, v34, v32
    v_add_f32 v33, v35, v27
    v_sub_f32 v27, v35, v27
    v_add_f32 v34, v38, v30
    v_sub_f32 v35, v39, v29
    v_sub_f32 v36, v38, v30
    v_add_f32 v37, v39, v29
    ds_write_b32 v48, v26 offset:0
    ds_write_b32 v48, v31 offset:4
    ds_write_b32 v48, v28 offset:8
    ds_write_b32 v48, v33 offset:12
    ds_write_b32 v48, v58 offset:16
    ds_write_b32 v48, v59 offset:20
    ds_write_b32 v48, v34 offset:24
    ds_write_b32 v48, v35 offset:28
    ds_write_b32 v48, v24 offset:32
    ds_write_b32 v48, v25 offset:36
    ds_write_b32 v48, v32 offset:40
    ds_write_b32 v48, v27 offset:44
    ds_write_b32 v48, v60 offset:48
    ds_write_b32 v48, v61 offset:52
    ds_write_b32 v48, v36 offset:56
    ds_write_b32 v48, v37 offset:60
    s_waitcnt lgkmcnt(0)
    s_barrier
    ds_read_b64 v[24:25], v49 offset:0
    ds_read_b64 v[26:27], v49 offset:2560
    ds_read_b64 v[28:29], v49 offset:5120
    ds_read_b64 v[30:31], v49 offset:7680
    ds_read_b64 v[32:33], v49 offset:10240
    ds_read_b64 v[34:35], v49 offset:12800
    ds_read_b64 v[36:37], v49 offset:15360
    ds_read_b64 v[38:39], v49 offset:17920
    s_waitcnt lgkmcnt(0)
    v_sin_f32 v60, v54
    v_cos_f32 v59, v54
    v_mul_f32 v58, 0x40000000, v54
    v_sin_f32 v62, v58
    v_cos_f32 v61, v58
    v_mul_f32 v58, v26, v59
    v_mul_f32 v63, v27, v59
    v_fmac_f32 v58, v27, v60
    v_fma_f32 v63, -v26, v60, v63
    v_mul_f32 v26, 0x40400000, v54
    v_sin_f32 v59, v26
    v_cos_f32 v27, v26
    v_mul_f32 v26, v28, v61
    v_mul_f32 v60, v29, v61
    v_fmac_f32 v26, v29, v62
    v_fma_f32 v60, -v28, v62, v60
    v_mul_f32 v28, 0x40800000, v54
    v_sin_f32 v61, v28
    v_cos_f32 v29, v28
    v_mul_f32 v28, v30, v27
    v_mul_f32 v62, v31, v27
    v_fmac_f32 v28, v31, v59
    v_fma_f32 v62, -v30, v59, v62
    v_mul_f32 v27, 0x40a00000, v54
    v_sin_f32 v31, v27
    v_cos_f32 v30, v27
    v_mul_f32 v27, v32, v29
    v_mul_f32 v59, v33, v29
    v_fmac_f32 v27, v33, v61
    v_fma_f32 v59, -v32, v61, v59
    v_mul_f32 v29, 0x40c00000, v54
    v_sin_f32 v33, v29
    v_cos_f32 v32, v29
    v_mul_f32 v29, v34, v30
    v_mul_f32 v61, v35, v30
    v_fmac_f32 v29, v35, v31
    v_fma_f32 v61, -v34, v31, v61
    v_mul_f32 v30, 0x40e00000, v54
    v_sin_f32 v34, v30
    v_cos_f32 v31, v30
    v_mul_f32 v30, v36, v32
    v_mul_f32 v35, v37, v32
    v_fmac_f32 v30, v37, v33
    v_fma_f32 v35, -v36, v33, v35
    v_mul_f32 v32, v38, v31
    v_mul_f32 v33, v39, v31
    v_fmac_f32 v32, v39, v34
    v_fma_f32 v33, -v38, v34, v33
    v_add_f32 v31, v24, v27
    v_sub_f32 v27, v24, v27
    v_add_f32 v24, v25, v59
    v_sub_f32 v59, v25, v59
    v_add_f32 v25, v58, v29
    v_sub_f32 v29, v58, v29
    v_add_f32 v34, v63, v61
    v_sub_f32 v61, v63, v61
    v_add_f32 v36, v26, v30
    v_sub_f32 v30, v26, v30
    v_add_f32 v26, v60, v35
    v_sub_f32 v35, v60, v35
    v_add_f32 v37, v28, v32
    v_sub_f32 v32, v28, v32
    v_add_f32 v28, v62, v33
    v_sub_f32 v33, v62, v33
    v_add_f32 v38, v31, v36
    v_sub_f32 v36, v31, v36
    v_add_f32 v31, v24, v26
    v_sub_f32 v26, v24, v26
    v_add_f32 v24, v25, v37
    v_sub_f32 v37, v25, v37
    v_add_f32 v25, v34, v28
    v_sub_f32 v28, v34, v28
    v_add_f32 v34, v38, v24
    v_sub_f32 v24, v38, v24
    v_add_f32 v38, v31, v25
    v_sub_f32 v25, v31, v25
    v_add_f32 v31, v36, v28
    v_sub_f32 v39, v26, v37
    v_sub_f32 v58, v36, v28
    v_add_f32 v60, v26, v37
    v_add_f32 v26, v29, v61
    v_sub_f32 v28, v61, v29
    v_mul_f32 v26, 0x3f3504f3, v26
    v_mul_f32 v28, 0x3f3504f3, v28
    v_sub_f32 v29, v33, v32
    v_add_f32 v36, v32, v33
    v_mul_f32 v29, 0x3f3504f3, v29
    v_mul_f32 v36, 0xbf3504f3, v36
    v_add_f32 v32, v27, v35
    v_sub_f32 v33, v59, v30
    v_sub_f32 v37, v27, v35
    v_add_f32 v61, v59, v30
    v_add_f32 v27, v26, v29
    v_sub_f32 v29, v26, v29
    v_add_f32 v26, v28, v36
    v_sub_f32 v36, v28, v36
    v_add_f32 v28, v32, v27
    v_sub_f32 v27, v32, v27
    v_add_f32 v30, v33, v26
    v_sub_f32 v26, v33, v26
    v_add_f32 v32, v37, v36
    v_sub_f32 v33, v61, v29
    v_sub_f32 v35, v37, v36
    v_add_f32 v59, v61, v29
    ds_write_b32 v50, v34 offset:20480
    ds_write_b32 v50, v38 offset:20484
    ds_write_b32 v50, v28 offset:20544
    ds_write_b32 v50, v30 offset:20548
    ds_write_b32 v50, v31 offset:20608
    ds_write_b32 v50, v39 offset:20612
    ds_write_b32 v50, v32 offset:20672
    ds_write_b32 v50, v33 offset:20676
    ds_write_b32 v50, v24 offset:20736
    ds_write_b32 v50, v25 offset:20740
    ds_write_b32 v50, v27 offset:20800
    ds_write_b32 v50, v26 offset:20804
    ds_write_b32 v50, v58 offset:20864
    ds_write_b32 v50, v60 offset:20868
    ds_write_b32 v50, v35 offset:20928
    ds_write_b32 v50, v59 offset:20932
    s_waitcnt lgkmcnt(0)
    s_barrier
    ds_read_b64 v[24:25], v51 offset:20480
    ds_read_b64 v[26:27], v51 offset:22784
    ds_read_b64 v[28:29], v51 offset:25088
    ds_read_b64 v[30:31], v51 offset:27392
    ds_read_b64 v[32:33], v51 offset:29696
    ds_read_b64 v[34:35], v51 offset:32000
    ds_read_b64 v[36:37], v51 offset:34304
    ds_read_b64 v[38:39], v51 offset:36608
    s_waitcnt lgkmcnt(0)
    v_sin_f32 v60, v55
    v_cos_f32 v59, v55
    v_mul_f32 v58, 0x40000000, v55
    v_sin_f32 v62, v58
    v_cos_f32 v61, v58
    v_mul_f32 v58, v26, v59
    v_mul_f32 v63, v27, v59
    v_fmac_f32 v58, v27, v60
    v_fma_f32 v63, -v26, v60, v63
    v_mul_f32 v26, 0x40400000, v55
    v_sin_f32 v59, v26
    v_cos_f32 v27, v26
    v_mul_f32 v26, v28, v61
    v_mul_f32 v60, v29, v61
    v_fmac_f32 v26, v29, v62
    v_fma_f32 v60, -v28, v62, v60
    v_mul_f32 v28, 0x40800000, v55
    v_sin_f32 v61, v28
    v_cos_f32 v29, v28
    v_mul_f32 v28, v30, v27
    v_mul_f32 v62, v31, v27
    v_fmac_f32 v28, v31, v59
    v_fma_f32 v62, -v30, v59, v62
    v_mul_f32 v27, 0x40a00000, v55
    v_sin_f32 v31, v27
    v_cos_f32 v30, v27
    v_mul_f32 v27, v32, v29
    v_mul_f32 v59, v33, v29
    v_fmac_f32 v27, v33, v61
    v_fma_f32 v59, -v32, v61, v59
    v_mul_f32 v29, 0x40c00000, v55
    v_sin_f32 v33, v29
    v_cos_f32 v32, v29
    v_mul_f32 v29, v34, v30
    v_mul_f32 v61, v35, v30
    v_fmac_f32 v29, v35, v31
    v_fma_f32 v61, -v34, v31, v61
    v_mul_f32 v30, 0x40e00000, v55
    v_sin_f32 v34, v30
    v_cos_f32 v31, v30
    v_mul_f32 v30, v36, v32
    v_mul_f32 v35, v37, v32
    v_fmac_f32 v30, v37, v33
    v_fma_f32 v35, -v36, v33, v35
    v_mul_f32 v32, v38, v31
    v_mul_f32 v33, v39, v31
    v_fmac_f32 v32, v39, v34
    v_fma_f32 v33, -v38, v34, v33
    v_add_f32 v31, v24, v27
    v_sub_f32 v27, v24, v27
    v_add_f32 v24, v25, v59
    v_sub_f32 v59, v25, v59
    v_add_f32 v25, v58, v29
    v_sub_f32 v29, v58, v29
    v_add_f32 v34, v63, v61
    v_sub_f32 v61, v63, v61
    v_add_f32 v36, v26, v30
    v_sub_f32 v30, v26, v30
    v_add_f32 v26, v60, v35
    v_sub_f32 v35, v60, v35
    v_add_f32 v37, v28, v32
    v_sub_f32 v32, v28, v32
    v_add_f32 v28, v62, v33
    v_sub_f32 v33, v62, v33
    v_add_f32 v38, v31, v36
    v_sub_f32 v36, v31, v36
    v_add_f32 v31, v24, v26
    v_sub_f32 v26, v24, v26
    v_add_f32 v24, v25, v37
    v_sub_f32 v37, v25, v37
    v_add_f32 v25, v34, v28
    v_sub_f32 v28, v34, v28
    v_add_f32 v34, v38, v24
    v_sub_f32 v24, v38, v24
    v_add_f32 v38, v31, v25
    v_sub_f32 v25, v31, v25
    v_add_f32 v31, v36, v28
    v_sub_f32 v39, v26, v37
    v_sub_f32 v58, v36, v28
    v_add_f32 v60, v26, v37
    v_add_f32 v26, v29, v61
    v_sub_f32 v28, v61, v29
    v_mul_f32 v26, 0x3f3504f3, v26
    v_mul_f32 v28, 0x3f3504f3, v28
    v_sub_f32 v29, v33, v32
    v_add_f32 v36, v32, v33
    v_mul_f32 v29, 0x3f3504f3, v29
    v_mul_f32 v36, 0xbf3504f3, v36
    v_add_f32 v32, v27, v35
    v_sub_f32 v33, v59, v30
    v_sub_f32 v37, v27, v35
    v_add_f32 v61, v59, v30
    v_add_f32 v27, v26, v29
    v_sub_f32 v29, v26, v29
    v_add_f32 v26, v28, v36
    v_sub_f32 v36, v28, v36
    v_add_f32 v28, v32, v27
    v_sub_f32 v27, v32, v27
    v_add_f32 v30, v33, v26
    v_sub_f32 v26, v33, v26
    v_add_f32 v32, v37, v36
    v_sub_f32 v33, v61, v29
    v_sub_f32 v35, v37, v36
    v_add_f32 v59, v61, v29
    ds_write_b32 v52, v34 offset:0
    ds_write_b32 v52, v38 offset:4
    ds_write_b32 v52, v28 offset:512
    ds_write_b32 v52, v30 offset:516
    ds_write_b32 v52, v31 offset:1024
    ds_write_b32 v52, v39 offset:1028
    ds_write_b32 v52, v32 offset:1536
    ds_write_b32 v52, v33 offset:1540
    ds_write_b32 v52, v24 offset:2048
    ds_write_b32 v52, v25 offset:2052
    ds_write_b32 v52, v27 offset:2560
    ds_write_b32 v52, v26 offset:2564
    ds_write_b32 v52, v58 offset:3072
    ds_write_b32 v52, v60 offset:3076
    ds_write_b32 v52, v35 offset:3584
    ds_write_b32 v52, v59 offset:3588
    s_waitcnt lgkmcnt(0)
    s_barrier
    ds_read_b64 v[24:25], v53 offset:0
    ds_read_b64 v[26:27], v53 offset:2048
    ds_read_b64 v[28:29], v53 offset:4096
    ds_read_b64 v[30:31], v53 offset:6144
    ds_read_b64 v[32:33], v53 offset:8192
    ds_read_b64 v[34:35], v53 offset:10240
    ds_read_b64 v[36:37], v53 offset:12288
    ds_read_b64 v[38:39], v53 offset:14336
    s_waitcnt lgkmcnt(0)
    v_sin_f32 v60, v56
    v_cos_f32 v59, v56
    v_mul_f32 v58, 0x40000000, v56
    v_sin_f32 v62, v58
    v_cos_f32 v61, v58
    v_mul_f32 v58, v28, v59
    v_mul_f32 v63, v29, v59
    v_fmac_f32 v58, v29, v60
    v_fma_f32 v63, -v28, v60, v63
    v_mul_f32 v28, 0x40400000, v56
    v_sin_f32 v59, v28
    v_cos_f32 v29, v28
    v_mul_f32 v28, v32, v61
    v_mul_f32 v60, v33, v61
    v_fmac_f32 v28, v33, v62
    v_fma_f32 v60, -v32, v62, v60
    v_mul_f32 v32, v36, v29
    v_mul_f32 v33, v37, v29
    v_fmac_f32 v32, v37, v59
    v_fma_f32 v33, -v36, v59, v33
    v_add_f32 v29, v24, v28
    v_sub_f32 v28, v24, v28
    v_add_f32 v24, v25, v60
    v_sub_f32 v60, v25, v60
    v_add_f32 v25, v58, v32
    v_sub_f32 v32, v58, v32
    v_add_f32 v36, v63, v33
    v_sub_f32 v33, v63, v33
    v_add_f32 v37, v29, v25
    v_sub_f32 v25, v29, v25
    v_add_f32 v29, v24, v36
    v_sub_f32 v36, v24, v36
    v_add_f32 v24, v28, v33
    v_sub_f32 v58, v60, v32
    v_sub_f32 v59, v28, v33
    v_add_f32 v61, v60, v32
    v_sin_f32 v33, v57
    v_cos_f32 v32, v57
    v_mul_f32 v28, 0x40000000, v57
    v_sin_f32 v62, v28
    v_cos_f32 v60, v28
    v_mul_f32 v28, v30, v32
    v_mul_f32 v63, v31, v32
    v_fmac_f32 v28, v31, v33
    v_fma_f32 v63, -v30, v33, v63
    v_mul_f32 v30, 0x40400000, v57
    v_sin_f32 v32, v30
    v_cos_f32 v31, v30
    v_mul_f32 v30, v34, v60
    v_mul_f32 v33, v35, v60
    v_fmac_f32 v30, v35, v62
    v_fma_f32 v33, -v34, v62, v33
    v_mul_f32 v34, v38, v31
    v_mul_f32 v35, v39, v31
    v_fmac_f32 v34, v39, v32
    v_fma_f32 v35, -v38, v32, v35
    v_add_f32 v31, v26, v30
    v_sub_f32 v30, v26, v30
    v_add_f32 v26, v27, v33
    v_sub_f32 v33, v27, v33
    v_add_f32 v27, v28, v34
    v_sub_f32 v34, v28, v34
    v_add_f32 v28, v63, v35
    v_sub_f32 v35, v63, v35
    v_add_f32 v32, v31, v27
    v_sub_f32 v27, v31, v27
    v_add_f32 v31, v26, v28
    v_sub_f32 v28, v26, v28
    v_add_f32 v26, v30, v35
    v_sub_f32 v38, v33, v34
    v_sub_f32 v39, v30, v35
    v_add_f32 v60, v33, v34
    s_waitcnt vmcnt(0)
    v_lshlrev_b32 v30, 16, v40
    v_and_b32 v33, 0xffff0000, v40
    v_mul_f32 v34, v37, v30
    v_mul_f32 v35, v37, v33
    v_fma_f32 v34, -v29, v33, v34
    v_fmac_f32 v35, v29, v30
    v_lshlrev_b32 v29, 16, v41
    v_and_b32 v30, 0xffff0000, v41
    v_mul_f32 v33, v32, v29
    v_mul_f32 v37, v32, v30
    v_fma_f32 v33, -v31, v30, v33
    v_fmac_f32 v37, v31, v29
    v_lshlrev_b32 v29, 16, v42
    v_and_b32 v30, 0xffff0000, v42
    v_mul_f32 v31, v24, v29
    v_mul_f32 v32, v24, v30
    v_fma_f32 v31, -v58, v30, v31
    v_fmac_f32 v32, v58, v29
    v_lshlrev_b32 v24, 16, v43
    v_and_b32 v29, 0xffff0000, v43
    v_mul_f32 v30, v26, v24
    v_mul_f32 v40, v26, v29
    v_fma_f32 v30, -v38, v29, v30
    v_fmac_f32 v40, v38, v24
    v_lshlrev_b32 v24, 16, v44
    v_and_b32 v26, 0xffff0000, v44
    v_mul_f32 v29, v25, v24
    v_mul_f32 v38, v25, v26
    v_fma_f32 v29, -v36, v26, v29
    v_fmac_f32 v38, v36, v24
    v_lshlrev_b32 v24, 16, v45
    v_and_b32 v25, 0xffff0000, v45
    v_mul_f32 v26, v27, v24
    v_mul_f32 v36, v27, v25
    v_fma_f32 v26, -v28, v25, v26
    v_fmac_f32 v36, v28, v24
    v_lshlrev_b32 v24, 16, v46
    v_and_b32 v25, 0xffff0000, v46
    v_mul_f32 v27, v59, v24
    v_mul_f32 v28, v59, v25
    v_fma_f32 v27, -v61, v25, v27
    v_fmac_f32 v28, v61, v24
    v_lshlrev_b32 v24, 16, v47
    v_and_b32 v25, 0xffff0000, v47
    v_mul_f32 v41, v39, v24
    v_mul_f32 v42, v39, v25
    v_fma_f32 v41, -v60, v25, v41
    v_fmac_f32 v42, v60, v24
    v_add_f32 v24, v34, v29
    v_sub_f32 v29, v34, v29
    v_add_f32 v25, v35, v38
    v_sub_f32 v38, v35, v38
    v_add_f32 v34, v33, v26
    v_sub_f32 v26, v33, v26
    v_add_f32 v33, v37, v36
    v_sub_f32 v36, v37, v36
    v_add_f32 v35, v31, v27
    v_sub_f32 v27, v31, v27
    v_add_f32 v31, v32, v28
    v_sub_f32 v28, v32, v28
    v_add_f32 v32, v30, v41
    v_sub_f32 v41, v30, v41
    v_add_f32 v30, v40, v42
    v_sub_f32 v42, v40, v42
    v_add_f32 v37, v24, v35
    v_sub_f32 v35, v24, v35
    v_add_f32 v24, v25, v31
    v_sub_f32 v31, v25, v31
    v_add_f32 v25, v34, v32
    v_sub_f32 v32, v34, v32
    v_add_f32 v34, v33, v30
    v_sub_f32 v30, v33, v30
    v_add_f32 v33, v37, v25
    v_sub_f32 v25, v37, v25
    v_add_f32 v37, v24, v34
    v_sub_f32 v34, v24, v34
    v_add_f32 v24, v35, v30
    v_sub_f32 v39, v31, v32
    v_sub_f32 v40, v35, v30
    v_add_f32 v43, v31, v32
    v_sub_f32 v30, v26, v36
    v_add_f32 v31, v26, v36
    v_mul_f32 v30, 0x3f3504f3, v30
    v_mul_f32 v31, 0x3f3504f3, v31
    v_add_f32 v26, v41, v42
    v_sub_f32 v32, v41, v42
    v_mul_f32 v26, 0xbf3504f3, v26
    v_mul_f32 v32, 0x3f3504f3, v32
    v_add_f32 v35, v29, v28
    v_sub_f32 v36, v38, v27
    v_sub_f32 v41, v29, v28
    v_add_f32 v42, v38, v27
    v_add_f32 v27, v30, v26
    v_sub_f32 v26, v30, v26
    v_add_f32 v28, v31, v32
    v_sub_f32 v32, v31, v32
    v_add_f32 v29, v41, v27
    v_sub_f32 v27, v41, v27
    v_add_f32 v30, v42, v28
    v_sub_f32 v28, v42, v28
    v_add_f32 v31, v35, v32
    v_sub_f32 v38, v36, v26
    v_sub_f32 v41, v35, v32
    v_add_f32 v42, v36, v26
    ds_write_b32 v48, v33 offset:20480
    ds_write_b32 v48, v37 offset:20484
    ds_write_b32 v48, v29 offset:20488
    ds_write_b32 v48, v30 offset:20492
    ds_write_b32 v48, v40 offset:20496
    ds_write_b32 v48, v43 offset:20500
    ds_write_b32 v48, v41 offset:20504
    ds_write_b32 v48, v42 offset:20508
    ds_write_b32 v48, v25 offset:20512
    ds_write_b32 v48, v34 offset:20516
    ds_write_b32 v48, v27 offset:20520
    ds_write_b32 v48, v28 offset:20524
    ds_write_b32 v48, v24 offset:20528
    ds_write_b32 v48, v39 offset:20532
    ds_write_b32 v48, v31 offset:20536
    ds_write_b32 v48, v38 offset:20540
    s_waitcnt lgkmcnt(0)
    s_barrier
    ds_read_b64 v[24:25], v49 offset:20480
    ds_read_b64 v[26:27], v49 offset:23040
    ds_read_b64 v[28:29], v49 offset:25600
    ds_read_b64 v[30:31], v49 offset:28160
    ds_read_b64 v[32:33], v49 offset:30720
    ds_read_b64 v[34:35], v49 offset:33280
    ds_read_b64 v[36:37], v49 offset:35840
    ds_read_b64 v[38:39], v49 offset:38400
    s_waitcnt lgkmcnt(0)
    v_sin_f32 v42, v54
    v_cos_f32 v41, v54
    v_mul_f32 v40, 0x40000000, v54
    v_sin_f32 v44, v40
    v_cos_f32 v43, v40
    v_mul_f32 v40, v26, v41
    v_mul_f32 v45, v27, v41
    v_fma_f32 v40, -v27, v42, v40
    v_fmac_f32 v45, v26, v42
    v_mul_f32 v26, 0x40400000, v54
    v_sin_f32 v41, v26
    v_cos_f32 v27, v26
    v_mul_f32 v26, v28, v43
    v_mul_f32 v42, v29, v43
    v_fma_f32 v26, -v29, v44, v26
    v_fmac_f32 v42, v28, v44
    v_mul_f32 v28, 0x40800000, v54
    v_sin_f32 v43, v28
    v_cos_f32 v29, v28
    v_mul_f32 v28, v30, v27
    v_mul_f32 v44, v31, v27
    v_fma_f32 v28, -v31, v41, v28
    v_fmac_f32 v44, v30, v41
    v_mul_f32 v27, 0x40a00000, v54
    v_sin_f32 v31, v27
    v_cos_f32 v30, v27
    v_mul_f32 v27, v32, v29
    v_mul_f32 v41, v33, v29
    v_fma_f32 v27, -v33, v43, v27
    v_fmac_f32 v41, v32, v43
    v_mul_f32 v29, 0x40c00000, v54
    v_sin_f32 v33, v29
    v_cos_f32 v32, v29
    v_mul_f32 v29, v34, v30
    v_mul_f32 v43, v35, v30
    v_fma_f32 v29, -v35, v31, v29
    v_fmac_f32 v43, v34, v31
    v_mul_f32 v30, 0x40e00000, v54
    v_sin_f32 v34, v30
    v_cos_f32 v31, v30
    v_mul_f32 v30, v36, v32
    v_mul_f32 v35, v37, v32
    v_fma_f32 v30, -v37, v33, v30
    v_fmac_f32 v35, v36, v33
    v_mul_f32 v32, v38, v31
    v_mul_f32 v33, v39, v31
    v_fma_f32 v32, -v39, v34, v32
    v_fmac_f32 v33, v38, v34
    v_add_f32 v31, v24, v27
    v_sub_f32 v27, v24, v27
    v_add_f32 v24, v25, v41
    v_sub_f32 v41, v25, v41
    v_add_f32 v25, v40, v29
    v_sub_f32 v29, v40, v29
    v_add_f32 v34, v45, v43
    v_sub_f32 v43, v45, v43
    v_add_f32 v36, v26, v30
    v_sub_f32 v30, v26, v30
    v_add_f32 v26, v42, v35
    v_sub_f32 v35, v42, v35
    v_add_f32 v37, v28, v32
    v_sub_f32 v32, v28, v32
    v_add_f32 v28, v44, v33
    v_sub_f32 v33, v44, v33
    v_add_f32 v38, v31, v36
    v_sub_f32 v36, v31, v36
    v_add_f32 v31, v24, v26
    v_sub_f32 v26, v24, v26
    v_add_f32 v24, v25, v37
    v_sub_f32 v37, v25, v37
    v_add_f32 v25, v34, v28
    v_sub_f32 v28, v34, v28
    v_add_f32 v34, v38, v24
    v_sub_f32 v24, v38, v24
    v_add_f32 v38, v31, v25
    v_sub_f32 v25, v31, v25
    v_add_f32 v31, v36, v28
    v_sub_f32 v39, v26, v37
    v_sub_f32 v40, v36, v28
    v_add_f32 v42, v26, v37
    v_sub_f32 v26, v29, v43
    v_add_f32 v28, v29, v43
    v_mul_f32 v26, 0x3f3504f3, v26
    v_mul_f32 v28, 0x3f3504f3, v28
    v_add_f32 v29, v32, v33
    v_sub_f32 v36, v32, v33
    v_mul_f32 v29, 0xbf3504f3, v29
    v_mul_f32 v36, 0x3f3504f3, v36
    v_add_f32 v32, v27, v35
    v_sub_f32 v33, v41, v30
    v_sub_f32 v37, v27, v35
    v_add_f32 v43, v41, v30
    v_add_f32 v27, v26, v29
    v_sub_f32 v29, v26, v29
    v_add_f32 v26, v28, v36
    v_sub_f32 v36, v28, v36
    v_add_f32 v28, v37, v27
    v_sub_f32 v27, v37, v27
    v_add_f32 v30, v43, v26
    v_sub_f32 v26, v43, v26
    v_add_f32 v35, v32, v36
    v_sub_f32 v37, v33, v29
    v_sub_f32 v41, v32, v36
    v_add_f32 v43, v33, v29
    ds_write_b32 v50, v34 offset:0
    ds_write_b32 v50, v38 offset:4
    ds_write_b32 v50, v28 offset:64
    ds_write_b32 v50, v30 offset:68
    ds_write_b32 v50, v40 offset:128
    ds_write_b32 v50, v42 offset:132
    ds_write_b32 v50, v41 offset:192
    ds_write_b32 v50, v43 offset:196
    ds_write_b32 v50, v24 offset:256
    ds_write_b32 v50, v25 offset:260
    ds_write_b32 v50, v27 offset:320
    ds_write_b32 v50, v26 offset:324
    ds_write_b32 v50, v31 offset:384
    ds_write_b32 v50, v39 offset:388
    ds_write_b32 v50, v35 offset:448
    ds_write_b32 v50, v37 offset:452
    s_waitcnt lgkmcnt(0)
    s_barrier
    ds_read_b64 v[24:25], v51 offset:0
    ds_read_b64 v[26:27], v51 offset:2304
    ds_read_b64 v[28:29], v51 offset:4608
    ds_read_b64 v[30:31], v51 offset:6912
    ds_read_b64 v[32:33], v51 offset:9216
    ds_read_b64 v[34:35], v51 offset:11520
    ds_read_b64 v[36:37], v51 offset:13824
    ds_read_b64 v[38:39], v51 offset:16128
    s_waitcnt lgkmcnt(0)
    v_sin_f32 v42, v55
    v_cos_f32 v41, v55
    v_mul_f32 v40, 0x40000000, v55
    v_sin_f32 v44, v40
    v_cos_f32 v43, v40
    v_mul_f32 v40, v26, v41
    v_mul_f32 v45, v27, v41
    v_fma_f32 v40, -v27, v42, v40
    v_fmac_f32 v45, v26, v42
    v_mul_f32 v26, 0x40400000, v55
    v_sin_f32 v41, v26
    v_cos_f32 v27, v26
    v_mul_f32 v26, v28, v43
    v_mul_f32 v42, v29, v43
    v_fma_f32 v26, -v29, v44, v26
    v_fmac_f32 v42, v28, v44
    v_mul_f32 v28, 0x40800000, v55
    v_sin_f32 v43, v28
    v_cos_f32 v29, v28
    v_mul_f32 v28, v30, v27
    v_mul_f32 v44, v31, v27
    v_fma_f32 v28, -v31, v41, v28
    v_fmac_f32 v44, v30, v41
    v_mul_f32 v27, 0x40a00000, v55
    v_sin_f32 v31, v27
    v_cos_f32 v30, v27
    v_mul_f32 v27, v32, v29
    v_mul_f32 v41, v33, v29
    v_fma_f32 v27, -v33, v43, v27
    v_fmac_f32 v41, v32, v43
    v_mul_f32 v29, 0x40c00000, v55
    v_sin_f32 v33, v29
    v_cos_f32 v32, v29
    v_mul_f32 v29, v34, v30
    v_mul_f32 v43, v35, v30
    v_fma_f32 v29, -v35, v31, v29
    v_fmac_f32 v43, v34, v31
    v_mul_f32 v30, 0x40e00000, v55
    v_sin_f32 v34, v30
    v_cos_f32 v31, v30
    v_mul_f32 v30, v36, v32
    v_mul_f32 v35, v37, v32
    v_fma_f32 v30, -v37, v33, v30
    v_fmac_f32 v35, v36, v33
    v_mul_f32 v32, v38, v31
    v_mul_f32 v33, v39, v31
    v_fma_f32 v32, -v39, v34, v32
    v_fmac_f32 v33, v38, v34
    v_add_f32 v31, v24, v27
    v_sub_f32 v27, v24, v27
    v_add_f32 v24, v25, v41
    v_sub_f32 v41, v25, v41
    v_add_f32 v25, v40, v29
    v_sub_f32 v29, v40, v29
    v_add_f32 v34, v45, v43
    v_sub_f32 v43, v45, v43
    v_add_f32 v36, v26, v30
    v_sub_f32 v30, v26, v30
    v_add_f32 v26, v42, v35
    v_sub_f32 v35, v42, v35
    v_add_f32 v37, v28, v32
    v_sub_f32 v32, v28, v32
    v_add_f32 v28, v44, v33
    v_sub_f32 v33, v44, v33
    v_add_f32 v38, v31, v36
    v_sub_f32 v36, v31, v36
    v_add_f32 v31, v24, v26
    v_sub_f32 v26, v24, v26
    v_add_f32 v24, v25, v37
    v_sub_f32 v37, v25, v37
    v_add_f32 v25, v34, v28
    v_sub_f32 v28, v34, v28
    v_add_f32 v34, v38, v24
    v_sub_f32 v24, v38, v24
    v_add_f32 v38, v31, v25
    v_sub_f32 v25, v31, v25
    v_add_f32 v31, v36, v28
    v_sub_f32 v39, v26, v37
    v_sub_f32 v40, v36, v28
    v_add_f32 v42, v26, v37
    v_sub_f32 v26, v29, v43
    v_add_f32 v28, v29, v43
    v_mul_f32 v26, 0x3f3504f3, v26
    v_mul_f32 v28, 0x3f3504f3, v28
    v_add_f32 v29, v32, v33
    v_sub_f32 v36, v32, v33
    v_mul_f32 v29, 0xbf3504f3, v29
    v_mul_f32 v36, 0x3f3504f3, v36
    v_add_f32 v32, v27, v35
    v_sub_f32 v33, v41, v30
    v_sub_f32 v37, v27, v35
    v_add_f32 v43, v41, v30
    v_add_f32 v27, v26, v29
    v_sub_f32 v29, v26, v29
    v_add_f32 v26, v28, v36
    v_sub_f32 v36, v28, v36
    v_add_f32 v28, v37, v27
    v_sub_f32 v27, v37, v27
    v_add_f32 v30, v43, v26
    v_sub_f32 v26, v43, v26
    v_add_f32 v35, v32, v36
    v_sub_f32 v37, v33, v29
    v_sub_f32 v41, v32, v36
    v_add_f32 v43, v33, v29
    ds_write_b32 v52, v34 offset:20480
    ds_write_b32 v52, v38 offset:20484
    ds_write_b32 v52, v28 offset:20992
    ds_write_b32 v52, v30 offset:20996
    ds_write_b32 v52, v40 offset:21504
    ds_write_b32 v52, v42 offset:21508
    ds_write_b32 v52, v41 offset:22016
    ds_write_b32 v52, v43 offset:22020
    ds_write_b32 v52, v24 offset:22528
    ds_write_b32 v52, v25 offset:22532
    ds_write_b32 v52, v27 offset:23040
    ds_write_b32 v52, v26 offset:23044
    ds_write_b32 v52, v31 offset:23552
    ds_write_b32 v52, v39 offset:23556
    ds_write_b32 v52, v35 offset:24064
    ds_write_b32 v52, v37 offset:24068
    s_waitcnt lgkmcnt(0)
    s_barrier
    ds_read_b64 v[24:25], v53 offset:20480
    ds_read_b64 v[26:27], v53 offset:22528
    ds_read_b64 v[28:29], v53 offset:24576
    ds_read_b64 v[30:31], v53 offset:26624
    ds_read_b64 v[32:33], v53 offset:28672
    ds_read_b64 v[34:35], v53 offset:30720
    ds_read_b64 v[36:37], v53 offset:32768
    ds_read_b64 v[38:39], v53 offset:34816
    s_waitcnt lgkmcnt(0)
    v_sin_f32 v42, v56
    v_cos_f32 v41, v56
    v_mul_f32 v40, 0x40000000, v56
    v_sin_f32 v44, v40
    v_cos_f32 v43, v40
    v_mul_f32 v40, v28, v41
    v_mul_f32 v45, v29, v41
    v_fma_f32 v40, -v29, v42, v40
    v_fmac_f32 v45, v28, v42
    v_mul_f32 v28, 0x40400000, v56
    v_sin_f32 v41, v28
    v_cos_f32 v29, v28
    v_mul_f32 v28, v32, v43
    v_mul_f32 v42, v33, v43
    v_fma_f32 v28, -v33, v44, v28
    v_fmac_f32 v42, v32, v44
    v_mul_f32 v32, v36, v29
    v_mul_f32 v33, v37, v29
    v_fma_f32 v32, -v37, v41, v32
    v_fmac_f32 v33, v36, v41
    v_add_f32 v29, v24, v28
    v_sub_f32 v28, v24, v28
    v_add_f32 v24, v25, v42
    v_sub_f32 v42, v25, v42
    v_add_f32 v25, v40, v32
    v_sub_f32 v32, v40, v32
    v_add_f32 v36, v45, v33
    v_sub_f32 v33, v45, v33
    v_add_f32 v37, v29, v25
    v_sub_f32 v25, v29, v25
    v_add_f32 v29, v24, v36
    v_sub_f32 v36, v24, v36
    v_add_f32 v24, v28, v33
    v_sub_f32 v40, v42, v32
    v_sub_f32 v41, v28, v33
    v_add_f32 v43, v42, v32
    v_sin_f32 v33, v57
    v_cos_f32 v32, v57
    v_mul_f32 v28, 0x40000000, v57
    v_sin_f32 v44, v28
    v_cos_f32 v42, v28
    v_mul_f32 v28, v30, v32
    v_mul_f32 v45, v31, v32
    v_fma_f32 v28, -v31, v33, v28
    v_fmac_f32 v45, v30, v33
    v_mul_f32 v30, 0x40400000, v57
    v_sin_f32 v32, v30
    v_cos_f32 v31, v30
    v_mul_f32 v30, v34, v42
    v_mul_f32 v33, v35, v42
    v_fma_f32 v30, -v35, v44, v30
    v_fmac_f32 v33, v34, v44
    v_mul_f32 v34, v38, v31
    v_mul_f32 v35, v39, v31
    v_fma_f32 v34, -v39, v32, v34
    v_fmac_f32 v35, v38, v32
    v_add_f32 v31, v26, v30
    v_sub_f32 v30, v26, v30
    v_add_f32 v26, v27, v33
    v_sub_f32 v33, v27, v33
    v_add_f32 v27, v28, v34
    v_sub_f32 v34, v28, v34
    v_add_f32 v28, v45, v35
    v_sub_f32 v35, v45, v35
    v_add_f32 v32, v31, v27
    v_sub_f32 v27, v31, v27
    v_add_f32 v31, v26, v28
    v_sub_f32 v28, v26, v28
    v_add_f32 v26, v30, v35
    v_sub_f32 v38, v33, v34
    v_sub_f32 v39, v30, v35
    v_add_f32 v42, v33, v34
    v_mov_b32 v34, v37
    v_mov_b32 v35, v29
    s_mov_b32 s21, 0
    buffer_store_dwordx2 v[34:35], v1, s[8:11], s21 offen
    v_mov_b32 v44, v32
    v_mov_b32 v45, v31
    s_mov_b32 s21, 2048
    buffer_store_dwordx2 v[44:45], v1, s[8:11], s21 offen
    v_mov_b32 v46, v41
    v_mov_b32 v47, v43
    s_mov_b32 s21, 4096
    buffer_store_dwordx2 v[46:47], v1, s[8:11], s21 offen
    v_mov_b32 v58, v39
    v_mov_b32 v59, v42
    s_mov_b32 s21, 6144
    buffer_store_dwordx2 v[58:59], v1, s[8:11], s21 offen
    v_mov_b32 v60, v25
    v_mov_b32 v61, v36
    s_mov_b32 s21, 8192
    buffer_store_dwordx2 v[60:61], v1, s[8:11], s21 offen
    v_mov_b32 v62, v27
    v_mov_b32 v63, v28
    s_mov_b32 s21, 10240
    buffer_store_dwordx2 v[62:63], v1, s[8:11], s21 offen
    v_mov_b32 v64, v24
    v_mov_b32 v65, v40
    s_mov_b32 s21, 12288
    buffer_store_dwordx2 v[64:65], v1, s[8:11], s21 offen
    v_mov_b32 v66, v26
    v_mov_b32 v67, v38
    s_mov_b32 s21, 14336
    buffer_store_dwordx2 v[66:67], v1, s[8:11], s21 offen
K2_END:
    s_endpgm
.globl irfft_ln_kernel
.p2align 8
.type irfft_ln_kernel,@function
irfft_ln_kernel:
    s_cmp_ge_u32 s2, 256
    s_cbranch_scc1 K3_END
    s_load_dwordx2 s[4:5], s[0:1], 0
    s_load_dwordx2 s[6:7], s[0:1], 80
    s_waitcnt lgkmcnt(0)
    s_mov_b32 s8, s4
    s_and_b32 s9, s5, 0xffff
    s_mov_b32 s10, 2359296
    s_mov_b32 s11, 0x20000
    s_mov_b32 s12, s6
    s_and_b32 s13, s7, 0xffff
    s_mov_b32 s14, 13824
    s_mov_b32 s15, 0x20000
    s_add_u32 s16, s6, 3145728
    s_addc_u32 s17, s7, 0
    s_and_b32 s17, s17, 0xffff
    s_mov_b32 s18, 4734976
    s_mov_b32 s19, 0x20000
    s_add_u32 s24, s6, 8388608
    s_addc_u32 s25, s7, 0
    s_and_b32 s25, s25, 0xffff
    s_mov_b32 s26, 2359296
    s_mov_b32 s27, 0x20000
    s_add_u32 s28, s6, 11534336
    s_addc_u32 s29, s7, 0
    s_and_b32 s29, s29, 0xffff
    s_mov_b32 s30, 2359296
    s_mov_b32 s31, 0x20000
    s_lshl_b32 s20, s2, 3
    v_lshrrev_b32 v1, 2, v0
    v_and_b32 v2, 3, v0
    v_lshlrev_b32 v8, 14, v1
    v_lshlrev_b32 v4, 4, v2
    v_add_u32 v8, v8, v4
    s_lshl_b32 s21, s20, 3
    v_add_u32 v8, s21, v8
    s_mov_b32 s22, 0
    buffer_load_dwordx4 v[12:15], v8, s[16:19], s22 offen
    s_mov_b32 s22, 786432
    buffer_load_dwordx4 v[16:19], v8, s[16:19], s22 offen
    s_mov_b32 s22, 1572864
    buffer_load_dwordx4 v[20:23], v8, s[16:19], s22 offen
    s_mov_b32 s22, 2359296
    buffer_load_dwordx4 v[24:27], v8, s[16:19], s22 offen
    s_mov_b32 s22, 3145728
    buffer_load_dwordx4 v[28:31], v8, s[16:19], s22 offen
    s_mov_b32 s22, 3932160
    buffer_load_dwordx4 v[32:35], v8, s[16:19], s22 offen
    s_mov_b32 s22, 4718592
    buffer_load_dwordx4 v[36:39], v8, s[16:19], s22 offen
    v_mul_u32_u24 v3, 4672, v2
    v_mul_u32_u24 v4, 96, v1
    v_add_u32 v9, v3, v4
    v_lshlrev_b32 v4, 3, v1
    v_add_u32 v10, v3, v4
    v_mul_u32_u24 v4, 21846, v1
    v_lshrrev_b32 v4, 18, v4
    v_mul_u32_u24 v5, 12, v4
    v_sub_u32 v5, v1, v5
    v_mul_u32_u24 v4, 1152, v4
    v_lshlrev_b32 v5, 3, v5
    v_add3_u32 v4, v3, v4, v5
    v_mov_b32 v11, v4
    v_mul_u32_u24 v4, 21846, v1
    v_lshrrev_b32 v4, 18, v4
    v_mul_u32_u24 v4, 12, v4
    v_sub_u32 v4, v1, v4
    v_cvt_f32_u32 v4, v4
    v_mul_f32 v40, 0x3be38e39, v4
    v_cvt_f32_u32 v4, v1
    v_mul_f32 v41, 0x3ae38e39, v4
    v_add_f32 v4, 0x42400000, v4
    v_mul_f32 v42, 0x3ae38e39, v4
    v_add_f32 v4, 0x42400000, v4
    v_mul_f32 v43, 0x3ae38e39, v4
    v_cmp_eq_u32 vcc, 0, v1
    v_mul_u32_u24 v44, 2688, v2
    v_lshlrev_b32 v4, 3, v1
    v_sub_u32 v44, v44, v4
    v_add_u32 v44, 20224, v44
    s_waitcnt vmcnt(6)
    v_cndmask_b32 v13, v13, 0, vcc
    v_cndmask_b32 v15, v15, 0, vcc
    v_sub_f32 v45, v12, v15
    v_add_f32 v46, v13, v14
    v_add_f32 v48, v12, v15
    v_sub_f32 v49, v14, v13
    ds_write_b64 v44, v[48:49] offset:2304
    s_waitcnt vmcnt(5)
    v_sub_f32 v12, v16, v19
    v_add_f32 v13, v17, v18
    v_add_f32 v14, v16, v19
    v_sub_f32 v15, v18, v17
    ds_write_b64 v44, v[14:15] offset:1920
    s_waitcnt vmcnt(4)
    v_sub_f32 v14, v20, v23
    v_add_f32 v15, v21, v22
    v_add_f32 v16, v20, v23
    v_sub_f32 v17, v22, v21
    ds_write_b64 v44, v[16:17] offset:1536
    s_waitcnt vmcnt(3)
    v_sub_f32 v16, v24, v27
    v_add_f32 v17, v25, v26
    v_add_f32 v18, v24, v27
    v_sub_f32 v19, v26, v25
    ds_write_b64 v44, v[18:19] offset:1152
    s_waitcnt vmcnt(2)
    v_sub_f32 v18, v28, v31
    v_add_f32 v19, v29, v30
    v_add_f32 v20, v28, v31
    v_sub_f32 v21, v30, v29
    ds_write_b64 v44, v[20:21] offset:768
    s_waitcnt vmcnt(1)
    v_sub_f32 v20, v32, v35
    v_add_f32 v21, v33, v34
    v_add_f32 v22, v32, v35
    v_sub_f32 v23, v34, v33
    ds_write_b64 v44, v[22:23] offset:384
    s_waitcnt vmcnt(0)
    v_cndmask_b32 v37, v37, 0, vcc
    v_cndmask_b32 v39, v39, 0, vcc
    v_sub_f32 v22, v36, v39
    v_add_f32 v23, v37, v38
    v_mov_b32 v24, v22
    v_mov_b32 v25, v23
    v_mul_u32_u24 v4, 2688, v2
    v_add_u32 v4, 20224, v4
    v_add_u32 v5, 2680, v4
    v_cndmask_b32 v4, v5, v4, vcc
    ds_write_b64 v4, v[24:25]
    s_waitcnt lgkmcnt(0)
    s_barrier
    v_mul_u32_u24 v22, 2688, v2
    v_lshlrev_b32 v4, 3, v1
    v_add_u32 v22, v22, v4
    ds_read_b64 v[24:25], v22 offset:20224
    ds_read_b64 v[26:27], v22 offset:20608
    ds_read_b64 v[28:29], v22 offset:20992
    ds_read_b64 v[30:31], v22 offset:21376
    ds_read_b64 v[32:33], v22 offset:21760
    ds_read_b64 v[34:35], v22 offset:22144
    s_waitcnt lgkmcnt(0)
    v_add_f32 v23, v45, v24
    v_sub_f32 v24, v45, v24
    v_add_f32 v36, v46, v25
    v_sub_f32 v25, v46, v25
    v_add_f32 v37, v16, v30
    v_sub_f32 v30, v16, v30
    v_add_f32 v16, v17, v31
    v_sub_f32 v31, v17, v31
    v_add_f32 v17, v23, v37
    v_sub_f32 v37, v23, v37
    v_add_f32 v23, v36, v16
    v_sub_f32 v16, v36, v16
    v_add_f32 v36, v24, v31
    v_sub_f32 v38, v25, v30
    v_sub_f32 v39, v24, v31
    v_add_f32 v45, v25, v30
    v_add_f32 v24, v18, v32
    v_sub_f32 v32, v18, v32
    v_add_f32 v18, v19, v33
    v_sub_f32 v33, v19, v33
    v_add_f32 v19, v26, v12
    v_sub_f32 v12, v26, v12
    v_add_f32 v25, v27, v13
    v_sub_f32 v13, v27, v13
    v_add_f32 v26, v24, v19
    v_sub_f32 v19, v24, v19
    v_add_f32 v24, v18, v25
    v_sub_f32 v25, v18, v25
    v_add_f32 v18, v32, v13
    v_sub_f32 v27, v33, v12
    v_sub_f32 v30, v32, v13
    v_add_f32 v31, v33, v12
    v_add_f32 v12, v28, v14
    v_sub_f32 v14, v28, v14
    v_add_f32 v13, v29, v15
    v_sub_f32 v15, v29, v15
    v_add_f32 v28, v34, v20
    v_sub_f32 v20, v34, v20
    v_add_f32 v29, v35, v21
    v_sub_f32 v21, v35, v21
    v_add_f32 v32, v12, v28
    v_sub_f32 v28, v12, v28
    v_add_f32 v12, v13, v29
    v_sub_f32 v29, v13, v29
    v_add_f32 v13, v14, v21
    v_sub_f32 v33, v15, v20
    v_sub_f32 v34, v14, v21
    v_add_f32 v35, v15, v20
    v_add_f32 v14, v26, v32
    v_sub_f32 v32, v26, v32
    v_add_f32 v15, v24, v12
    v_sub_f32 v12, v24, v12
    v_add_f32 v20, v17, v14
    v_fma_f32 v24, -0.5, v14, v17
    v_mul_f32 v32, 0x3f5db3d7, v32
    v_add_f32 v21, v23, v15
    v_fma_f32 v26, -0.5, v15, v23
    v_mul_f32 v12, 0x3f5db3d7, v12
    v_add_f32 v14, v24, v12
    v_sub_f32 v15, v26, v32
    v_sub_f32 v17, v24, v12
    v_add_f32 v23, v26, v32
    v_add_f32 v12, v30, v34
    v_sub_f32 v34, v30, v34
    v_add_f32 v24, v31, v35
    v_sub_f32 v35, v31, v35
    v_add_f32 v26, v39, v12
    v_fma_f32 v31, -0.5, v12, v39
    v_mul_f32 v34, 0x3f5db3d7, v34
    v_add_f32 v30, v45, v24
    v_fma_f32 v32, -0.5, v24, v45
    v_mul_f32 v35, 0x3f5db3d7, v35
    v_add_f32 v12, v31, v35
    v_sub_f32 v24, v32, v34
    v_sub_f32 v39, v31, v35
    v_add_f32 v45, v32, v34
    v_add_f32 v31, v19, v28
    v_sub_f32 v28, v19, v28
    v_add_f32 v19, v25, v29
    v_sub_f32 v29, v25, v29
    v_add_f32 v25, v37, v31
    v_fma_f32 v34, -0.5, v31, v37
    v_mul_f32 v28, 0x3f5db3d7, v28
    v_add_f32 v32, v16, v19
    v_fma_f32 v35, -0.5, v19, v16
    v_mul_f32 v29, 0x3f5db3d7, v29
    v_add_f32 v16, v34, v29
    v_sub_f32 v19, v35, v28
    v_sub_f32 v31, v34, v29
    v_add_f32 v37, v35, v28
    v_add_f32 v28, v18, v13
    v_sub_f32 v13, v18, v13
    v_add_f32 v18, v27, v33
    v_sub_f32 v33, v27, v33
    v_add_f32 v27, v36, v28
    v_fma_f32 v34, -0.5, v28, v36
    v_mul_f32 v13, 0x3f5db3d7, v13
    v_add_f32 v29, v38, v18
    v_fma_f32 v35, -0.5, v18, v38
    v_mul_f32 v33, 0x3f5db3d7, v33
    v_add_f32 v18, v34, v33
    v_sub_f32 v28, v35, v13
    v_sub_f32 v36, v34, v33
    v_add_f32 v38, v35, v13
    ds_write_b32 v9, v20 offset:1536
    ds_write_b32 v9, v21 offset:1540
    ds_write_b32 v9, v39 offset:1544
    ds_write_b32 v9, v45 offset:1548
    ds_write_b32 v9, v16 offset:1552
    ds_write_b32 v9, v19 offset:1556
    ds_write_b32 v9, v27 offset:1560
    ds_write_b32 v9, v29 offset:1564
    ds_write_b32 v9, v17 offset:1568
    ds_write_b32 v9, v23 offset:1572
    ds_write_b32 v9, v12 offset:1576
    ds_write_b32 v9, v24 offset:1580
    ds_write_b32 v9, v25 offset:1584
    ds_write_b32 v9, v32 offset:1588
    ds_write_b32 v9, v36 offset:1592
    ds_write_b32 v9, v38 offset:1596
    ds_write_b32 v9, v14 offset:1600
    ds_write_b32 v9, v15 offset:1604
    ds_write_b32 v9, v26 offset:1608
    ds_write_b32 v9, v30 offset:1612
    ds_write_b32 v9, v31 offset:1616
    ds_write_b32 v9, v37 offset:1620
    ds_write_b32 v9, v18 offset:1624
    ds_write_b32 v9, v28 offset:1628
    s_waitcnt lgkmcnt(0)
    s_barrier
    ds_read_b64 v[12:13], v10 offset:1536
    ds_read_b64 v[14:15], v10 offset:1920
    ds_read_b64 v[16:17], v10 offset:2304
    ds_read_b64 v[18:19], v10 offset:2688
    ds_read_b64 v[20:21], v10 offset:3072
    ds_read_b64 v[24:25], v10 offset:3456
    ds_read_b64 v[26:27], v10 offset:3840
    ds_read_b64 v[28:29], v10 offset:4224
    ds_read_b64 v[30:31], v10 offset:4608
    ds_read_b64 v[32:33], v10 offset:4992
    ds_read_b64 v[34:35], v10 offset:5376
    ds_read_b64 v[36:37], v10 offset:5760
    s_waitcnt lgkmcnt(0)
    v_sin_f32 v39, v40
    v_cos_f32 v38, v40
    v_mul_f32 v23, 0x40000000, v40
    v_sin_f32 v46, v23
    v_cos_f32 v45, v23
    v_mul_f32 v23, v14, v38
    v_mul_f32 v47, v15, v38
    v_fma_f32 v23, -v15, v39, v23
    v_fmac_f32 v47, v14, v39
    v_mul_f32 v14, 0x40400000, v40
    v_sin_f32 v38, v14
    v_cos_f32 v15, v14
    v_mul_f32 v14, v16, v45
    v_mul_f32 v39, v17, v45
    v_fma_f32 v14, -v17, v46, v14
    v_fmac_f32 v39, v16, v46
    v_mul_f32 v16, 0x40800000, v40
    v_sin_f32 v45, v16
    v_cos_f32 v17, v16
    v_mul_f32 v16, v18, v15
    v_mul_f32 v46, v19, v15
    v_fma_f32 v16, -v19, v38, v16
    v_fmac_f32 v46, v18, v38
    v_mul_f32 v15, 0x40a00000, v40
    v_sin_f32 v19, v15
    v_cos_f32 v18, v15
    v_mul_f32 v15, v20, v17
    v_mul_f32 v38, v21, v17
    v_fma_f32 v15, -v21, v45, v15
    v_fmac_f32 v38, v20, v45
    v_mul_f32 v17, 0x40c00000, v40
    v_sin_f32 v21, v17
    v_cos_f32 v20, v17
    v_mul_f32 v17, v24, v18
    v_mul_f32 v45, v25, v18
    v_fma_f32 v17, -v25, v19, v17
    v_fmac_f32 v45, v24, v19
    v_mul_f32 v18, 0x40e00000, v40
    v_sin_f32 v24, v18
    v_cos_f32 v19, v18
    v_mul_f32 v18, v26, v20
    v_mul_f32 v25, v27, v20
    v_fma_f32 v18, -v27, v21, v18
    v_fmac_f32 v25, v26, v21
    v_mul_f32 v20, 0x41000000, v40
    v_sin_f32 v26, v20
    v_cos_f32 v21, v20
    v_mul_f32 v20, v28, v19
    v_mul_f32 v27, v29, v19
    v_fma_f32 v20, -v29, v24, v20
    v_fmac_f32 v27, v28, v24
    v_mul_f32 v19, 0x41100000, v40
    v_sin_f32 v28, v19
    v_cos_f32 v24, v19
    v_mul_f32 v19, v30, v21
    v_mul_f32 v29, v31, v21
    v_fma_f32 v19, -v31, v26, v19
    v_fmac_f32 v29, v30, v26
    v_mul_f32 v21, 0x41200000, v40
    v_sin_f32 v30, v21
    v_cos_f32 v26, v21
    v_mul_f32 v21, v32, v24
    v_mul_f32 v31, v33, v24
    v_fma_f32 v21, -v33, v28, v21
    v_fmac_f32 v31, v32, v28
    v_mul_f32 v24, 0x41300000, v40
    v_sin_f32 v32, v24
    v_cos_f32 v28, v24
    v_mul_f32 v24, v34, v26
    v_mul_f32 v33, v35, v26
    v_fma_f32 v24, -v35, v30, v24
    v_fmac_f32 v33, v34, v30
    v_mul_f32 v26, v36, v28
    v_mul_f32 v30, v37, v28
    v_fma_f32 v26, -v37, v32, v26
    v_fmac_f32 v30, v36, v32
    v_add_f32 v28, v12, v18
    v_sub_f32 v18, v12, v18
    v_add_f32 v12, v13, v25
    v_sub_f32 v25, v13, v25
    v_add_f32 v13, v16, v21
    v_sub_f32 v21, v16, v21
    v_add_f32 v16, v46, v31
    v_sub_f32 v31, v46, v31
    v_add_f32 v32, v28, v13
    v_sub_f32 v13, v28, v13
    v_add_f32 v28, v12, v16
    v_sub_f32 v16, v12, v16
    v_add_f32 v12, v18, v31
    v_sub_f32 v34, v25, v21
    v_sub_f32 v35, v18, v31
    v_add_f32 v36, v25, v21
    v_add_f32 v18, v15, v24
    v_sub_f32 v24, v15, v24
    v_add_f32 v15, v38, v33
    v_sub_f32 v33, v38, v33
    v_add_f32 v21, v20, v23
    v_sub_f32 v23, v20, v23
    v_add_f32 v20, v27, v47
    v_sub_f32 v47, v27, v47
    v_add_f32 v25, v18, v21
    v_sub_f32 v21, v18, v21
    v_add_f32 v18, v15, v20
    v_sub_f32 v20, v15, v20
    v_add_f32 v15, v24, v47
    v_sub_f32 v27, v33, v23
    v_sub_f32 v31, v24, v47
    v_add_f32 v37, v33, v23
    v_add_f32 v23, v19, v14
    v_sub_f32 v14, v19, v14
    v_add_f32 v19, v29, v39
    v_sub_f32 v39, v29, v39
    v_add_f32 v24, v26, v17
    v_sub_f32 v17, v26, v17
    v_add_f32 v26, v30, v45
    v_sub_f32 v45, v30, v45
    v_add_f32 v29, v23, v24
    v_sub_f32 v24, v23, v24
    v_add_f32 v23, v19, v26
    v_sub_f32 v26, v19, v26
    v_add_f32 v19, v14, v45
    v_sub_f32 v30, v39, v17
    v_sub_f32 v33, v14, v45
    v_add_f32 v38, v39, v17
    v_add_f32 v14, v25, v29
    v_sub_f32 v29, v25, v29
    v_add_f32 v17, v18, v23
    v_sub_f32 v23, v18, v23
    v_add_f32 v18, v32, v14
    v_fma_f32 v39, -0.5, v14, v32
    v_mul_f32 v29, 0x3f5db3d7, v29
    v_add_f32 v25, v28, v17
    v_fma_f32 v45, -0.5, v17, v28
    v_mul_f32 v23, 0x3f5db3d7, v23
    v_add_f32 v14, v39, v23
    v_sub_f32 v17, v45, v29
    v_sub_f32 v28, v39, v23
    v_add_f32 v32, v45, v29
    v_add_f32 v23, v31, v33
    v_sub_f32 v33, v31, v33
    v_add_f32 v29, v37, v38
    v_sub_f32 v38, v37, v38
    v_add_f32 v31, v35, v23
    v_fma_f32 v39, -0.5, v23, v35
    v_mul_f32 v33, 0x3f5db3d7, v33
    v_add_f32 v37, v36, v29
    v_fma_f32 v45, -0.5, v29, v36
    v_mul_f32 v38, 0x3f5db3d7, v38
    v_add_f32 v23, v39, v38
    v_sub_f32 v29, v45, v33
    v_sub_f32 v35, v39, v38
    v_add_f32 v36, v45, v33
    v_add_f32 v33, v21, v24
    v_sub_f32 v24, v21, v24
    v_add_f32 v21, v20, v26
    v_sub_f32 v26, v20, v26
    v_add_f32 v20, v13, v33
    v_fma_f32 v39, -0.5, v33, v13
    v_mul_f32 v24, 0x3f5db3d7, v24
    v_add_f32 v38, v16, v21
    v_fma_f32 v45, -0.5, v21, v16
    v_mul_f32 v26, 0x3f5db3d7, v26
    v_add_f32 v13, v39, v26
    v_sub_f32 v16, v45, v24
    v_sub_f32 v21, v39, v26
    v_add_f32 v33, v45, v24
    v_add_f32 v24, v15, v19
    v_sub_f32 v19, v15, v19
    v_add_f32 v15, v27, v30
    v_sub_f32 v30, v27, v30
    v_add_f32 v26, v12, v24
    v_fma_f32 v39, -0.5, v24, v12
    v_mul_f32 v19, 0x3f5db3d7, v19
    v_add_f32 v27, v34, v15
    v_fma_f32 v45, -0.5, v15, v34
    v_mul_f32 v30, 0x3f5db3d7, v30
    v_add_f32 v12, v39, v30
    v_sub_f32 v15, v45, v19
    v_sub_f32 v24, v39, v30
    v_add_f32 v34, v45, v19
    ds_write_b32 v11, v18 offset:38912
    ds_write_b32 v11, v25 offset:38916
    ds_write_b32 v11, v35 offset:39008
    ds_write_b32 v11, v36 offset:39012
    ds_write_b32 v11, v13 offset:39104
    ds_write_b32 v11, v16 offset:39108
    ds_write_b32 v11, v26 offset:39200
    ds_write_b32 v11, v27 offset:39204
    ds_write_b32 v11, v28 offset:39296
    ds_write_b32 v11, v32 offset:39300
    ds_write_b32 v11, v23 offset:39392
    ds_write_b32 v11, v29 offset:39396
    ds_write_b32 v11, v20 offset:39488
    ds_write_b32 v11, v38 offset:39492
    ds_write_b32 v11, v24 offset:39584
    ds_write_b32 v11, v34 offset:39588
    ds_write_b32 v11, v14 offset:39680
    ds_write_b32 v11, v17 offset:39684
    ds_write_b32 v11, v31 offset:39776
    ds_write_b32 v11, v37 offset:39780
    ds_write_b32 v11, v21 offset:39872
    ds_write_b32 v11, v33 offset:39876
    ds_write_b32 v11, v12 offset:39968
    ds_write_b32 v11, v15 offset:39972
    s_waitcnt lgkmcnt(0)
    s_barrier
    ds_read_b64 v[12:13], v10 offset:38912
    ds_read_b64 v[14:15], v10 offset:39296
    ds_read_b64 v[16:17], v10 offset:39680
    ds_read_b64 v[18:19], v10 offset:40064
    ds_read_b64 v[20:21], v10 offset:40448
    ds_read_b64 v[24:25], v10 offset:40832
    ds_read_b64 v[26:27], v10 offset:41216
    ds_read_b64 v[28:29], v10 offset:41600
    ds_read_b64 v[30:31], v10 offset:41984
    ds_read_b64 v[32:33], v10 offset:42368
    ds_read_b64 v[34:35], v10 offset:42752
    ds_read_b64 v[36:37], v10 offset:43136
    s_waitcnt lgkmcnt(0)
    v_sin_f32 v39, v41
    v_cos_f32 v38, v41
    v_mul_f32 v23, 0x40000000, v41
    v_sin_f32 v46, v23
    v_cos_f32 v45, v23
    v_mul_f32 v23, v18, v38
    v_mul_f32 v47, v19, v38
    v_fma_f32 v23, -v19, v39, v23
    v_fmac_f32 v47, v18, v39
    v_mul_f32 v18, 0x40400000, v41
    v_sin_f32 v38, v18
    v_cos_f32 v19, v18
    v_mul_f32 v18, v26, v45
    v_mul_f32 v39, v27, v45
    v_fma_f32 v18, -v27, v46, v18
    v_fmac_f32 v39, v26, v46
    v_mul_f32 v26, v32, v19
    v_mul_f32 v27, v33, v19
    v_fma_f32 v26, -v33, v38, v26
    v_fmac_f32 v27, v32, v38
    v_add_f32 v19, v12, v18
    v_sub_f32 v18, v12, v18
    v_add_f32 v12, v13, v39
    v_sub_f32 v39, v13, v39
    v_add_f32 v13, v23, v26
    v_sub_f32 v26, v23, v26
    v_add_f32 v23, v47, v27
    v_sub_f32 v27, v47, v27
    v_add_f32 v32, v19, v13
    v_sub_f32 v13, v19, v13
    v_add_f32 v19, v12, v23
    v_sub_f32 v23, v12, v23
    v_add_f32 v12, v18, v27
    v_sub_f32 v33, v39, v26
    v_sub_f32 v38, v18, v27
    v_add_f32 v45, v39, v26
    v_sin_f32 v27, v42
    v_cos_f32 v26, v42
    v_mul_f32 v18, 0x40000000, v42
    v_sin_f32 v46, v18
    v_cos_f32 v39, v18
    v_mul_f32 v18, v20, v26
    v_mul_f32 v47, v21, v26
    v_fma_f32 v18, -v21, v27, v18
    v_fmac_f32 v47, v20, v27
    v_mul_f32 v20, 0x40400000, v42
    v_sin_f32 v26, v20
    v_cos_f32 v21, v20
    v_mul_f32 v20, v28, v39
    v_mul_f32 v27, v29, v39
    v_fma_f32 v20, -v29, v46, v20
    v_fmac_f32 v27, v28, v46
    v_mul_f32 v28, v34, v21
    v_mul_f32 v29, v35, v21
    v_fma_f32 v28, -v35, v26, v28
    v_fmac_f32 v29, v34, v26
    v_add_f32 v21, v14, v20
    v_sub_f32 v20, v14, v20
    v_add_f32 v14, v15, v27
    v_sub_f32 v27, v15, v27
    v_add_f32 v15, v18, v28
    v_sub_f32 v28, v18, v28
    v_add_f32 v18, v47, v29
    v_sub_f32 v29, v47, v29
    v_add_f32 v26, v21, v15
    v_sub_f32 v15, v21, v15
    v_add_f32 v21, v14, v18
    v_sub_f32 v18, v14, v18
    v_add_f32 v14, v20, v29
    v_sub_f32 v34, v27, v28
    v_sub_f32 v35, v20, v29
    v_add_f32 v39, v27, v28
    v_sin_f32 v28, v43
    v_cos_f32 v27, v43
    v_mul_f32 v20, 0x40000000, v43
    v_sin_f32 v46, v20
    v_cos_f32 v29, v20
    v_mul_f32 v20, v24, v27
    v_mul_f32 v47, v25, v27
    v_fma_f32 v20, -v25, v28, v20
    v_fmac_f32 v47, v24, v28
    v_mul_f32 v24, 0x40400000, v43
    v_sin_f32 v27, v24
    v_cos_f32 v25, v24
    v_mul_f32 v24, v30, v29
    v_mul_f32 v28, v31, v29
    v_fma_f32 v24, -v31, v46, v24
    v_fmac_f32 v28, v30, v46
    v_mul_f32 v29, v36, v25
    v_mul_f32 v30, v37, v25
    v_fma_f32 v29, -v37, v27, v29
    v_fmac_f32 v30, v36, v27
    v_add_f32 v25, v16, v24
    v_sub_f32 v24, v16, v24
    v_add_f32 v16, v17, v28
    v_sub_f32 v28, v17, v28
    v_add_f32 v17, v20, v29
    v_sub_f32 v29, v20, v29
    v_add_f32 v20, v47, v30
    v_sub_f32 v30, v47, v30
    v_add_f32 v27, v25, v17
    v_sub_f32 v17, v25, v17
    v_add_f32 v25, v16, v20
    v_sub_f32 v20, v16, v20
    v_add_f32 v16, v24, v30
    v_sub_f32 v31, v28, v29
    v_sub_f32 v36, v24, v30
    v_add_f32 v37, v28, v29
    v_mul_u32_u24 v24, 2336, v2
    v_lshlrev_b32 v4, 2, v1
    v_add_u32 v24, v24, v4
    v_mul_f32 v32, 0x34e38e39, v32
    v_mul_f32 v19, 0x34e38e39, v19
    v_cvt_pk_bf16_f32 v19, v32, v19
    v_lshlrev_b32 v32, 16, v19
    v_and_b32 v19, 0xffff0000, v19
    ds_write_b32 v24, v32 offset:20224
    ds_write_b32 v24, v19 offset:29568
    v_mul_f32 v26, 0x34e38e39, v26
    v_mul_f32 v21, 0x34e38e39, v21
    v_cvt_pk_bf16_f32 v21, v26, v21
    v_lshlrev_b32 v26, 16, v21
    v_and_b32 v21, 0xffff0000, v21
    ds_write_b32 v24, v26 offset:20416
    ds_write_b32 v24, v21 offset:29760
    v_mul_f32 v27, 0x34e38e39, v27
    v_mul_f32 v25, 0x34e38e39, v25
    v_cvt_pk_bf16_f32 v25, v27, v25
    v_lshlrev_b32 v27, 16, v25
    v_and_b32 v25, 0xffff0000, v25
    ds_write_b32 v24, v27 offset:20608
    ds_write_b32 v24, v25 offset:29952
    v_mul_f32 v38, 0x34e38e39, v38
    v_mul_f32 v45, 0x34e38e39, v45
    v_cvt_pk_bf16_f32 v45, v38, v45
    v_lshlrev_b32 v38, 16, v45
    v_and_b32 v45, 0xffff0000, v45
    ds_write_b32 v24, v38 offset:20800
    ds_write_b32 v24, v45 offset:30144
    v_mul_f32 v35, 0x34e38e39, v35
    v_mul_f32 v39, 0x34e38e39, v39
    v_cvt_pk_bf16_f32 v39, v35, v39
    v_lshlrev_b32 v35, 16, v39
    v_and_b32 v39, 0xffff0000, v39
    ds_write_b32 v24, v35 offset:20992
    ds_write_b32 v24, v39 offset:30336
    v_mul_f32 v36, 0x34e38e39, v36
    v_mul_f32 v37, 0x34e38e39, v37
    v_cvt_pk_bf16_f32 v37, v36, v37
    v_lshlrev_b32 v36, 16, v37
    v_and_b32 v37, 0xffff0000, v37
    ds_write_b32 v24, v36 offset:21184
    ds_write_b32 v24, v37 offset:30528
    v_mul_f32 v13, 0x34e38e39, v13
    v_mul_f32 v23, 0x34e38e39, v23
    v_cvt_pk_bf16_f32 v23, v13, v23
    v_lshlrev_b32 v13, 16, v23
    v_and_b32 v23, 0xffff0000, v23
    ds_write_b32 v24, v13 offset:21376
    ds_write_b32 v24, v23 offset:30720
    v_mul_f32 v15, 0x34e38e39, v15
    v_mul_f32 v18, 0x34e38e39, v18
    v_cvt_pk_bf16_f32 v18, v15, v18
    v_lshlrev_b32 v15, 16, v18
    v_and_b32 v18, 0xffff0000, v18
    ds_write_b32 v24, v15 offset:21568
    ds_write_b32 v24, v18 offset:30912
    v_mul_f32 v17, 0x34e38e39, v17
    v_mul_f32 v20, 0x34e38e39, v20
    v_cvt_pk_bf16_f32 v20, v17, v20
    v_lshlrev_b32 v17, 16, v20
    v_and_b32 v20, 0xffff0000, v20
    ds_write_b32 v24, v17 offset:21760
    ds_write_b32 v24, v20 offset:31104
    v_mul_f32 v12, 0x34e38e39, v12
    v_mul_f32 v33, 0x34e38e39, v33
    v_cvt_pk_bf16_f32 v33, v12, v33
    v_lshlrev_b32 v12, 16, v33
    v_and_b32 v33, 0xffff0000, v33
    ds_write_b32 v24, v12 offset:21952
    ds_write_b32 v24, v33 offset:31296
    v_mul_f32 v14, 0x34e38e39, v14
    v_mul_f32 v34, 0x34e38e39, v34
    v_cvt_pk_bf16_f32 v34, v14, v34
    v_lshlrev_b32 v14, 16, v34
    v_and_b32 v34, 0xffff0000, v34
    ds_write_b32 v24, v14 offset:22144
    ds_write_b32 v24, v34 offset:31488
    v_mul_f32 v16, 0x34e38e39, v16
    v_mul_f32 v31, 0x34e38e39, v31
    v_cvt_pk_bf16_f32 v31, v16, v31
    v_lshlrev_b32 v16, 16, v31
    v_and_b32 v31, 0xffff0000, v31
    ds_write_b32 v24, v16 offset:22336
    ds_write_b32 v24, v31 offset:31680
    v_mul_u32_u24 v3, 2731, v0
    v_lshrrev_b32 v1, 16, v3
    v_mul_u32_u24 v3, 24, v1
    v_sub_u32 v2, v0, v3
    v_add_u32 v4, s20, v1
    v_mul_u32_u24 v4, 1152, v4
    v_mul_u32_u24 v5, 48, v2
    v_add_u32 v4, v4, v5
    buffer_load_dwordx4 v[8:11], v4, s[8:11], 0 offen offset:0
    buffer_load_dwordx4 v[12:15], v4, s[8:11], 0 offen offset:16
    buffer_load_dwordx4 v[16:19], v4, s[8:11], 0 offen offset:32
    v_mul_u32_u24 v5, 96, v2
    s_mov_b32 s21, 4608
    s_mov_b32 s22, 6912
    s_mov_b32 s23, 9216
    buffer_load_dwordx4 v[80:83], v5, s[12:15], s21 offen offset:0
    buffer_load_dwordx4 v[84:87], v5, s[12:15], s21 offen offset:16
    buffer_load_dwordx4 v[88:91], v5, s[12:15], s21 offen offset:32
    buffer_load_dwordx4 v[92:95], v5, s[12:15], s21 offen offset:48
    buffer_load_dwordx4 v[96:99], v5, s[12:15], s21 offen offset:64
    buffer_load_dwordx4 v[100:103], v5, s[12:15], s21 offen offset:80
    buffer_load_dwordx4 v[104:107], v5, s[12:15], s22 offen offset:0
    buffer_load_dwordx4 v[108:111], v5, s[12:15], s22 offen offset:16
    buffer_load_dwordx4 v[112:115], v5, s[12:15], s22 offen offset:32
    buffer_load_dwordx4 v[116:119], v5, s[12:15], s22 offen offset:48
    buffer_load_dwordx4 v[120:123], v5, s[12:15], s22 offen offset:64
    buffer_load_dwordx4 v[124:127], v5, s[12:15], s22 offen offset:80
    buffer_load_dwordx4 v[128:131], v5, s[12:15], s23 offen offset:0
    buffer_load_dwordx4 v[132:135], v5, s[12:15], s23 offen offset:16
    buffer_load_dwordx4 v[136:139], v5, s[12:15], s23 offen offset:32
    buffer_load_dwordx4 v[140:143], v5, s[12:15], s23 offen offset:48
    buffer_load_dwordx4 v[144:147], v5, s[12:15], s23 offen offset:64
    buffer_load_dwordx4 v[148:151], v5, s[12:15], s23 offen offset:80
    s_waitcnt lgkmcnt(0)
    s_barrier
    v_and_b32 v6, 1, v1
    v_lshlrev_b32 v6, 2, v6
    v_lshrrev_b32 v7, 1, v1
    v_add_u32 v6, v6, v7
    v_mul_u32_u24 v6, 2336, v6
    v_add_u32 v6, v6, v5
    ds_read_b128 v[20:23], v6 offset:20224
    ds_read_b128 v[24:27], v6 offset:20240
    ds_read_b128 v[28:31], v6 offset:20256
    ds_read_b128 v[32:35], v6 offset:20272
    ds_read_b128 v[36:39], v6 offset:20288
    ds_read_b128 v[40:43], v6 offset:20304
    s_waitcnt vmcnt(12) lgkmcnt(0)
    v_mul_f32 v20, v20, v80
    v_mul_f32 v21, v21, v81
    v_cvt_pk_bf16_f32 v21, v20, v21
    v_lshlrev_b32 v20, 16, v21
    v_and_b32 v21, 0xffff0000, v21
    v_lshlrev_b32 v7, 16, v8
    v_and_b32 v8, 0xffff0000, v8
    v_add_f32 v20, v7, v20
    v_add_f32 v21, v8, v21
    v_cvt_pk_bf16_f32 v8, v20, v21
    v_lshlrev_b32 v20, 16, v8
    v_and_b32 v21, 0xffff0000, v8
    v_mul_f32 v22, v22, v82
    v_mul_f32 v23, v23, v83
    v_cvt_pk_bf16_f32 v23, v22, v23
    v_lshlrev_b32 v22, 16, v23
    v_and_b32 v23, 0xffff0000, v23
    v_lshlrev_b32 v7, 16, v9
    v_and_b32 v9, 0xffff0000, v9
    v_add_f32 v22, v7, v22
    v_add_f32 v23, v9, v23
    v_cvt_pk_bf16_f32 v9, v22, v23
    v_lshlrev_b32 v22, 16, v9
    v_and_b32 v23, 0xffff0000, v9
    v_mul_f32 v24, v24, v84
    v_mul_f32 v25, v25, v85
    v_cvt_pk_bf16_f32 v25, v24, v25
    v_lshlrev_b32 v24, 16, v25
    v_and_b32 v25, 0xffff0000, v25
    v_lshlrev_b32 v7, 16, v10
    v_and_b32 v10, 0xffff0000, v10
    v_add_f32 v24, v7, v24
    v_add_f32 v25, v10, v25
    v_cvt_pk_bf16_f32 v10, v24, v25
    v_lshlrev_b32 v24, 16, v10
    v_and_b32 v25, 0xffff0000, v10
    v_mul_f32 v26, v26, v86
    v_mul_f32 v27, v27, v87
    v_cvt_pk_bf16_f32 v27, v26, v27
    v_lshlrev_b32 v26, 16, v27
    v_and_b32 v27, 0xffff0000, v27
    v_lshlrev_b32 v7, 16, v11
    v_and_b32 v11, 0xffff0000, v11
    v_add_f32 v26, v7, v26
    v_add_f32 v27, v11, v27
    v_cvt_pk_bf16_f32 v11, v26, v27
    v_lshlrev_b32 v26, 16, v11
    v_and_b32 v27, 0xffff0000, v11
    v_mul_f32 v28, v28, v88
    v_mul_f32 v29, v29, v89
    v_cvt_pk_bf16_f32 v29, v28, v29
    v_lshlrev_b32 v28, 16, v29
    v_and_b32 v29, 0xffff0000, v29
    v_lshlrev_b32 v7, 16, v12
    v_and_b32 v12, 0xffff0000, v12
    v_add_f32 v28, v7, v28
    v_add_f32 v29, v12, v29
    v_cvt_pk_bf16_f32 v12, v28, v29
    v_lshlrev_b32 v28, 16, v12
    v_and_b32 v29, 0xffff0000, v12
    v_mul_f32 v30, v30, v90
    v_mul_f32 v31, v31, v91
    v_cvt_pk_bf16_f32 v31, v30, v31
    v_lshlrev_b32 v30, 16, v31
    v_and_b32 v31, 0xffff0000, v31
    v_lshlrev_b32 v7, 16, v13
    v_and_b32 v13, 0xffff0000, v13
    v_add_f32 v30, v7, v30
    v_add_f32 v31, v13, v31
    v_cvt_pk_bf16_f32 v13, v30, v31
    v_lshlrev_b32 v30, 16, v13
    v_and_b32 v31, 0xffff0000, v13
    v_mul_f32 v32, v32, v92
    v_mul_f32 v33, v33, v93
    v_cvt_pk_bf16_f32 v33, v32, v33
    v_lshlrev_b32 v32, 16, v33
    v_and_b32 v33, 0xffff0000, v33
    v_lshlrev_b32 v7, 16, v14
    v_and_b32 v14, 0xffff0000, v14
    v_add_f32 v32, v7, v32
    v_add_f32 v33, v14, v33
    v_cvt_pk_bf16_f32 v14, v32, v33
    v_lshlrev_b32 v32, 16, v14
    v_and_b32 v33, 0xffff0000, v14
    v_mul_f32 v34, v34, v94
    v_mul_f32 v35, v35, v95
    v_cvt_pk_bf16_f32 v35, v34, v35
    v_lshlrev_b32 v34, 16, v35
    v_and_b32 v35, 0xffff0000, v35
    v_lshlrev_b32 v7, 16, v15
    v_and_b32 v15, 0xffff0000, v15
    v_add_f32 v34, v7, v34
    v_add_f32 v35, v15, v35
    v_cvt_pk_bf16_f32 v15, v34, v35
    v_lshlrev_b32 v34, 16, v15
    v_and_b32 v35, 0xffff0000, v15
    v_mul_f32 v36, v36, v96
    v_mul_f32 v37, v37, v97
    v_cvt_pk_bf16_f32 v37, v36, v37
    v_lshlrev_b32 v36, 16, v37
    v_and_b32 v37, 0xffff0000, v37
    v_lshlrev_b32 v7, 16, v16
    v_and_b32 v16, 0xffff0000, v16
    v_add_f32 v36, v7, v36
    v_add_f32 v37, v16, v37
    v_cvt_pk_bf16_f32 v16, v36, v37
    v_lshlrev_b32 v36, 16, v16
    v_and_b32 v37, 0xffff0000, v16
    v_mul_f32 v38, v38, v98
    v_mul_f32 v39, v39, v99
    v_cvt_pk_bf16_f32 v39, v38, v39
    v_lshlrev_b32 v38, 16, v39
    v_and_b32 v39, 0xffff0000, v39
    v_lshlrev_b32 v7, 16, v17
    v_and_b32 v17, 0xffff0000, v17
    v_add_f32 v38, v7, v38
    v_add_f32 v39, v17, v39
    v_cvt_pk_bf16_f32 v17, v38, v39
    v_lshlrev_b32 v38, 16, v17
    v_and_b32 v39, 0xffff0000, v17
    v_mul_f32 v40, v40, v100
    v_mul_f32 v41, v41, v101
    v_cvt_pk_bf16_f32 v41, v40, v41
    v_lshlrev_b32 v40, 16, v41
    v_and_b32 v41, 0xffff0000, v41
    v_lshlrev_b32 v7, 16, v18
    v_and_b32 v18, 0xffff0000, v18
    v_add_f32 v40, v7, v40
    v_add_f32 v41, v18, v41
    v_cvt_pk_bf16_f32 v18, v40, v41
    v_lshlrev_b32 v40, 16, v18
    v_and_b32 v41, 0xffff0000, v18
    v_mul_f32 v42, v42, v102
    v_mul_f32 v43, v43, v103
    v_cvt_pk_bf16_f32 v43, v42, v43
    v_lshlrev_b32 v42, 16, v43
    v_and_b32 v43, 0xffff0000, v43
    v_lshlrev_b32 v7, 16, v19
    v_and_b32 v19, 0xffff0000, v19
    v_add_f32 v42, v7, v42
    v_add_f32 v43, v19, v43
    v_cvt_pk_bf16_f32 v19, v42, v43
    v_lshlrev_b32 v42, 16, v19
    v_and_b32 v43, 0xffff0000, v19
    buffer_store_dwordx4 v[8:11], v4, s[24:27], 0 offen offset:0
    buffer_store_dwordx4 v[12:15], v4, s[24:27], 0 offen offset:16
    buffer_store_dwordx4 v[16:19], v4, s[24:27], 0 offen offset:32
    v_add_f32 v44, v20, v24
    v_add_f32 v45, v21, v25
    v_add_f32 v46, v22, v26
    v_add_f32 v47, v23, v27
    v_add_f32 v44, v44, v28
    v_add_f32 v45, v45, v29
    v_add_f32 v46, v46, v30
    v_add_f32 v47, v47, v31
    v_add_f32 v44, v44, v32
    v_add_f32 v45, v45, v33
    v_add_f32 v46, v46, v34
    v_add_f32 v47, v47, v35
    v_add_f32 v44, v44, v36
    v_add_f32 v45, v45, v37
    v_add_f32 v46, v46, v38
    v_add_f32 v47, v47, v39
    v_add_f32 v44, v44, v40
    v_add_f32 v45, v45, v41
    v_add_f32 v46, v46, v42
    v_add_f32 v47, v47, v43
    v_add_f32 v44, v44, v45
    v_add_f32 v46, v46, v47
    v_add_f32 v44, v44, v46
    v_lshlrev_b32 v6, 2, v0
    ds_write_b32 v6, v44 offset:0
    s_waitcnt lgkmcnt(0)
    s_barrier
    v_mul_u32_u24 v6, 96, v1
    ds_read_b128 v[48:51], v6 offset:0
    ds_read_b128 v[52:55], v6 offset:16
    ds_read_b128 v[56:59], v6 offset:32
    ds_read_b128 v[60:63], v6 offset:48
    ds_read_b128 v[64:67], v6 offset:64
    ds_read_b128 v[68:71], v6 offset:80
    s_waitcnt lgkmcnt(0)
    v_add_f32 v76, v48, v52
    v_add_f32 v72, v49, v53
    v_add_f32 v73, v50, v54
    v_add_f32 v74, v51, v55
    v_add_f32 v76, v76, v56
    v_add_f32 v72, v72, v57
    v_add_f32 v73, v73, v58
    v_add_f32 v74, v74, v59
    v_add_f32 v76, v76, v60
    v_add_f32 v72, v72, v61
    v_add_f32 v73, v73, v62
    v_add_f32 v74, v74, v63
    v_add_f32 v76, v76, v64
    v_add_f32 v72, v72, v65
    v_add_f32 v73, v73, v66
    v_add_f32 v74, v74, v67
    v_add_f32 v76, v76, v68
    v_add_f32 v72, v72, v69
    v_add_f32 v73, v73, v70
    v_add_f32 v74, v74, v71
    v_add_f32 v76, v76, v72
    v_add_f32 v73, v73, v74
    v_add_f32 v76, v76, v73
    v_mul_f32 v76, 0x3ae38e39, v76
    v_sub_f32 v7, v20, v76
    v_mul_f32 v44, v7, v7
    v_sub_f32 v7, v21, v76
    v_mul_f32 v45, v7, v7
    v_sub_f32 v7, v22, v76
    v_mul_f32 v46, v7, v7
    v_sub_f32 v7, v23, v76
    v_mul_f32 v47, v7, v7
    v_sub_f32 v7, v24, v76
    v_fmac_f32 v44, v7, v7
    v_sub_f32 v7, v25, v76
    v_fmac_f32 v45, v7, v7
    v_sub_f32 v7, v26, v76
    v_fmac_f32 v46, v7, v7
    v_sub_f32 v7, v27, v76
    v_fmac_f32 v47, v7, v7
    v_sub_f32 v7, v28, v76
    v_fmac_f32 v44, v7, v7
    v_sub_f32 v7, v29, v76
    v_fmac_f32 v45, v7, v7
    v_sub_f32 v7, v30, v76
    v_fmac_f32 v46, v7, v7
    v_sub_f32 v7, v31, v76
    v_fmac_f32 v47, v7, v7
    v_sub_f32 v7, v32, v76
    v_fmac_f32 v44, v7, v7
    v_sub_f32 v7, v33, v76
    v_fmac_f32 v45, v7, v7
    v_sub_f32 v7, v34, v76
    v_fmac_f32 v46, v7, v7
    v_sub_f32 v7, v35, v76
    v_fmac_f32 v47, v7, v7
    v_sub_f32 v7, v36, v76
    v_fmac_f32 v44, v7, v7
    v_sub_f32 v7, v37, v76
    v_fmac_f32 v45, v7, v7
    v_sub_f32 v7, v38, v76
    v_fmac_f32 v46, v7, v7
    v_sub_f32 v7, v39, v76
    v_fmac_f32 v47, v7, v7
    v_sub_f32 v7, v40, v76
    v_fmac_f32 v44, v7, v7
    v_sub_f32 v7, v41, v76
    v_fmac_f32 v45, v7, v7
    v_sub_f32 v7, v42, v76
    v_fmac_f32 v46, v7, v7
    v_sub_f32 v7, v43, v76
    v_fmac_f32 v47, v7, v7
    v_add_f32 v44, v44, v45
    v_add_f32 v46, v46, v47
    v_add_f32 v44, v44, v46
    v_lshlrev_b32 v6, 2, v0
    ds_write_b32 v6, v44 offset:768
    s_waitcnt lgkmcnt(0)
    s_barrier
    v_mul_u32_u24 v6, 96, v1
    ds_read_b128 v[48:51], v6 offset:768
    ds_read_b128 v[52:55], v6 offset:784
    ds_read_b128 v[56:59], v6 offset:800
    ds_read_b128 v[60:63], v6 offset:816
    ds_read_b128 v[64:67], v6 offset:832
    ds_read_b128 v[68:71], v6 offset:848
    s_waitcnt lgkmcnt(0)
    v_add_f32 v77, v48, v52
    v_add_f32 v72, v49, v53
    v_add_f32 v73, v50, v54
    v_add_f32 v74, v51, v55
    v_add_f32 v77, v77, v56
    v_add_f32 v72, v72, v57
    v_add_f32 v73, v73, v58
    v_add_f32 v74, v74, v59
    v_add_f32 v77, v77, v60
    v_add_f32 v72, v72, v61
    v_add_f32 v73, v73, v62
    v_add_f32 v74, v74, v63
    v_add_f32 v77, v77, v64
    v_add_f32 v72, v72, v65
    v_add_f32 v73, v73, v66
    v_add_f32 v74, v74, v67
    v_add_f32 v77, v77, v68
    v_add_f32 v72, v72, v69
    v_add_f32 v73, v73, v70
    v_add_f32 v74, v74, v71
    v_add_f32 v77, v77, v72
    v_add_f32 v73, v73, v74
    v_add_f32 v77, v77, v73
    v_mul_f32 v77, 0x3ae38e39, v77
    v_cvt_pk_bf16_f32 v77, v77, v77
    v_lshlrev_b32 v77, 16, v77
    v_add_f32 v77, 0x3727c5ac, v77
    v_cvt_pk_bf16_f32 v77, v77, v77
    v_lshlrev_b32 v77, 16, v77
    v_sqrt_f32 v77, v77
    s_nop 0
    v_cvt_pk_bf16_f32 v77, v77, v77
    v_lshlrev_b32 v77, 16, v77
    v_rcp_f32 v77, v77
    v_cvt_pk_bf16_f32 v76, v76, v76
    v_lshlrev_b32 v76, 16, v76
    s_waitcnt vmcnt(3)
    v_sub_f32 v20, v20, v76
    v_sub_f32 v21, v21, v76
    v_cvt_pk_bf16_f32 v21, v20, v21
    v_lshlrev_b32 v20, 16, v21
    v_and_b32 v21, 0xffff0000, v21
    v_mul_f32 v20, v20, v77
    v_mul_f32 v21, v21, v77
    v_cvt_pk_bf16_f32 v21, v20, v21
    v_lshlrev_b32 v20, 16, v21
    v_and_b32 v21, 0xffff0000, v21
    v_mul_f32 v20, v20, v128
    v_mul_f32 v21, v21, v129
    v_cvt_pk_bf16_f32 v21, v20, v21
    v_lshlrev_b32 v20, 16, v21
    v_and_b32 v21, 0xffff0000, v21
    v_add_f32 v20, v20, v104
    v_add_f32 v21, v21, v105
    v_cvt_pk_bf16_f32 v21, v20, v21
    v_lshlrev_b32 v20, 16, v21
    v_and_b32 v21, 0xffff0000, v21
    v_sub_f32 v22, v22, v76
    v_sub_f32 v23, v23, v76
    v_cvt_pk_bf16_f32 v23, v22, v23
    v_lshlrev_b32 v22, 16, v23
    v_and_b32 v23, 0xffff0000, v23
    v_mul_f32 v22, v22, v77
    v_mul_f32 v23, v23, v77
    v_cvt_pk_bf16_f32 v23, v22, v23
    v_lshlrev_b32 v22, 16, v23
    v_and_b32 v23, 0xffff0000, v23
    v_mul_f32 v22, v22, v130
    v_mul_f32 v23, v23, v131
    v_cvt_pk_bf16_f32 v23, v22, v23
    v_lshlrev_b32 v22, 16, v23
    v_and_b32 v23, 0xffff0000, v23
    v_add_f32 v22, v22, v106
    v_add_f32 v23, v23, v107
    v_cvt_pk_bf16_f32 v23, v22, v23
    v_lshlrev_b32 v22, 16, v23
    v_and_b32 v23, 0xffff0000, v23
    v_sub_f32 v24, v24, v76
    v_sub_f32 v25, v25, v76
    v_cvt_pk_bf16_f32 v25, v24, v25
    v_lshlrev_b32 v24, 16, v25
    v_and_b32 v25, 0xffff0000, v25
    v_mul_f32 v24, v24, v77
    v_mul_f32 v25, v25, v77
    v_cvt_pk_bf16_f32 v25, v24, v25
    v_lshlrev_b32 v24, 16, v25
    v_and_b32 v25, 0xffff0000, v25
    v_mul_f32 v24, v24, v132
    v_mul_f32 v25, v25, v133
    v_cvt_pk_bf16_f32 v25, v24, v25
    v_lshlrev_b32 v24, 16, v25
    v_and_b32 v25, 0xffff0000, v25
    v_add_f32 v24, v24, v108
    v_add_f32 v25, v25, v109
    v_cvt_pk_bf16_f32 v25, v24, v25
    v_lshlrev_b32 v24, 16, v25
    v_and_b32 v25, 0xffff0000, v25
    v_sub_f32 v26, v26, v76
    v_sub_f32 v27, v27, v76
    v_cvt_pk_bf16_f32 v27, v26, v27
    v_lshlrev_b32 v26, 16, v27
    v_and_b32 v27, 0xffff0000, v27
    v_mul_f32 v26, v26, v77
    v_mul_f32 v27, v27, v77
    v_cvt_pk_bf16_f32 v27, v26, v27
    v_lshlrev_b32 v26, 16, v27
    v_and_b32 v27, 0xffff0000, v27
    v_mul_f32 v26, v26, v134
    v_mul_f32 v27, v27, v135
    v_cvt_pk_bf16_f32 v27, v26, v27
    v_lshlrev_b32 v26, 16, v27
    v_and_b32 v27, 0xffff0000, v27
    v_add_f32 v26, v26, v110
    v_add_f32 v27, v27, v111
    v_cvt_pk_bf16_f32 v27, v26, v27
    v_lshlrev_b32 v26, 16, v27
    v_and_b32 v27, 0xffff0000, v27
    v_sub_f32 v28, v28, v76
    v_sub_f32 v29, v29, v76
    v_cvt_pk_bf16_f32 v29, v28, v29
    v_lshlrev_b32 v28, 16, v29
    v_and_b32 v29, 0xffff0000, v29
    v_mul_f32 v28, v28, v77
    v_mul_f32 v29, v29, v77
    v_cvt_pk_bf16_f32 v29, v28, v29
    v_lshlrev_b32 v28, 16, v29
    v_and_b32 v29, 0xffff0000, v29
    v_mul_f32 v28, v28, v136
    v_mul_f32 v29, v29, v137
    v_cvt_pk_bf16_f32 v29, v28, v29
    v_lshlrev_b32 v28, 16, v29
    v_and_b32 v29, 0xffff0000, v29
    v_add_f32 v28, v28, v112
    v_add_f32 v29, v29, v113
    v_cvt_pk_bf16_f32 v29, v28, v29
    v_lshlrev_b32 v28, 16, v29
    v_and_b32 v29, 0xffff0000, v29
    v_sub_f32 v30, v30, v76
    v_sub_f32 v31, v31, v76
    v_cvt_pk_bf16_f32 v31, v30, v31
    v_lshlrev_b32 v30, 16, v31
    v_and_b32 v31, 0xffff0000, v31
    v_mul_f32 v30, v30, v77
    v_mul_f32 v31, v31, v77
    v_cvt_pk_bf16_f32 v31, v30, v31
    v_lshlrev_b32 v30, 16, v31
    v_and_b32 v31, 0xffff0000, v31
    v_mul_f32 v30, v30, v138
    v_mul_f32 v31, v31, v139
    v_cvt_pk_bf16_f32 v31, v30, v31
    v_lshlrev_b32 v30, 16, v31
    v_and_b32 v31, 0xffff0000, v31
    v_add_f32 v30, v30, v114
    v_add_f32 v31, v31, v115
    v_cvt_pk_bf16_f32 v31, v30, v31
    v_lshlrev_b32 v30, 16, v31
    v_and_b32 v31, 0xffff0000, v31
    v_sub_f32 v32, v32, v76
    v_sub_f32 v33, v33, v76
    v_cvt_pk_bf16_f32 v33, v32, v33
    v_lshlrev_b32 v32, 16, v33
    v_and_b32 v33, 0xffff0000, v33
    v_mul_f32 v32, v32, v77
    v_mul_f32 v33, v33, v77
    v_cvt_pk_bf16_f32 v33, v32, v33
    v_lshlrev_b32 v32, 16, v33
    v_and_b32 v33, 0xffff0000, v33
    v_mul_f32 v32, v32, v140
    v_mul_f32 v33, v33, v141
    v_cvt_pk_bf16_f32 v33, v32, v33
    v_lshlrev_b32 v32, 16, v33
    v_and_b32 v33, 0xffff0000, v33
    v_add_f32 v32, v32, v116
    v_add_f32 v33, v33, v117
    v_cvt_pk_bf16_f32 v33, v32, v33
    v_lshlrev_b32 v32, 16, v33
    v_and_b32 v33, 0xffff0000, v33
    v_sub_f32 v34, v34, v76
    v_sub_f32 v35, v35, v76
    v_cvt_pk_bf16_f32 v35, v34, v35
    v_lshlrev_b32 v34, 16, v35
    v_and_b32 v35, 0xffff0000, v35
    v_mul_f32 v34, v34, v77
    v_mul_f32 v35, v35, v77
    v_cvt_pk_bf16_f32 v35, v34, v35
    v_lshlrev_b32 v34, 16, v35
    v_and_b32 v35, 0xffff0000, v35
    v_mul_f32 v34, v34, v142
    v_mul_f32 v35, v35, v143
    v_cvt_pk_bf16_f32 v35, v34, v35
    v_lshlrev_b32 v34, 16, v35
    v_and_b32 v35, 0xffff0000, v35
    v_add_f32 v34, v34, v118
    v_add_f32 v35, v35, v119
    v_cvt_pk_bf16_f32 v35, v34, v35
    v_lshlrev_b32 v34, 16, v35
    v_and_b32 v35, 0xffff0000, v35
    v_sub_f32 v36, v36, v76
    v_sub_f32 v37, v37, v76
    v_cvt_pk_bf16_f32 v37, v36, v37
    v_lshlrev_b32 v36, 16, v37
    v_and_b32 v37, 0xffff0000, v37
    v_mul_f32 v36, v36, v77
    v_mul_f32 v37, v37, v77
    v_cvt_pk_bf16_f32 v37, v36, v37
    v_lshlrev_b32 v36, 16, v37
    v_and_b32 v37, 0xffff0000, v37
    v_mul_f32 v36, v36, v144
    v_mul_f32 v37, v37, v145
    v_cvt_pk_bf16_f32 v37, v36, v37
    v_lshlrev_b32 v36, 16, v37
    v_and_b32 v37, 0xffff0000, v37
    v_add_f32 v36, v36, v120
    v_add_f32 v37, v37, v121
    v_cvt_pk_bf16_f32 v37, v36, v37
    v_lshlrev_b32 v36, 16, v37
    v_and_b32 v37, 0xffff0000, v37
    v_sub_f32 v38, v38, v76
    v_sub_f32 v39, v39, v76
    v_cvt_pk_bf16_f32 v39, v38, v39
    v_lshlrev_b32 v38, 16, v39
    v_and_b32 v39, 0xffff0000, v39
    v_mul_f32 v38, v38, v77
    v_mul_f32 v39, v39, v77
    v_cvt_pk_bf16_f32 v39, v38, v39
    v_lshlrev_b32 v38, 16, v39
    v_and_b32 v39, 0xffff0000, v39
    v_mul_f32 v38, v38, v146
    v_mul_f32 v39, v39, v147
    v_cvt_pk_bf16_f32 v39, v38, v39
    v_lshlrev_b32 v38, 16, v39
    v_and_b32 v39, 0xffff0000, v39
    v_add_f32 v38, v38, v122
    v_add_f32 v39, v39, v123
    v_cvt_pk_bf16_f32 v39, v38, v39
    v_lshlrev_b32 v38, 16, v39
    v_and_b32 v39, 0xffff0000, v39
    v_sub_f32 v40, v40, v76
    v_sub_f32 v41, v41, v76
    v_cvt_pk_bf16_f32 v41, v40, v41
    v_lshlrev_b32 v40, 16, v41
    v_and_b32 v41, 0xffff0000, v41
    v_mul_f32 v40, v40, v77
    v_mul_f32 v41, v41, v77
    v_cvt_pk_bf16_f32 v41, v40, v41
    v_lshlrev_b32 v40, 16, v41
    v_and_b32 v41, 0xffff0000, v41
    v_mul_f32 v40, v40, v148
    v_mul_f32 v41, v41, v149
    v_cvt_pk_bf16_f32 v41, v40, v41
    v_lshlrev_b32 v40, 16, v41
    v_and_b32 v41, 0xffff0000, v41
    v_add_f32 v40, v40, v124
    v_add_f32 v41, v41, v125
    v_cvt_pk_bf16_f32 v41, v40, v41
    v_lshlrev_b32 v40, 16, v41
    v_and_b32 v41, 0xffff0000, v41
    v_sub_f32 v42, v42, v76
    v_sub_f32 v43, v43, v76
    v_cvt_pk_bf16_f32 v43, v42, v43
    v_lshlrev_b32 v42, 16, v43
    v_and_b32 v43, 0xffff0000, v43
    v_mul_f32 v42, v42, v77
    v_mul_f32 v43, v43, v77
    v_cvt_pk_bf16_f32 v43, v42, v43
    v_lshlrev_b32 v42, 16, v43
    v_and_b32 v43, 0xffff0000, v43
    v_mul_f32 v42, v42, v150
    v_mul_f32 v43, v43, v151
    v_cvt_pk_bf16_f32 v43, v42, v43
    v_lshlrev_b32 v42, 16, v43
    v_and_b32 v43, 0xffff0000, v43
    v_add_f32 v42, v42, v126
    v_add_f32 v43, v43, v127
    v_cvt_pk_bf16_f32 v43, v42, v43
    v_lshlrev_b32 v42, 16, v43
    v_and_b32 v43, 0xffff0000, v43
    s_waitcnt vmcnt(0)
    v_cvt_pk_bf16_f32 v8, v20, v21
    v_cvt_pk_bf16_f32 v9, v22, v23
    v_cvt_pk_bf16_f32 v10, v24, v25
    v_cvt_pk_bf16_f32 v11, v26, v27
    v_cvt_pk_bf16_f32 v12, v28, v29
    v_cvt_pk_bf16_f32 v13, v30, v31
    v_cvt_pk_bf16_f32 v14, v32, v33
    v_cvt_pk_bf16_f32 v15, v34, v35
    v_cvt_pk_bf16_f32 v16, v36, v37
    v_cvt_pk_bf16_f32 v17, v38, v39
    v_cvt_pk_bf16_f32 v18, v40, v41
    v_cvt_pk_bf16_f32 v19, v42, v43
    buffer_store_dwordx4 v[8:11], v4, s[28:31], 0 offen offset:0
    buffer_store_dwordx4 v[12:15], v4, s[28:31], 0 offen offset:16
    buffer_store_dwordx4 v[16:19], v4, s[28:31], 0 offen offset:32
K3_END:
    s_endpgm
.globl gemm1_kernel
.p2align 8
.type gemm1_kernel,@function
gemm1_kernel:
    s_cmp_ge_u32 s2, 256
    s_cbranch_scc1 gemm1_kernel_END
    s_load_dwordx2 s[4:5], s[0:1], 32
    s_load_dwordx2 s[6:7], s[0:1], 80
    s_mov_b32 s20, 0
    s_mov_b32 s21, s2
    s_and_b32 s22, s21, 31
    s_lshr_b32 s23, s21, 5
    s_waitcnt lgkmcnt(0)
    s_add_u32 s8, s6, 11534336
    s_addc_u32 s9, s7, 0
    s_and_b32 s9, s9, 0xffff
    s_mov_b32 s10, 2359296
    s_mov_b32 s11, 0x20000
    s_mov_b32 s12, s4
    s_and_b32 s13, s5, 0xffff
    s_mov_b32 s14, 5308416
    s_mov_b32 s15, 0x20000
    s_add_u32 s16, s6, 16777216
    s_addc_u32 s17, s7, 0
    s_and_b32 s17, s17, 0xffff
    s_mov_b32 s18, 18874368
    s_mov_b32 s19, 0x20000
    v_and_b32 v1, 63, v0
    v_lshrrev_b32 v2, 6, v0
    v_and_b32 v3, 15, v1
    v_lshrrev_b32 v4, 4, v1
    s_lshl_b32 s24, s23, 8
    v_lshlrev_b32 v5, 5, v2
    v_add3_u32 v5, v5, s24, v3
    s_mov_b32 s25, 1152
    v_mul_lo_u32 v5, v5, s25
    v_lshlrev_b32 v6, 4, v4
    s_mul_i32 s26, s20, 1152
    v_add3_u32 v240, v5, v6, s26
    v_add_u32 v241, 18432, v240
    s_mul_i32 s27, s20, 5308416
    s_mul_i32 s28, s22, 288
    s_add_u32 s27, s27, s28
    v_add_u32 v5, 0, v0
    v_mul_u32_u24 v6, 3641, v5
    v_lshrrev_b32 v6, 16, v6
    v_mul_u32_u24 v7, 18, v6
    v_sub_u32 v7, v5, v7
    s_mov_b32 s29, 9216
    v_mul_lo_u32 v242, v6, s29
    v_lshlrev_b32 v5, 4, v7
    v_add3_u32 v242, v242, v5, s27
    v_mul_u32_u24 v247, 288, v6
    v_lshrrev_b32 v6, 3, v6
    v_lshlrev_b32 v6, 7, v6
    v_add3_u32 v247, v247, v6, v5
    v_add_u32 v5, 512, v0
    v_mul_u32_u24 v6, 3641, v5
    v_lshrrev_b32 v6, 16, v6
    v_mul_u32_u24 v7, 18, v6
    v_sub_u32 v7, v5, v7
    s_mov_b32 s29, 9216
    v_mul_lo_u32 v243, v6, s29
    v_lshlrev_b32 v5, 4, v7
    v_add3_u32 v243, v243, v5, s27
    v_mul_u32_u24 v248, 288, v6
    v_lshrrev_b32 v6, 3, v6
    v_lshlrev_b32 v6, 7, v6
    v_add3_u32 v248, v248, v6, v5
    v_add_u32 v5, 1024, v0
    v_mul_u32_u24 v6, 3641, v5
    v_lshrrev_b32 v6, 16, v6
    v_mul_u32_u24 v7, 18, v6
    v_sub_u32 v7, v5, v7
    s_mov_b32 s29, 9216
    v_mul_lo_u32 v244, v6, s29
    v_lshlrev_b32 v5, 4, v7
    v_add3_u32 v244, v244, v5, s27
    v_mul_u32_u24 v249, 288, v6
    v_lshrrev_b32 v6, 3, v6
    v_lshlrev_b32 v6, 7, v6
    v_add3_u32 v249, v249, v6, v5
    v_add_u32 v5, 1024, v0
    v_cmp_gt_u32 vcc, 1152, v5
    v_mov_b32 v6, 0x7ffffff0
    s_nop 0
    v_cndmask_b32 v244, v6, v244, vcc
    v_lshlrev_b32 v6, 4, v1
    v_add_u32 v6, 38912, v6
    v_cndmask_b32 v249, v6, v249, vcc
    v_lshrrev_b32 v5, 2, v3
    v_lshlrev_b32 v6, 3, v4
    v_add_u32 v5, v5, v6
    v_mul_u32_u24 v5, 288, v5
    v_lshlrev_b32 v6, 7, v4
    v_and_b32 v7, 3, v3
    v_lshlrev_b32 v7, 3, v7
    v_add3_u32 v252, v5, v6, v7
    s_mov_b32 s30, 0
    buffer_load_dwordx4 v[128:131], v242, s[12:15], s30 offen
    buffer_load_dwordx4 v[132:135], v243, s[12:15], s30 offen
    buffer_load_dwordx4 v[136:139], v244, s[12:15], s30 offen
    buffer_load_dwordx4 v[80:83], v240, s[8:11], 0 offen offset:0
    buffer_load_dwordx4 v[84:87], v241, s[8:11], 0 offen offset:0
    buffer_load_dwordx4 v[88:91], v240, s[8:11], 0 offen offset:64
    buffer_load_dwordx4 v[92:95], v241, s[8:11], 0 offen offset:64
    s_mov_b32 s30, 589824
    buffer_load_dwordx4 v[148:151], v242, s[12:15], s30 offen
    buffer_load_dwordx4 v[152:155], v243, s[12:15], s30 offen
    buffer_load_dwordx4 v[156:159], v244, s[12:15], s30 offen
    buffer_load_dwordx4 v[96:99], v240, s[8:11], 0 offen offset:128
    buffer_load_dwordx4 v[100:103], v241, s[8:11], 0 offen offset:128
    buffer_load_dwordx4 v[104:107], v240, s[8:11], 0 offen offset:192
    buffer_load_dwordx4 v[108:111], v241, s[8:11], 0 offen offset:192
    s_waitcnt vmcnt(11)
    ds_write_b128 v247, v[128:131] offset:0
    ds_write_b128 v248, v[132:135] offset:0
    ds_write_b128 v249, v[136:139] offset:0
    s_mov_b32 s30, 1179648
    buffer_load_dwordx4 v[128:131], v242, s[12:15], s30 offen
    buffer_load_dwordx4 v[132:135], v243, s[12:15], s30 offen
    buffer_load_dwordx4 v[136:139], v244, s[12:15], s30 offen
    s_waitcnt lgkmcnt(0)
    s_barrier
    ds_read_b64_tr_b16 v[168:169], v252 offset:0
    ds_read_b64_tr_b16 v[170:171], v252 offset:1152
    ds_read_b64_tr_b16 v[172:173], v252 offset:32
    ds_read_b64_tr_b16 v[174:175], v252 offset:1184
    ds_read_b64_tr_b16 v[176:177], v252 offset:64
    ds_read_b64_tr_b16 v[178:179], v252 offset:1216
    ds_read_b64_tr_b16 v[180:181], v252 offset:96
    ds_read_b64_tr_b16 v[182:183], v252 offset:1248
    ds_read_b64_tr_b16 v[184:185], v252 offset:128
    ds_read_b64_tr_b16 v[186:187], v252 offset:1280
    ds_read_b64_tr_b16 v[188:189], v252 offset:160
    ds_read_b64_tr_b16 v[190:191], v252 offset:1312
    ds_read_b64_tr_b16 v[192:193], v252 offset:192
    ds_read_b64_tr_b16 v[194:195], v252 offset:1344
    ds_read_b64_tr_b16 v[196:197], v252 offset:224
    ds_read_b64_tr_b16 v[198:199], v252 offset:1376
    ds_read_b64_tr_b16 v[200:201], v252 offset:256
    ds_read_b64_tr_b16 v[202:203], v252 offset:1408
    s_waitcnt vmcnt(10)
    s_waitcnt lgkmcnt(15)
    v_mfma_f32_16x16x32_bf16 v[8:11], v[168:171], v[80:83], 0
    v_mfma_f32_16x16x32_bf16 v[44:47], v[168:171], v[84:87], 0
    ds_read_b64_tr_b16 v[204:205], v252 offset:9728
    ds_read_b64_tr_b16 v[206:207], v252 offset:10880
    s_waitcnt lgkmcnt(15)
    v_mfma_f32_16x16x32_bf16 v[12:15], v[172:175], v[80:83], 0
    v_mfma_f32_16x16x32_bf16 v[48:51], v[172:175], v[84:87], 0
    ds_read_b64_tr_b16 v[208:209], v252 offset:9760
    ds_read_b64_tr_b16 v[210:211], v252 offset:10912
    s_waitcnt lgkmcnt(15)
    v_mfma_f32_16x16x32_bf16 v[16:19], v[176:179], v[80:83], 0
    v_mfma_f32_16x16x32_bf16 v[52:55], v[176:179], v[84:87], 0
    ds_read_b64_tr_b16 v[212:213], v252 offset:9792
    ds_read_b64_tr_b16 v[214:215], v252 offset:10944
    s_waitcnt lgkmcnt(15)
    v_mfma_f32_16x16x32_bf16 v[20:23], v[180:183], v[80:83], 0
    v_mfma_f32_16x16x32_bf16 v[56:59], v[180:183], v[84:87], 0
    ds_read_b64_tr_b16 v[216:217], v252 offset:9824
    ds_read_b64_tr_b16 v[218:219], v252 offset:10976
    s_waitcnt lgkmcnt(15)
    v_mfma_f32_16x16x32_bf16 v[24:27], v[184:187], v[80:83], 0
    v_mfma_f32_16x16x32_bf16 v[60:63], v[184:187], v[84:87], 0
    ds_read_b64_tr_b16 v[220:221], v252 offset:9856
    ds_read_b64_tr_b16 v[222:223], v252 offset:11008
    s_waitcnt lgkmcnt(15)
    v_mfma_f32_16x16x32_bf16 v[28:31], v[188:191], v[80:83], 0
    v_mfma_f32_16x16x32_bf16 v[64:67], v[188:191], v[84:87], 0
    ds_read_b64_tr_b16 v[224:225], v252 offset:9888
    ds_read_b64_tr_b16 v[226:227], v252 offset:11040
    s_waitcnt lgkmcnt(15)
    v_mfma_f32_16x16x32_bf16 v[32:35], v[192:195], v[80:83], 0
    v_mfma_f32_16x16x32_bf16 v[68:71], v[192:195], v[84:87], 0
    ds_read_b64_tr_b16 v[228:229], v252 offset:9920
    ds_read_b64_tr_b16 v[230:231], v252 offset:11072
    s_waitcnt lgkmcnt(15)
    v_mfma_f32_16x16x32_bf16 v[36:39], v[196:199], v[80:83], 0
    v_mfma_f32_16x16x32_bf16 v[72:75], v[196:199], v[84:87], 0
    ds_read_b64_tr_b16 v[232:233], v252 offset:9952
    ds_read_b64_tr_b16 v[234:235], v252 offset:11104
    s_waitcnt lgkmcnt(15)
    v_mfma_f32_16x16x32_bf16 v[40:43], v[200:203], v[80:83], 0
    v_mfma_f32_16x16x32_bf16 v[76:79], v[200:203], v[84:87], 0
    ds_read_b64_tr_b16 v[236:237], v252 offset:9984
    ds_read_b64_tr_b16 v[238:239], v252 offset:11136
    s_waitcnt lgkmcnt(15)
    v_mfma_f32_16x16x32_bf16 v[8:11], v[204:207], v[88:91], v[8:11]
    v_mfma_f32_16x16x32_bf16 v[44:47], v[204:207], v[92:95], v[44:47]
    s_waitcnt vmcnt(7)
    ds_write_b128 v247, v[148:151] offset:19456
    s_waitcnt lgkmcnt(15)
    v_mfma_f32_16x16x32_bf16 v[12:15], v[208:211], v[88:91], v[12:15]
    v_mfma_f32_16x16x32_bf16 v[48:51], v[208:211], v[92:95], v[48:51]
    ds_write_b128 v248, v[152:155] offset:19456
    ds_write_b128 v249, v[156:159] offset:19456
    s_waitcnt lgkmcnt(15)
    v_mfma_f32_16x16x32_bf16 v[16:19], v[212:215], v[88:91], v[16:19]
    v_mfma_f32_16x16x32_bf16 v[52:55], v[212:215], v[92:95], v[52:55]
    s_mov_b32 s30, 1769472
    buffer_load_dwordx4 v[148:151], v242, s[12:15], s30 offen
    s_waitcnt lgkmcnt(13)
    v_mfma_f32_16x16x32_bf16 v[20:23], v[216:219], v[88:91], v[20:23]
    v_mfma_f32_16x16x32_bf16 v[56:59], v[216:219], v[92:95], v[56:59]
    buffer_load_dwordx4 v[152:155], v243, s[12:15], s30 offen
    buffer_load_dwordx4 v[156:159], v244, s[12:15], s30 offen
    s_waitcnt lgkmcnt(11)
    v_mfma_f32_16x16x32_bf16 v[24:27], v[220:223], v[88:91], v[24:27]
    v_mfma_f32_16x16x32_bf16 v[60:63], v[220:223], v[92:95], v[60:63]
    buffer_load_dwordx4 v[112:115], v240, s[8:11], 0 offen offset:256
    buffer_load_dwordx4 v[116:119], v241, s[8:11], 0 offen offset:256
    s_waitcnt lgkmcnt(9)
    v_mfma_f32_16x16x32_bf16 v[28:31], v[224:227], v[88:91], v[28:31]
    v_mfma_f32_16x16x32_bf16 v[64:67], v[224:227], v[92:95], v[64:67]
    buffer_load_dwordx4 v[120:123], v240, s[8:11], 0 offen offset:320
    buffer_load_dwordx4 v[124:127], v241, s[8:11], 0 offen offset:320
    s_waitcnt lgkmcnt(7)
    v_mfma_f32_16x16x32_bf16 v[32:35], v[228:231], v[88:91], v[32:35]
    v_mfma_f32_16x16x32_bf16 v[68:71], v[228:231], v[92:95], v[68:71]
    s_waitcnt lgkmcnt(5)
    v_mfma_f32_16x16x32_bf16 v[36:39], v[232:235], v[88:91], v[36:39]
    v_mfma_f32_16x16x32_bf16 v[72:75], v[232:235], v[92:95], v[72:75]
    s_waitcnt lgkmcnt(3)
    v_mfma_f32_16x16x32_bf16 v[40:43], v[236:239], v[88:91], v[40:43]
    v_mfma_f32_16x16x32_bf16 v[76:79], v[236:239], v[92:95], v[76:79]
    s_waitcnt lgkmcnt(0)
    s_barrier
    ds_read_b64_tr_b16 v[168:169], v252 offset:19456
    ds_read_b64_tr_b16 v[170:171], v252 offset:20608
    ds_read_b64_tr_b16 v[172:173], v252 offset:19488
    ds_read_b64_tr_b16 v[174:175], v252 offset:20640
    ds_read_b64_tr_b16 v[176:177], v252 offset:19520
    ds_read_b64_tr_b16 v[178:179], v252 offset:20672
    ds_read_b64_tr_b16 v[180:181], v252 offset:19552
    ds_read_b64_tr_b16 v[182:183], v252 offset:20704
    ds_read_b64_tr_b16 v[184:185], v252 offset:19584
    ds_read_b64_tr_b16 v[186:187], v252 offset:20736
    ds_read_b64_tr_b16 v[188:189], v252 offset:19616
    ds_read_b64_tr_b16 v[190:191], v252 offset:20768
    ds_read_b64_tr_b16 v[192:193], v252 offset:19648
    ds_read_b64_tr_b16 v[194:195], v252 offset:20800
    ds_read_b64_tr_b16 v[196:197], v252 offset:19680
    ds_read_b64_tr_b16 v[198:199], v252 offset:20832
    ds_read_b64_tr_b16 v[200:201], v252 offset:19712
    ds_read_b64_tr_b16 v[202:203], v252 offset:20864
    s_waitcnt vmcnt(10)
    s_waitcnt lgkmcnt(15)
    v_mfma_f32_16x16x32_bf16 v[8:11], v[168:171], v[96:99], v[8:11]
    v_mfma_f32_16x16x32_bf16 v[44:47], v[168:171], v[100:103], v[44:47]
    ds_read_b64_tr_b16 v[204:205], v252 offset:29184
    ds_read_b64_tr_b16 v[206:207], v252 offset:30336
    s_waitcnt lgkmcnt(15)
    v_mfma_f32_16x16x32_bf16 v[12:15], v[172:175], v[96:99], v[12:15]
    v_mfma_f32_16x16x32_bf16 v[48:51], v[172:175], v[100:103], v[48:51]
    ds_read_b64_tr_b16 v[208:209], v252 offset:29216
    ds_read_b64_tr_b16 v[210:211], v252 offset:30368
    s_waitcnt lgkmcnt(15)
    v_mfma_f32_16x16x32_bf16 v[16:19], v[176:179], v[96:99], v[16:19]
    v_mfma_f32_16x16x32_bf16 v[52:55], v[176:179], v[100:103], v[52:55]
    ds_read_b64_tr_b16 v[212:213], v252 offset:29248
    ds_read_b64_tr_b16 v[214:215], v252 offset:30400
    s_waitcnt lgkmcnt(15)
    v_mfma_f32_16x16x32_bf16 v[20:23], v[180:183], v[96:99], v[20:23]
    v_mfma_f32_16x16x32_bf16 v[56:59], v[180:183], v[100:103], v[56:59]
    ds_read_b64_tr_b16 v[216:217], v252 offset:29280
    ds_read_b64_tr_b16 v[218:219], v252 offset:30432
    s_waitcnt lgkmcnt(15)
    v_mfma_f32_16x16x32_bf16 v[24:27], v[184:187], v[96:99], v[24:27]
    v_mfma_f32_16x16x32_bf16 v[60:63], v[184:187], v[100:103], v[60:63]
    ds_read_b64_tr_b16 v[220:221], v252 offset:29312
    ds_read_b64_tr_b16 v[222:223], v252 offset:30464
    s_waitcnt lgkmcnt(15)
    v_mfma_f32_16x16x32_bf16 v[28:31], v[188:191], v[96:99], v[28:31]
    v_mfma_f32_16x16x32_bf16 v[64:67], v[188:191], v[100:103], v[64:67]
    ds_read_b64_tr_b16 v[224:225], v252 offset:29344
    ds_read_b64_tr_b16 v[226:227], v252 offset:30496
    s_waitcnt lgkmcnt(15)
    v_mfma_f32_16x16x32_bf16 v[32:35], v[192:195], v[96:99], v[32:35]
    v_mfma_f32_16x16x32_bf16 v[68:71], v[192:195], v[100:103], v[68:71]
    ds_read_b64_tr_b16 v[228:229], v252 offset:29376
    ds_read_b64_tr_b16 v[230:231], v252 offset:30528
    s_waitcnt lgkmcnt(15)
    v_mfma_f32_16x16x32_bf16 v[36:39], v[196:199], v[96:99], v[36:39]
    v_mfma_f32_16x16x32_bf16 v[72:75], v[196:199], v[100:103], v[72:75]
    ds_read_b64_tr_b16 v[232:233], v252 offset:29408
    ds_read_b64_tr_b16 v[234:235], v252 offset:30560
    s_waitcnt lgkmcnt(15)
    v_mfma_f32_16x16x32_bf16 v[40:43], v[200:203], v[96:99], v[40:43]
    v_mfma_f32_16x16x32_bf16 v[76:79], v[200:203], v[100:103], v[76:79]
    ds_read_b64_tr_b16 v[236:237], v252 offset:29440
    ds_read_b64_tr_b16 v[238:239], v252 offset:30592
    s_waitcnt lgkmcnt(15)
    v_mfma_f32_16x16x32_bf16 v[8:11], v[204:207], v[104:107], v[8:11]
    v_mfma_f32_16x16x32_bf16 v[44:47], v[204:207], v[108:111], v[44:47]
    s_waitcnt vmcnt(7)
    ds_write_b128 v247, v[128:131] offset:0
    s_waitcnt lgkmcnt(15)
    v_mfma_f32_16x16x32_bf16 v[12:15], v[208:211], v[104:107], v[12:15]
    v_mfma_f32_16x16x32_bf16 v[48:51], v[208:211], v[108:111], v[48:51]
    ds_write_b128 v248, v[132:135] offset:0
    ds_write_b128 v249, v[136:139] offset:0
    s_waitcnt lgkmcnt(15)
    v_mfma_f32_16x16x32_bf16 v[16:19], v[212:215], v[104:107], v[16:19]
    v_mfma_f32_16x16x32_bf16 v[52:55], v[212:215], v[108:111], v[52:55]
    s_mov_b32 s30, 2359296
    buffer_load_dwordx4 v[128:131], v242, s[12:15], s30 offen
    s_waitcnt lgkmcnt(13)
    v_mfma_f32_16x16x32_bf16 v[20:23], v[216:219], v[104:107], v[20:23]
    v_mfma_f32_16x16x32_bf16 v[56:59], v[216:219], v[108:111], v[56:59]
    buffer_load_dwordx4 v[132:135], v243, s[12:15], s30 offen
    buffer_load_dwordx4 v[136:139], v244, s[12:15], s30 offen
    s_waitcnt lgkmcnt(11)
    v_mfma_f32_16x16x32_bf16 v[24:27], v[220:223], v[104:107], v[24:27]
    v_mfma_f32_16x16x32_bf16 v[60:63], v[220:223], v[108:111], v[60:63]
    buffer_load_dwordx4 v[80:83], v240, s[8:11], 0 offen offset:384
    buffer_load_dwordx4 v[84:87], v241, s[8:11], 0 offen offset:384
    s_waitcnt lgkmcnt(9)
    v_mfma_f32_16x16x32_bf16 v[28:31], v[224:227], v[104:107], v[28:31]
    v_mfma_f32_16x16x32_bf16 v[64:67], v[224:227], v[108:111], v[64:67]
    buffer_load_dwordx4 v[88:91], v240, s[8:11], 0 offen offset:448
    buffer_load_dwordx4 v[92:95], v241, s[8:11], 0 offen offset:448
    s_waitcnt lgkmcnt(7)
    v_mfma_f32_16x16x32_bf16 v[32:35], v[228:231], v[104:107], v[32:35]
    v_mfma_f32_16x16x32_bf16 v[68:71], v[228:231], v[108:111], v[68:71]
    s_waitcnt lgkmcnt(5)
    v_mfma_f32_16x16x32_bf16 v[36:39], v[232:235], v[104:107], v[36:39]
    v_mfma_f32_16x16x32_bf16 v[72:75], v[232:235], v[108:111], v[72:75]
    s_waitcnt lgkmcnt(3)
    v_mfma_f32_16x16x32_bf16 v[40:43], v[236:239], v[104:107], v[40:43]
    v_mfma_f32_16x16x32_bf16 v[76:79], v[236:239], v[108:111], v[76:79]
    s_waitcnt lgkmcnt(0)
    s_barrier
    ds_read_b64_tr_b16 v[168:169], v252 offset:0
    ds_read_b64_tr_b16 v[170:171], v252 offset:1152
    ds_read_b64_tr_b16 v[172:173], v252 offset:32
    ds_read_b64_tr_b16 v[174:175], v252 offset:1184
    ds_read_b64_tr_b16 v[176:177], v252 offset:64
    ds_read_b64_tr_b16 v[178:179], v252 offset:1216
    ds_read_b64_tr_b16 v[180:181], v252 offset:96
    ds_read_b64_tr_b16 v[182:183], v252 offset:1248
    ds_read_b64_tr_b16 v[184:185], v252 offset:128
    ds_read_b64_tr_b16 v[186:187], v252 offset:1280
    ds_read_b64_tr_b16 v[188:189], v252 offset:160
    ds_read_b64_tr_b16 v[190:191], v252 offset:1312
    ds_read_b64_tr_b16 v[192:193], v252 offset:192
    ds_read_b64_tr_b16 v[194:195], v252 offset:1344
    ds_read_b64_tr_b16 v[196:197], v252 offset:224
    ds_read_b64_tr_b16 v[198:199], v252 offset:1376
    ds_read_b64_tr_b16 v[200:201], v252 offset:256
    ds_read_b64_tr_b16 v[202:203], v252 offset:1408
    s_waitcnt vmcnt(7)
    s_waitcnt lgkmcnt(15)
    v_mfma_f32_16x16x32_bf16 v[8:11], v[168:171], v[112:115], v[8:11]
    v_mfma_f32_16x16x32_bf16 v[44:47], v[168:171], v[116:119], v[44:47]
    ds_read_b64_tr_b16 v[204:205], v252 offset:9728
    ds_read_b64_tr_b16 v[206:207], v252 offset:10880
    s_waitcnt lgkmcnt(15)
    v_mfma_f32_16x16x32_bf16 v[12:15], v[172:175], v[112:115], v[12:15]
    v_mfma_f32_16x16x32_bf16 v[48:51], v[172:175], v[116:119], v[48:51]
    ds_read_b64_tr_b16 v[208:209], v252 offset:9760
    ds_read_b64_tr_b16 v[210:211], v252 offset:10912
    s_waitcnt lgkmcnt(15)
    v_mfma_f32_16x16x32_bf16 v[16:19], v[176:179], v[112:115], v[16:19]
    v_mfma_f32_16x16x32_bf16 v[52:55], v[176:179], v[116:119], v[52:55]
    ds_read_b64_tr_b16 v[212:213], v252 offset:9792
    ds_read_b64_tr_b16 v[214:215], v252 offset:10944
    s_waitcnt lgkmcnt(15)
    v_mfma_f32_16x16x32_bf16 v[20:23], v[180:183], v[112:115], v[20:23]
    v_mfma_f32_16x16x32_bf16 v[56:59], v[180:183], v[116:119], v[56:59]
    ds_read_b64_tr_b16 v[216:217], v252 offset:9824
    ds_read_b64_tr_b16 v[218:219], v252 offset:10976
    s_waitcnt lgkmcnt(15)
    v_mfma_f32_16x16x32_bf16 v[24:27], v[184:187], v[112:115], v[24:27]
    v_mfma_f32_16x16x32_bf16 v[60:63], v[184:187], v[116:119], v[60:63]
    ds_read_b64_tr_b16 v[220:221], v252 offset:9856
    ds_read_b64_tr_b16 v[222:223], v252 offset:11008
    s_waitcnt lgkmcnt(15)
    v_mfma_f32_16x16x32_bf16 v[28:31], v[188:191], v[112:115], v[28:31]
    v_mfma_f32_16x16x32_bf16 v[64:67], v[188:191], v[116:119], v[64:67]
    ds_read_b64_tr_b16 v[224:225], v252 offset:9888
    ds_read_b64_tr_b16 v[226:227], v252 offset:11040
    s_waitcnt lgkmcnt(15)
    v_mfma_f32_16x16x32_bf16 v[32:35], v[192:195], v[112:115], v[32:35]
    v_mfma_f32_16x16x32_bf16 v[68:71], v[192:195], v[116:119], v[68:71]
    ds_read_b64_tr_b16 v[228:229], v252 offset:9920
    ds_read_b64_tr_b16 v[230:231], v252 offset:11072
    s_waitcnt lgkmcnt(15)
    v_mfma_f32_16x16x32_bf16 v[36:39], v[196:199], v[112:115], v[36:39]
    v_mfma_f32_16x16x32_bf16 v[72:75], v[196:199], v[116:119], v[72:75]
    ds_read_b64_tr_b16 v[232:233], v252 offset:9952
    ds_read_b64_tr_b16 v[234:235], v252 offset:11104
    s_waitcnt lgkmcnt(15)
    v_mfma_f32_16x16x32_bf16 v[40:43], v[200:203], v[112:115], v[40:43]
    v_mfma_f32_16x16x32_bf16 v[76:79], v[200:203], v[116:119], v[76:79]
    ds_read_b64_tr_b16 v[236:237], v252 offset:9984
    ds_read_b64_tr_b16 v[238:239], v252 offset:11136
    s_waitcnt lgkmcnt(15)
    v_mfma_f32_16x16x32_bf16 v[8:11], v[204:207], v[120:123], v[8:11]
    v_mfma_f32_16x16x32_bf16 v[44:47], v[204:207], v[124:127], v[44:47]
    s_waitcnt vmcnt(11)
    ds_write_b128 v247, v[148:151] offset:19456
    s_waitcnt lgkmcnt(15)
    v_mfma_f32_16x16x32_bf16 v[12:15], v[208:211], v[120:123], v[12:15]
    v_mfma_f32_16x16x32_bf16 v[48:51], v[208:211], v[124:127], v[48:51]
    ds_write_b128 v248, v[152:155] offset:19456
    ds_write_b128 v249, v[156:159] offset:19456
    s_waitcnt lgkmcnt(15)
    v_mfma_f32_16x16x32_bf16 v[16:19], v[212:215], v[120:123], v[16:19]
    v_mfma_f32_16x16x32_bf16 v[52:55], v[212:215], v[124:127], v[52:55]
    s_mov_b32 s30, 2949120
    buffer_load_dwordx4 v[148:151], v242, s[12:15], s30 offen
    s_waitcnt lgkmcnt(13)
    v_mfma_f32_16x16x32_bf16 v[20:23], v[216:219], v[120:123], v[20:23]
    v_mfma_f32_16x16x32_bf16 v[56:59], v[216:219], v[124:127], v[56:59]
    buffer_load_dwordx4 v[152:155], v243, s[12:15], s30 offen
    buffer_load_dwordx4 v[156:159], v244, s[12:15], s30 offen
    s_waitcnt lgkmcnt(11)
    v_mfma_f32_16x16x32_bf16 v[24:27], v[220:223], v[120:123], v[24:27]
    v_mfma_f32_16x16x32_bf16 v[60:63], v[220:223], v[124:127], v[60:63]
    buffer_load_dwordx4 v[96:99], v240, s[8:11], 0 offen offset:512
    buffer_load_dwordx4 v[100:103], v241, s[8:11], 0 offen offset:512
    s_waitcnt lgkmcnt(9)
    v_mfma_f32_16x16x32_bf16 v[28:31], v[224:227], v[120:123], v[28:31]
    v_mfma_f32_16x16x32_bf16 v[64:67], v[224:227], v[124:127], v[64:67]
    buffer_load_dwordx4 v[104:107], v240, s[8:11], 0 offen offset:576
    buffer_load_dwordx4 v[108:111], v241, s[8:11], 0 offen offset:576
    s_waitcnt lgkmcnt(7)
    v_mfma_f32_16x16x32_bf16 v[32:35], v[228:231], v[120:123], v[32:35]
    v_mfma_f32_16x16x32_bf16 v[68:71], v[228:231], v[124:127], v[68:71]
    s_waitcnt lgkmcnt(5)
    v_mfma_f32_16x16x32_bf16 v[36:39], v[232:235], v[120:123], v[36:39]
    v_mfma_f32_16x16x32_bf16 v[72:75], v[232:235], v[124:127], v[72:75]
    s_waitcnt lgkmcnt(3)
    v_mfma_f32_16x16x32_bf16 v[40:43], v[236:239], v[120:123], v[40:43]
    v_mfma_f32_16x16x32_bf16 v[76:79], v[236:239], v[124:127], v[76:79]
    s_waitcnt lgkmcnt(0)
    s_barrier
    ds_read_b64_tr_b16 v[168:169], v252 offset:19456
    ds_read_b64_tr_b16 v[170:171], v252 offset:20608
    ds_read_b64_tr_b16 v[172:173], v252 offset:19488
    ds_read_b64_tr_b16 v[174:175], v252 offset:20640
    ds_read_b64_tr_b16 v[176:177], v252 offset:19520
    ds_read_b64_tr_b16 v[178:179], v252 offset:20672
    ds_read_b64_tr_b16 v[180:181], v252 offset:19552
    ds_read_b64_tr_b16 v[182:183], v252 offset:20704
    ds_read_b64_tr_b16 v[184:185], v252 offset:19584
    ds_read_b64_tr_b16 v[186:187], v252 offset:20736
    ds_read_b64_tr_b16 v[188:189], v252 offset:19616
    ds_read_b64_tr_b16 v[190:191], v252 offset:20768
    ds_read_b64_tr_b16 v[192:193], v252 offset:19648
    ds_read_b64_tr_b16 v[194:195], v252 offset:20800
    ds_read_b64_tr_b16 v[196:197], v252 offset:19680
    ds_read_b64_tr_b16 v[198:199], v252 offset:20832
    ds_read_b64_tr_b16 v[200:201], v252 offset:19712
    ds_read_b64_tr_b16 v[202:203], v252 offset:20864
    s_waitcnt vmcnt(7)
    s_waitcnt lgkmcnt(15)
    v_mfma_f32_16x16x32_bf16 v[8:11], v[168:171], v[80:83], v[8:11]
    v_mfma_f32_16x16x32_bf16 v[44:47], v[168:171], v[84:87], v[44:47]
    ds_read_b64_tr_b16 v[204:205], v252 offset:29184
    ds_read_b64_tr_b16 v[206:207], v252 offset:30336
    s_waitcnt lgkmcnt(15)
    v_mfma_f32_16x16x32_bf16 v[12:15], v[172:175], v[80:83], v[12:15]
    v_mfma_f32_16x16x32_bf16 v[48:51], v[172:175], v[84:87], v[48:51]
    ds_read_b64_tr_b16 v[208:209], v252 offset:29216
    ds_read_b64_tr_b16 v[210:211], v252 offset:30368
    s_waitcnt lgkmcnt(15)
    v_mfma_f32_16x16x32_bf16 v[16:19], v[176:179], v[80:83], v[16:19]
    v_mfma_f32_16x16x32_bf16 v[52:55], v[176:179], v[84:87], v[52:55]
    ds_read_b64_tr_b16 v[212:213], v252 offset:29248
    ds_read_b64_tr_b16 v[214:215], v252 offset:30400
    s_waitcnt lgkmcnt(15)
    v_mfma_f32_16x16x32_bf16 v[20:23], v[180:183], v[80:83], v[20:23]
    v_mfma_f32_16x16x32_bf16 v[56:59], v[180:183], v[84:87], v[56:59]
    ds_read_b64_tr_b16 v[216:217], v252 offset:29280
    ds_read_b64_tr_b16 v[218:219], v252 offset:30432
    s_waitcnt lgkmcnt(15)
    v_mfma_f32_16x16x32_bf16 v[24:27], v[184:187], v[80:83], v[24:27]
    v_mfma_f32_16x16x32_bf16 v[60:63], v[184:187], v[84:87], v[60:63]
    ds_read_b64_tr_b16 v[220:221], v252 offset:29312
    ds_read_b64_tr_b16 v[222:223], v252 offset:30464
    s_waitcnt lgkmcnt(15)
    v_mfma_f32_16x16x32_bf16 v[28:31], v[188:191], v[80:83], v[28:31]
    v_mfma_f32_16x16x32_bf16 v[64:67], v[188:191], v[84:87], v[64:67]
    ds_read_b64_tr_b16 v[224:225], v252 offset:29344
    ds_read_b64_tr_b16 v[226:227], v252 offset:30496
    s_waitcnt lgkmcnt(15)
    v_mfma_f32_16x16x32_bf16 v[32:35], v[192:195], v[80:83], v[32:35]
    v_mfma_f32_16x16x32_bf16 v[68:71], v[192:195], v[84:87], v[68:71]
    ds_read_b64_tr_b16 v[228:229], v252 offset:29376
    ds_read_b64_tr_b16 v[230:231], v252 offset:30528
    s_waitcnt lgkmcnt(15)
    v_mfma_f32_16x16x32_bf16 v[36:39], v[196:199], v[80:83], v[36:39]
    v_mfma_f32_16x16x32_bf16 v[72:75], v[196:199], v[84:87], v[72:75]
    ds_read_b64_tr_b16 v[232:233], v252 offset:29408
    ds_read_b64_tr_b16 v[234:235], v252 offset:30560
    s_waitcnt lgkmcnt(15)
    v_mfma_f32_16x16x32_bf16 v[40:43], v[200:203], v[80:83], v[40:43]
    v_mfma_f32_16x16x32_bf16 v[76:79], v[200:203], v[84:87], v[76:79]
    ds_read_b64_tr_b16 v[236:237], v252 offset:29440
    ds_read_b64_tr_b16 v[238:239], v252 offset:30592
    s_waitcnt lgkmcnt(15)
    v_mfma_f32_16x16x32_bf16 v[8:11], v[204:207], v[88:91], v[8:11]
    v_mfma_f32_16x16x32_bf16 v[44:47], v[204:207], v[92:95], v[44:47]
    s_waitcnt vmcnt(11)
    ds_write_b128 v247, v[128:131] offset:0
    s_waitcnt lgkmcnt(15)
    v_mfma_f32_16x16x32_bf16 v[12:15], v[208:211], v[88:91], v[12:15]
    v_mfma_f32_16x16x32_bf16 v[48:51], v[208:211], v[92:95], v[48:51]
    ds_write_b128 v248, v[132:135] offset:0
    ds_write_b128 v249, v[136:139] offset:0
    s_waitcnt lgkmcnt(15)
    v_mfma_f32_16x16x32_bf16 v[16:19], v[212:215], v[88:91], v[16:19]
    v_mfma_f32_16x16x32_bf16 v[52:55], v[212:215], v[92:95], v[52:55]
    s_mov_b32 s30, 3538944
    buffer_load_dwordx4 v[128:131], v242, s[12:15], s30 offen
    s_waitcnt lgkmcnt(13)
    v_mfma_f32_16x16x32_bf16 v[20:23], v[216:219], v[88:91], v[20:23]
    v_mfma_f32_16x16x32_bf16 v[56:59], v[216:219], v[92:95], v[56:59]
    buffer_load_dwordx4 v[132:135], v243, s[12:15], s30 offen
    buffer_load_dwordx4 v[136:139], v244, s[12:15], s30 offen
    s_waitcnt lgkmcnt(11)
    v_mfma_f32_16x16x32_bf16 v[24:27], v[220:223], v[88:91], v[24:27]
    v_mfma_f32_16x16x32_bf16 v[60:63], v[220:223], v[92:95], v[60:63]
    buffer_load_dwordx4 v[112:115], v240, s[8:11], 0 offen offset:640
    buffer_load_dwordx4 v[116:119], v241, s[8:11], 0 offen offset:640
    s_waitcnt lgkmcnt(9)
    v_mfma_f32_16x16x32_bf16 v[28:31], v[224:227], v[88:91], v[28:31]
    v_mfma_f32_16x16x32_bf16 v[64:67], v[224:227], v[92:95], v[64:67]
    buffer_load_dwordx4 v[120:123], v240, s[8:11], 0 offen offset:704
    buffer_load_dwordx4 v[124:127], v241, s[8:11], 0 offen offset:704
    s_waitcnt lgkmcnt(7)
    v_mfma_f32_16x16x32_bf16 v[32:35], v[228:231], v[88:91], v[32:35]
    v_mfma_f32_16x16x32_bf16 v[68:71], v[228:231], v[92:95], v[68:71]
    s_waitcnt lgkmcnt(5)
    v_mfma_f32_16x16x32_bf16 v[36:39], v[232:235], v[88:91], v[36:39]
    v_mfma_f32_16x16x32_bf16 v[72:75], v[232:235], v[92:95], v[72:75]
    s_waitcnt lgkmcnt(3)
    v_mfma_f32_16x16x32_bf16 v[40:43], v[236:239], v[88:91], v[40:43]
    v_mfma_f32_16x16x32_bf16 v[76:79], v[236:239], v[92:95], v[76:79]
    s_waitcnt lgkmcnt(0)
    s_barrier
    ds_read_b64_tr_b16 v[168:169], v252 offset:0
    ds_read_b64_tr_b16 v[170:171], v252 offset:1152
    ds_read_b64_tr_b16 v[172:173], v252 offset:32
    ds_read_b64_tr_b16 v[174:175], v252 offset:1184
    ds_read_b64_tr_b16 v[176:177], v252 offset:64
    ds_read_b64_tr_b16 v[178:179], v252 offset:1216
    ds_read_b64_tr_b16 v[180:181], v252 offset:96
    ds_read_b64_tr_b16 v[182:183], v252 offset:1248
    ds_read_b64_tr_b16 v[184:185], v252 offset:128
    ds_read_b64_tr_b16 v[186:187], v252 offset:1280
    ds_read_b64_tr_b16 v[188:189], v252 offset:160
    ds_read_b64_tr_b16 v[190:191], v252 offset:1312
    ds_read_b64_tr_b16 v[192:193], v252 offset:192
    ds_read_b64_tr_b16 v[194:195], v252 offset:1344
    ds_read_b64_tr_b16 v[196:197], v252 offset:224
    ds_read_b64_tr_b16 v[198:199], v252 offset:1376
    ds_read_b64_tr_b16 v[200:201], v252 offset:256
    ds_read_b64_tr_b16 v[202:203], v252 offset:1408
    s_waitcnt vmcnt(7)
    s_waitcnt lgkmcnt(15)
    v_mfma_f32_16x16x32_bf16 v[8:11], v[168:171], v[96:99], v[8:11]
    v_mfma_f32_16x16x32_bf16 v[44:47], v[168:171], v[100:103], v[44:47]
    ds_read_b64_tr_b16 v[204:205], v252 offset:9728
    ds_read_b64_tr_b16 v[206:207], v252 offset:10880
    s_waitcnt lgkmcnt(15)
    v_mfma_f32_16x16x32_bf16 v[12:15], v[172:175], v[96:99], v[12:15]
    v_mfma_f32_16x16x32_bf16 v[48:51], v[172:175], v[100:103], v[48:51]
    ds_read_b64_tr_b16 v[208:209], v252 offset:9760
    ds_read_b64_tr_b16 v[210:211], v252 offset:10912
    s_waitcnt lgkmcnt(15)
    v_mfma_f32_16x16x32_bf16 v[16:19], v[176:179], v[96:99], v[16:19]
    v_mfma_f32_16x16x32_bf16 v[52:55], v[176:179], v[100:103], v[52:55]
    ds_read_b64_tr_b16 v[212:213], v252 offset:9792
    ds_read_b64_tr_b16 v[214:215], v252 offset:10944
    s_waitcnt lgkmcnt(15)
    v_mfma_f32_16x16x32_bf16 v[20:23], v[180:183], v[96:99], v[20:23]
    v_mfma_f32_16x16x32_bf16 v[56:59], v[180:183], v[100:103], v[56:59]
    ds_read_b64_tr_b16 v[216:217], v252 offset:9824
    ds_read_b64_tr_b16 v[218:219], v252 offset:10976
    s_waitcnt lgkmcnt(15)
    v_mfma_f32_16x16x32_bf16 v[24:27], v[184:187], v[96:99], v[24:27]
    v_mfma_f32_16x16x32_bf16 v[60:63], v[184:187], v[100:103], v[60:63]
    ds_read_b64_tr_b16 v[220:221], v252 offset:9856
    ds_read_b64_tr_b16 v[222:223], v252 offset:11008
    s_waitcnt lgkmcnt(15)
    v_mfma_f32_16x16x32_bf16 v[28:31], v[188:191], v[96:99], v[28:31]
    v_mfma_f32_16x16x32_bf16 v[64:67], v[188:191], v[100:103], v[64:67]
    ds_read_b64_tr_b16 v[224:225], v252 offset:9888
    ds_read_b64_tr_b16 v[226:227], v252 offset:11040
    s_waitcnt lgkmcnt(15)
    v_mfma_f32_16x16x32_bf16 v[32:35], v[192:195], v[96:99], v[32:35]
    v_mfma_f32_16x16x32_bf16 v[68:71], v[192:195], v[100:103], v[68:71]
    ds_read_b64_tr_b16 v[228:229], v252 offset:9920
    ds_read_b64_tr_b16 v[230:231], v252 offset:11072
    s_waitcnt lgkmcnt(15)
    v_mfma_f32_16x16x32_bf16 v[36:39], v[196:199], v[96:99], v[36:39]
    v_mfma_f32_16x16x32_bf16 v[72:75], v[196:199], v[100:103], v[72:75]
    ds_read_b64_tr_b16 v[232:233], v252 offset:9952
    ds_read_b64_tr_b16 v[234:235], v252 offset:11104
    s_waitcnt lgkmcnt(15)
    v_mfma_f32_16x16x32_bf16 v[40:43], v[200:203], v[96:99], v[40:43]
    v_mfma_f32_16x16x32_bf16 v[76:79], v[200:203], v[100:103], v[76:79]
    ds_read_b64_tr_b16 v[236:237], v252 offset:9984
    ds_read_b64_tr_b16 v[238:239], v252 offset:11136
    s_waitcnt lgkmcnt(15)
    v_mfma_f32_16x16x32_bf16 v[8:11], v[204:207], v[104:107], v[8:11]
    v_mfma_f32_16x16x32_bf16 v[44:47], v[204:207], v[108:111], v[44:47]
    s_waitcnt vmcnt(11)
    ds_write_b128 v247, v[148:151] offset:19456
    s_waitcnt lgkmcnt(15)
    v_mfma_f32_16x16x32_bf16 v[12:15], v[208:211], v[104:107], v[12:15]
    v_mfma_f32_16x16x32_bf16 v[48:51], v[208:211], v[108:111], v[48:51]
    ds_write_b128 v248, v[152:155] offset:19456
    ds_write_b128 v249, v[156:159] offset:19456
    s_waitcnt lgkmcnt(15)
    v_mfma_f32_16x16x32_bf16 v[16:19], v[212:215], v[104:107], v[16:19]
    v_mfma_f32_16x16x32_bf16 v[52:55], v[212:215], v[108:111], v[52:55]
    s_mov_b32 s30, 4128768
    buffer_load_dwordx4 v[148:151], v242, s[12:15], s30 offen
    s_waitcnt lgkmcnt(13)
    v_mfma_f32_16x16x32_bf16 v[20:23], v[216:219], v[104:107], v[20:23]
    v_mfma_f32_16x16x32_bf16 v[56:59], v[216:219], v[108:111], v[56:59]
    buffer_load_dwordx4 v[152:155], v243, s[12:15], s30 offen
    buffer_load_dwordx4 v[156:159], v244, s[12:15], s30 offen
    s_waitcnt lgkmcnt(11)
    v_mfma_f32_16x16x32_bf16 v[24:27], v[220:223], v[104:107], v[24:27]
    v_mfma_f32_16x16x32_bf16 v[60:63], v[220:223], v[108:111], v[60:63]
    buffer_load_dwordx4 v[80:83], v240, s[8:11], 0 offen offset:768
    buffer_load_dwordx4 v[84:87], v241, s[8:11], 0 offen offset:768
    s_waitcnt lgkmcnt(9)
    v_mfma_f32_16x16x32_bf16 v[28:31], v[224:227], v[104:107], v[28:31]
    v_mfma_f32_16x16x32_bf16 v[64:67], v[224:227], v[108:111], v[64:67]
    buffer_load_dwordx4 v[88:91], v240, s[8:11], 0 offen offset:832
    buffer_load_dwordx4 v[92:95], v241, s[8:11], 0 offen offset:832
    s_waitcnt lgkmcnt(7)
    v_mfma_f32_16x16x32_bf16 v[32:35], v[228:231], v[104:107], v[32:35]
    v_mfma_f32_16x16x32_bf16 v[68:71], v[228:231], v[108:111], v[68:71]
    s_waitcnt lgkmcnt(5)
    v_mfma_f32_16x16x32_bf16 v[36:39], v[232:235], v[104:107], v[36:39]
    v_mfma_f32_16x16x32_bf16 v[72:75], v[232:235], v[108:111], v[72:75]
    s_waitcnt lgkmcnt(3)
    v_mfma_f32_16x16x32_bf16 v[40:43], v[236:239], v[104:107], v[40:43]
    v_mfma_f32_16x16x32_bf16 v[76:79], v[236:239], v[108:111], v[76:79]
    s_waitcnt lgkmcnt(0)
    s_barrier
    ds_read_b64_tr_b16 v[168:169], v252 offset:19456
    ds_read_b64_tr_b16 v[170:171], v252 offset:20608
    ds_read_b64_tr_b16 v[172:173], v252 offset:19488
    ds_read_b64_tr_b16 v[174:175], v252 offset:20640
    ds_read_b64_tr_b16 v[176:177], v252 offset:19520
    ds_read_b64_tr_b16 v[178:179], v252 offset:20672
    ds_read_b64_tr_b16 v[180:181], v252 offset:19552
    ds_read_b64_tr_b16 v[182:183], v252 offset:20704
    ds_read_b64_tr_b16 v[184:185], v252 offset:19584
    ds_read_b64_tr_b16 v[186:187], v252 offset:20736
    ds_read_b64_tr_b16 v[188:189], v252 offset:19616
    ds_read_b64_tr_b16 v[190:191], v252 offset:20768
    ds_read_b64_tr_b16 v[192:193], v252 offset:19648
    ds_read_b64_tr_b16 v[194:195], v252 offset:20800
    ds_read_b64_tr_b16 v[196:197], v252 offset:19680
    ds_read_b64_tr_b16 v[198:199], v252 offset:20832
    ds_read_b64_tr_b16 v[200:201], v252 offset:19712
    ds_read_b64_tr_b16 v[202:203], v252 offset:20864
    s_waitcnt vmcnt(7)
    s_waitcnt lgkmcnt(15)
    v_mfma_f32_16x16x32_bf16 v[8:11], v[168:171], v[112:115], v[8:11]
    v_mfma_f32_16x16x32_bf16 v[44:47], v[168:171], v[116:119], v[44:47]
    ds_read_b64_tr_b16 v[204:205], v252 offset:29184
    ds_read_b64_tr_b16 v[206:207], v252 offset:30336
    s_waitcnt lgkmcnt(15)
    v_mfma_f32_16x16x32_bf16 v[12:15], v[172:175], v[112:115], v[12:15]
    v_mfma_f32_16x16x32_bf16 v[48:51], v[172:175], v[116:119], v[48:51]
    ds_read_b64_tr_b16 v[208:209], v252 offset:29216
    ds_read_b64_tr_b16 v[210:211], v252 offset:30368
    s_waitcnt lgkmcnt(15)
    v_mfma_f32_16x16x32_bf16 v[16:19], v[176:179], v[112:115], v[16:19]
    v_mfma_f32_16x16x32_bf16 v[52:55], v[176:179], v[116:119], v[52:55]
    ds_read_b64_tr_b16 v[212:213], v252 offset:29248
    ds_read_b64_tr_b16 v[214:215], v252 offset:30400
    s_waitcnt lgkmcnt(15)
    v_mfma_f32_16x16x32_bf16 v[20:23], v[180:183], v[112:115], v[20:23]
    v_mfma_f32_16x16x32_bf16 v[56:59], v[180:183], v[116:119], v[56:59]
    ds_read_b64_tr_b16 v[216:217], v252 offset:29280
    ds_read_b64_tr_b16 v[218:219], v252 offset:30432
    s_waitcnt lgkmcnt(15)
    v_mfma_f32_16x16x32_bf16 v[24:27], v[184:187], v[112:115], v[24:27]
    v_mfma_f32_16x16x32_bf16 v[60:63], v[184:187], v[116:119], v[60:63]
    ds_read_b64_tr_b16 v[220:221], v252 offset:29312
    ds_read_b64_tr_b16 v[222:223], v252 offset:30464
    s_waitcnt lgkmcnt(15)
    v_mfma_f32_16x16x32_bf16 v[28:31], v[188:191], v[112:115], v[28:31]
    v_mfma_f32_16x16x32_bf16 v[64:67], v[188:191], v[116:119], v[64:67]
    ds_read_b64_tr_b16 v[224:225], v252 offset:29344
    ds_read_b64_tr_b16 v[226:227], v252 offset:30496
    s_waitcnt lgkmcnt(15)
    v_mfma_f32_16x16x32_bf16 v[32:35], v[192:195], v[112:115], v[32:35]
    v_mfma_f32_16x16x32_bf16 v[68:71], v[192:195], v[116:119], v[68:71]
    ds_read_b64_tr_b16 v[228:229], v252 offset:29376
    ds_read_b64_tr_b16 v[230:231], v252 offset:30528
    s_waitcnt lgkmcnt(15)
    v_mfma_f32_16x16x32_bf16 v[36:39], v[196:199], v[112:115], v[36:39]
    v_mfma_f32_16x16x32_bf16 v[72:75], v[196:199], v[116:119], v[72:75]
    ds_read_b64_tr_b16 v[232:233], v252 offset:29408
    ds_read_b64_tr_b16 v[234:235], v252 offset:30560
    s_waitcnt lgkmcnt(15)
    v_mfma_f32_16x16x32_bf16 v[40:43], v[200:203], v[112:115], v[40:43]
    v_mfma_f32_16x16x32_bf16 v[76:79], v[200:203], v[116:119], v[76:79]
    ds_read_b64_tr_b16 v[236:237], v252 offset:29440
    ds_read_b64_tr_b16 v[238:239], v252 offset:30592
    s_waitcnt lgkmcnt(15)
    v_mfma_f32_16x16x32_bf16 v[8:11], v[204:207], v[120:123], v[8:11]
    v_mfma_f32_16x16x32_bf16 v[44:47], v[204:207], v[124:127], v[44:47]
    s_waitcnt vmcnt(11)
    ds_write_b128 v247, v[128:131] offset:0
    s_waitcnt lgkmcnt(15)
    v_mfma_f32_16x16x32_bf16 v[12:15], v[208:211], v[120:123], v[12:15]
    v_mfma_f32_16x16x32_bf16 v[48:51], v[208:211], v[124:127], v[48:51]
    ds_write_b128 v248, v[132:135] offset:0
    ds_write_b128 v249, v[136:139] offset:0
    s_waitcnt lgkmcnt(15)
    v_mfma_f32_16x16x32_bf16 v[16:19], v[212:215], v[120:123], v[16:19]
    v_mfma_f32_16x16x32_bf16 v[52:55], v[212:215], v[124:127], v[52:55]
    s_mov_b32 s30, 4718592
    buffer_load_dwordx4 v[128:131], v242, s[12:15], s30 offen
    s_waitcnt lgkmcnt(13)
    v_mfma_f32_16x16x32_bf16 v[20:23], v[216:219], v[120:123], v[20:23]
    v_mfma_f32_16x16x32_bf16 v[56:59], v[216:219], v[124:127], v[56:59]
    buffer_load_dwordx4 v[132:135], v243, s[12:15], s30 offen
    buffer_load_dwordx4 v[136:139], v244, s[12:15], s30 offen
    s_waitcnt lgkmcnt(11)
    v_mfma_f32_16x16x32_bf16 v[24:27], v[220:223], v[120:123], v[24:27]
    v_mfma_f32_16x16x32_bf16 v[60:63], v[220:223], v[124:127], v[60:63]
    buffer_load_dwordx4 v[96:99], v240, s[8:11], 0 offen offset:896
    buffer_load_dwordx4 v[100:103], v241, s[8:11], 0 offen offset:896
    s_waitcnt lgkmcnt(9)
    v_mfma_f32_16x16x32_bf16 v[28:31], v[224:227], v[120:123], v[28:31]
    v_mfma_f32_16x16x32_bf16 v[64:67], v[224:227], v[124:127], v[64:67]
    buffer_load_dwordx4 v[104:107], v240, s[8:11], 0 offen offset:960
    buffer_load_dwordx4 v[108:111], v241, s[8:11], 0 offen offset:960
    s_waitcnt lgkmcnt(7)
    v_mfma_f32_16x16x32_bf16 v[32:35], v[228:231], v[120:123], v[32:35]
    v_mfma_f32_16x16x32_bf16 v[68:71], v[228:231], v[124:127], v[68:71]
    s_waitcnt lgkmcnt(5)
    v_mfma_f32_16x16x32_bf16 v[36:39], v[232:235], v[120:123], v[36:39]
    v_mfma_f32_16x16x32_bf16 v[72:75], v[232:235], v[124:127], v[72:75]
    s_waitcnt lgkmcnt(3)
    v_mfma_f32_16x16x32_bf16 v[40:43], v[236:239], v[120:123], v[40:43]
    v_mfma_f32_16x16x32_bf16 v[76:79], v[236:239], v[124:127], v[76:79]
    s_waitcnt lgkmcnt(0)
    s_barrier
    ds_read_b64_tr_b16 v[168:169], v252 offset:0
    ds_read_b64_tr_b16 v[170:171], v252 offset:1152
    ds_read_b64_tr_b16 v[172:173], v252 offset:32
    ds_read_b64_tr_b16 v[174:175], v252 offset:1184
    ds_read_b64_tr_b16 v[176:177], v252 offset:64
    ds_read_b64_tr_b16 v[178:179], v252 offset:1216
    ds_read_b64_tr_b16 v[180:181], v252 offset:96
    ds_read_b64_tr_b16 v[182:183], v252 offset:1248
    ds_read_b64_tr_b16 v[184:185], v252 offset:128
    ds_read_b64_tr_b16 v[186:187], v252 offset:1280
    ds_read_b64_tr_b16 v[188:189], v252 offset:160
    ds_read_b64_tr_b16 v[190:191], v252 offset:1312
    ds_read_b64_tr_b16 v[192:193], v252 offset:192
    ds_read_b64_tr_b16 v[194:195], v252 offset:1344
    ds_read_b64_tr_b16 v[196:197], v252 offset:224
    ds_read_b64_tr_b16 v[198:199], v252 offset:1376
    ds_read_b64_tr_b16 v[200:201], v252 offset:256
    ds_read_b64_tr_b16 v[202:203], v252 offset:1408
    s_waitcnt vmcnt(7)
    s_waitcnt lgkmcnt(15)
    v_mfma_f32_16x16x32_bf16 v[8:11], v[168:171], v[80:83], v[8:11]
    v_mfma_f32_16x16x32_bf16 v[44:47], v[168:171], v[84:87], v[44:47]
    ds_read_b64_tr_b16 v[204:205], v252 offset:9728
    ds_read_b64_tr_b16 v[206:207], v252 offset:10880
    s_waitcnt lgkmcnt(15)
    v_mfma_f32_16x16x32_bf16 v[12:15], v[172:175], v[80:83], v[12:15]
    v_mfma_f32_16x16x32_bf16 v[48:51], v[172:175], v[84:87], v[48:51]
    ds_read_b64_tr_b16 v[208:209], v252 offset:9760
    ds_read_b64_tr_b16 v[210:211], v252 offset:10912
    s_waitcnt lgkmcnt(15)
    v_mfma_f32_16x16x32_bf16 v[16:19], v[176:179], v[80:83], v[16:19]
    v_mfma_f32_16x16x32_bf16 v[52:55], v[176:179], v[84:87], v[52:55]
    ds_read_b64_tr_b16 v[212:213], v252 offset:9792
    ds_read_b64_tr_b16 v[214:215], v252 offset:10944
    s_waitcnt lgkmcnt(15)
    v_mfma_f32_16x16x32_bf16 v[20:23], v[180:183], v[80:83], v[20:23]
    v_mfma_f32_16x16x32_bf16 v[56:59], v[180:183], v[84:87], v[56:59]
    ds_read_b64_tr_b16 v[216:217], v252 offset:9824
    ds_read_b64_tr_b16 v[218:219], v252 offset:10976
    s_waitcnt lgkmcnt(15)
    v_mfma_f32_16x16x32_bf16 v[24:27], v[184:187], v[80:83], v[24:27]
    v_mfma_f32_16x16x32_bf16 v[60:63], v[184:187], v[84:87], v[60:63]
    ds_read_b64_tr_b16 v[220:221], v252 offset:9856
    ds_read_b64_tr_b16 v[222:223], v252 offset:11008
    s_waitcnt lgkmcnt(15)
    v_mfma_f32_16x16x32_bf16 v[28:31], v[188:191], v[80:83], v[28:31]
    v_mfma_f32_16x16x32_bf16 v[64:67], v[188:191], v[84:87], v[64:67]
    ds_read_b64_tr_b16 v[224:225], v252 offset:9888
    ds_read_b64_tr_b16 v[226:227], v252 offset:11040
    s_waitcnt lgkmcnt(15)
    v_mfma_f32_16x16x32_bf16 v[32:35], v[192:195], v[80:83], v[32:35]
    v_mfma_f32_16x16x32_bf16 v[68:71], v[192:195], v[84:87], v[68:71]
    ds_read_b64_tr_b16 v[228:229], v252 offset:9920
    ds_read_b64_tr_b16 v[230:231], v252 offset:11072
    s_waitcnt lgkmcnt(15)
    v_mfma_f32_16x16x32_bf16 v[36:39], v[196:199], v[80:83], v[36:39]
    v_mfma_f32_16x16x32_bf16 v[72:75], v[196:199], v[84:87], v[72:75]
    ds_read_b64_tr_b16 v[232:233], v252 offset:9952
    ds_read_b64_tr_b16 v[234:235], v252 offset:11104
    s_waitcnt lgkmcnt(15)
    v_mfma_f32_16x16x32_bf16 v[40:43], v[200:203], v[80:83], v[40:43]
    v_mfma_f32_16x16x32_bf16 v[76:79], v[200:203], v[84:87], v[76:79]
    ds_read_b64_tr_b16 v[236:237], v252 offset:9984
    ds_read_b64_tr_b16 v[238:239], v252 offset:11136
    s_waitcnt lgkmcnt(15)
    v_mfma_f32_16x16x32_bf16 v[8:11], v[204:207], v[88:91], v[8:11]
    v_mfma_f32_16x16x32_bf16 v[44:47], v[204:207], v[92:95], v[44:47]
    s_waitcnt vmcnt(11)
    s_waitcnt lgkmcnt(14)
    v_mfma_f32_16x16x32_bf16 v[12:15], v[208:211], v[88:91], v[12:15]
    v_mfma_f32_16x16x32_bf16 v[48:51], v[208:211], v[92:95], v[48:51]
    ds_write_b128 v247, v[148:151] offset:19456
    s_waitcnt lgkmcnt(13)
    v_mfma_f32_16x16x32_bf16 v[16:19], v[212:215], v[88:91], v[16:19]
    v_mfma_f32_16x16x32_bf16 v[52:55], v[212:215], v[92:95], v[52:55]
    ds_write_b128 v248, v[152:155] offset:19456
    s_waitcnt lgkmcnt(12)
    v_mfma_f32_16x16x32_bf16 v[20:23], v[216:219], v[88:91], v[20:23]
    v_mfma_f32_16x16x32_bf16 v[56:59], v[216:219], v[92:95], v[56:59]
    ds_write_b128 v249, v[156:159] offset:19456
    s_waitcnt lgkmcnt(11)
    v_mfma_f32_16x16x32_bf16 v[24:27], v[220:223], v[88:91], v[24:27]
    v_mfma_f32_16x16x32_bf16 v[60:63], v[220:223], v[92:95], v[60:63]
    buffer_load_dwordx4 v[112:115], v240, s[8:11], 0 offen offset:1024
    s_waitcnt lgkmcnt(9)
    v_mfma_f32_16x16x32_bf16 v[28:31], v[224:227], v[88:91], v[28:31]
    v_mfma_f32_16x16x32_bf16 v[64:67], v[224:227], v[92:95], v[64:67]
    buffer_load_dwordx4 v[116:119], v241, s[8:11], 0 offen offset:1024
    s_waitcnt lgkmcnt(7)
    v_mfma_f32_16x16x32_bf16 v[32:35], v[228:231], v[88:91], v[32:35]
    v_mfma_f32_16x16x32_bf16 v[68:71], v[228:231], v[92:95], v[68:71]
    buffer_load_dwordx4 v[120:123], v240, s[8:11], 0 offen offset:1088
    s_waitcnt lgkmcnt(5)
    v_mfma_f32_16x16x32_bf16 v[36:39], v[232:235], v[88:91], v[36:39]
    v_mfma_f32_16x16x32_bf16 v[72:75], v[232:235], v[92:95], v[72:75]
    buffer_load_dwordx4 v[124:127], v241, s[8:11], 0 offen offset:1088
    s_waitcnt lgkmcnt(3)
    v_mfma_f32_16x16x32_bf16 v[40:43], v[236:239], v[88:91], v[40:43]
    v_mfma_f32_16x16x32_bf16 v[76:79], v[236:239], v[92:95], v[76:79]
    s_waitcnt lgkmcnt(0)
    s_barrier
    ds_read_b64_tr_b16 v[168:169], v252 offset:19456
    ds_read_b64_tr_b16 v[170:171], v252 offset:20608
    ds_read_b64_tr_b16 v[172:173], v252 offset:19488
    ds_read_b64_tr_b16 v[174:175], v252 offset:20640
    ds_read_b64_tr_b16 v[176:177], v252 offset:19520
    ds_read_b64_tr_b16 v[178:179], v252 offset:20672
    ds_read_b64_tr_b16 v[180:181], v252 offset:19552
    ds_read_b64_tr_b16 v[182:183], v252 offset:20704
    ds_read_b64_tr_b16 v[184:185], v252 offset:19584
    ds_read_b64_tr_b16 v[186:187], v252 offset:20736
    ds_read_b64_tr_b16 v[188:189], v252 offset:19616
    ds_read_b64_tr_b16 v[190:191], v252 offset:20768
    ds_read_b64_tr_b16 v[192:193], v252 offset:19648
    ds_read_b64_tr_b16 v[194:195], v252 offset:20800
    ds_read_b64_tr_b16 v[196:197], v252 offset:19680
    ds_read_b64_tr_b16 v[198:199], v252 offset:20832
    ds_read_b64_tr_b16 v[200:201], v252 offset:19712
    ds_read_b64_tr_b16 v[202:203], v252 offset:20864
    s_waitcnt vmcnt(4)
    s_waitcnt lgkmcnt(15)
    v_mfma_f32_16x16x32_bf16 v[8:11], v[168:171], v[96:99], v[8:11]
    v_mfma_f32_16x16x32_bf16 v[44:47], v[168:171], v[100:103], v[44:47]
    ds_read_b64_tr_b16 v[204:205], v252 offset:29184
    ds_read_b64_tr_b16 v[206:207], v252 offset:30336
    s_waitcnt lgkmcnt(15)
    v_mfma_f32_16x16x32_bf16 v[12:15], v[172:175], v[96:99], v[12:15]
    v_mfma_f32_16x16x32_bf16 v[48:51], v[172:175], v[100:103], v[48:51]
    ds_read_b64_tr_b16 v[208:209], v252 offset:29216
    ds_read_b64_tr_b16 v[210:211], v252 offset:30368
    s_waitcnt lgkmcnt(15)
    v_mfma_f32_16x16x32_bf16 v[16:19], v[176:179], v[96:99], v[16:19]
    v_mfma_f32_16x16x32_bf16 v[52:55], v[176:179], v[100:103], v[52:55]
    ds_read_b64_tr_b16 v[212:213], v252 offset:29248
    ds_read_b64_tr_b16 v[214:215], v252 offset:30400
    s_waitcnt lgkmcnt(15)
    v_mfma_f32_16x16x32_bf16 v[20:23], v[180:183], v[96:99], v[20:23]
    v_mfma_f32_16x16x32_bf16 v[56:59], v[180:183], v[100:103], v[56:59]
    ds_read_b64_tr_b16 v[216:217], v252 offset:29280
    ds_read_b64_tr_b16 v[218:219], v252 offset:30432
    s_waitcnt lgkmcnt(15)
    v_mfma_f32_16x16x32_bf16 v[24:27], v[184:187], v[96:99], v[24:27]
    v_mfma_f32_16x16x32_bf16 v[60:63], v[184:187], v[100:103], v[60:63]
    ds_read_b64_tr_b16 v[220:221], v252 offset:29312
    ds_read_b64_tr_b16 v[222:223], v252 offset:30464
    s_waitcnt lgkmcnt(15)
    v_mfma_f32_16x16x32_bf16 v[28:31], v[188:191], v[96:99], v[28:31]
    v_mfma_f32_16x16x32_bf16 v[64:67], v[188:191], v[100:103], v[64:67]
    ds_read_b64_tr_b16 v[224:225], v252 offset:29344
    ds_read_b64_tr_b16 v[226:227], v252 offset:30496
    s_waitcnt lgkmcnt(15)
    v_mfma_f32_16x16x32_bf16 v[32:35], v[192:195], v[96:99], v[32:35]
    v_mfma_f32_16x16x32_bf16 v[68:71], v[192:195], v[100:103], v[68:71]
    ds_read_b64_tr_b16 v[228:229], v252 offset:29376
    ds_read_b64_tr_b16 v[230:231], v252 offset:30528
    s_waitcnt lgkmcnt(15)
    v_mfma_f32_16x16x32_bf16 v[36:39], v[196:199], v[96:99], v[36:39]
    v_mfma_f32_16x16x32_bf16 v[72:75], v[196:199], v[100:103], v[72:75]
    ds_read_b64_tr_b16 v[232:233], v252 offset:29408
    ds_read_b64_tr_b16 v[234:235], v252 offset:30560
    s_waitcnt lgkmcnt(15)
    v_mfma_f32_16x16x32_bf16 v[40:43], v[200:203], v[96:99], v[40:43]
    v_mfma_f32_16x16x32_bf16 v[76:79], v[200:203], v[100:103], v[76:79]
    ds_read_b64_tr_b16 v[236:237], v252 offset:29440
    ds_read_b64_tr_b16 v[238:239], v252 offset:30592
    s_waitcnt lgkmcnt(15)
    v_mfma_f32_16x16x32_bf16 v[8:11], v[204:207], v[104:107], v[8:11]
    v_mfma_f32_16x16x32_bf16 v[44:47], v[204:207], v[108:111], v[44:47]
    s_waitcnt vmcnt(8)
    s_waitcnt lgkmcnt(14)
    v_mfma_f32_16x16x32_bf16 v[12:15], v[208:211], v[104:107], v[12:15]
    v_mfma_f32_16x16x32_bf16 v[48:51], v[208:211], v[108:111], v[48:51]
    ds_write_b128 v247, v[128:131] offset:0
    s_waitcnt lgkmcnt(13)
    v_mfma_f32_16x16x32_bf16 v[16:19], v[212:215], v[104:107], v[16:19]
    v_mfma_f32_16x16x32_bf16 v[52:55], v[212:215], v[108:111], v[52:55]
    ds_write_b128 v248, v[132:135] offset:0
    s_waitcnt lgkmcnt(12)
    v_mfma_f32_16x16x32_bf16 v[20:23], v[216:219], v[104:107], v[20:23]
    v_mfma_f32_16x16x32_bf16 v[56:59], v[216:219], v[108:111], v[56:59]
    ds_write_b128 v249, v[136:139] offset:0
    s_waitcnt lgkmcnt(11)
    v_mfma_f32_16x16x32_bf16 v[24:27], v[220:223], v[104:107], v[24:27]
    v_mfma_f32_16x16x32_bf16 v[60:63], v[220:223], v[108:111], v[60:63]
    s_waitcnt lgkmcnt(9)
    v_mfma_f32_16x16x32_bf16 v[28:31], v[224:227], v[104:107], v[28:31]
    v_mfma_f32_16x16x32_bf16 v[64:67], v[224:227], v[108:111], v[64:67]
    s_waitcnt lgkmcnt(7)
    v_mfma_f32_16x16x32_bf16 v[32:35], v[228:231], v[104:107], v[32:35]
    v_mfma_f32_16x16x32_bf16 v[68:71], v[228:231], v[108:111], v[68:71]
    s_waitcnt lgkmcnt(5)
    v_mfma_f32_16x16x32_bf16 v[36:39], v[232:235], v[104:107], v[36:39]
    v_mfma_f32_16x16x32_bf16 v[72:75], v[232:235], v[108:111], v[72:75]
    s_waitcnt lgkmcnt(3)
    v_mfma_f32_16x16x32_bf16 v[40:43], v[236:239], v[104:107], v[40:43]
    v_mfma_f32_16x16x32_bf16 v[76:79], v[236:239], v[108:111], v[76:79]
    s_waitcnt lgkmcnt(0)
    s_barrier
    ds_read_b64_tr_b16 v[168:169], v252 offset:0
    ds_read_b64_tr_b16 v[170:171], v252 offset:1152
    ds_read_b64_tr_b16 v[172:173], v252 offset:32
    ds_read_b64_tr_b16 v[174:175], v252 offset:1184
    ds_read_b64_tr_b16 v[176:177], v252 offset:64
    ds_read_b64_tr_b16 v[178:179], v252 offset:1216
    ds_read_b64_tr_b16 v[180:181], v252 offset:96
    ds_read_b64_tr_b16 v[182:183], v252 offset:1248
    ds_read_b64_tr_b16 v[184:185], v252 offset:128
    ds_read_b64_tr_b16 v[186:187], v252 offset:1280
    ds_read_b64_tr_b16 v[188:189], v252 offset:160
    ds_read_b64_tr_b16 v[190:191], v252 offset:1312
    ds_read_b64_tr_b16 v[192:193], v252 offset:192
    ds_read_b64_tr_b16 v[194:195], v252 offset:1344
    ds_read_b64_tr_b16 v[196:197], v252 offset:224
    ds_read_b64_tr_b16 v[198:199], v252 offset:1376
    ds_read_b64_tr_b16 v[200:201], v252 offset:256
    ds_read_b64_tr_b16 v[202:203], v252 offset:1408
    s_waitcnt vmcnt(0)
    s_waitcnt lgkmcnt(15)
    v_mfma_f32_16x16x32_bf16 v[8:11], v[168:171], v[112:115], v[8:11]
    v_mfma_f32_16x16x32_bf16 v[44:47], v[168:171], v[116:119], v[44:47]
    ds_read_b64_tr_b16 v[204:205], v252 offset:9728
    ds_read_b64_tr_b16 v[206:207], v252 offset:10880
    s_waitcnt lgkmcnt(15)
    v_mfma_f32_16x16x32_bf16 v[12:15], v[172:175], v[112:115], v[12:15]
    v_mfma_f32_16x16x32_bf16 v[48:51], v[172:175], v[116:119], v[48:51]
    ds_read_b64_tr_b16 v[208:209], v252 offset:9760
    ds_read_b64_tr_b16 v[210:211], v252 offset:10912
    s_waitcnt lgkmcnt(15)
    v_mfma_f32_16x16x32_bf16 v[16:19], v[176:179], v[112:115], v[16:19]
    v_mfma_f32_16x16x32_bf16 v[52:55], v[176:179], v[116:119], v[52:55]
    ds_read_b64_tr_b16 v[212:213], v252 offset:9792
    ds_read_b64_tr_b16 v[214:215], v252 offset:10944
    s_waitcnt lgkmcnt(15)
    v_mfma_f32_16x16x32_bf16 v[20:23], v[180:183], v[112:115], v[20:23]
    v_mfma_f32_16x16x32_bf16 v[56:59], v[180:183], v[116:119], v[56:59]
    ds_read_b64_tr_b16 v[216:217], v252 offset:9824
    ds_read_b64_tr_b16 v[218:219], v252 offset:10976
    s_waitcnt lgkmcnt(15)
    v_mfma_f32_16x16x32_bf16 v[24:27], v[184:187], v[112:115], v[24:27]
    v_mfma_f32_16x16x32_bf16 v[60:63], v[184:187], v[116:119], v[60:63]
    ds_read_b64_tr_b16 v[220:221], v252 offset:9856
    ds_read_b64_tr_b16 v[222:223], v252 offset:11008
    s_waitcnt lgkmcnt(15)
    v_mfma_f32_16x16x32_bf16 v[28:31], v[188:191], v[112:115], v[28:31]
    v_mfma_f32_16x16x32_bf16 v[64:67], v[188:191], v[116:119], v[64:67]
    ds_read_b64_tr_b16 v[224:225], v252 offset:9888
    ds_read_b64_tr_b16 v[226:227], v252 offset:11040
    s_waitcnt lgkmcnt(15)
    v_mfma_f32_16x16x32_bf16 v[32:35], v[192:195], v[112:115], v[32:35]
    v_mfma_f32_16x16x32_bf16 v[68:71], v[192:195], v[116:119], v[68:71]
    ds_read_b64_tr_b16 v[228:229], v252 offset:9920
    ds_read_b64_tr_b16 v[230:231], v252 offset:11072
    s_waitcnt lgkmcnt(15)
    v_mfma_f32_16x16x32_bf16 v[36:39], v[196:199], v[112:115], v[36:39]
    v_mfma_f32_16x16x32_bf16 v[72:75], v[196:199], v[116:119], v[72:75]
    ds_read_b64_tr_b16 v[232:233], v252 offset:9952
    ds_read_b64_tr_b16 v[234:235], v252 offset:11104
    s_waitcnt lgkmcnt(15)
    v_mfma_f32_16x16x32_bf16 v[40:43], v[200:203], v[112:115], v[40:43]
    v_mfma_f32_16x16x32_bf16 v[76:79], v[200:203], v[116:119], v[76:79]
    ds_read_b64_tr_b16 v[236:237], v252 offset:9984
    ds_read_b64_tr_b16 v[238:239], v252 offset:11136
    s_waitcnt lgkmcnt(15)
    v_mfma_f32_16x16x32_bf16 v[8:11], v[204:207], v[120:123], v[8:11]
    v_mfma_f32_16x16x32_bf16 v[44:47], v[204:207], v[124:127], v[44:47]
    s_waitcnt lgkmcnt(14)
    v_mfma_f32_16x16x32_bf16 v[12:15], v[208:211], v[120:123], v[12:15]
    v_mfma_f32_16x16x32_bf16 v[48:51], v[208:211], v[124:127], v[48:51]
    s_waitcnt lgkmcnt(12)
    v_mfma_f32_16x16x32_bf16 v[16:19], v[212:215], v[120:123], v[16:19]
    v_mfma_f32_16x16x32_bf16 v[52:55], v[212:215], v[124:127], v[52:55]
    s_waitcnt lgkmcnt(10)
    v_mfma_f32_16x16x32_bf16 v[20:23], v[216:219], v[120:123], v[20:23]
    v_mfma_f32_16x16x32_bf16 v[56:59], v[216:219], v[124:127], v[56:59]
    s_waitcnt lgkmcnt(8)
    v_mfma_f32_16x16x32_bf16 v[24:27], v[220:223], v[120:123], v[24:27]
    v_mfma_f32_16x16x32_bf16 v[60:63], v[220:223], v[124:127], v[60:63]
    s_waitcnt lgkmcnt(6)
    v_mfma_f32_16x16x32_bf16 v[28:31], v[224:227], v[120:123], v[28:31]
    v_mfma_f32_16x16x32_bf16 v[64:67], v[224:227], v[124:127], v[64:67]
    s_waitcnt lgkmcnt(4)
    v_mfma_f32_16x16x32_bf16 v[32:35], v[228:231], v[120:123], v[32:35]
    v_mfma_f32_16x16x32_bf16 v[68:71], v[228:231], v[124:127], v[68:71]
    s_waitcnt lgkmcnt(2)
    v_mfma_f32_16x16x32_bf16 v[36:39], v[232:235], v[120:123], v[36:39]
    v_mfma_f32_16x16x32_bf16 v[72:75], v[232:235], v[124:127], v[72:75]
    s_waitcnt lgkmcnt(0)
    v_mfma_f32_16x16x32_bf16 v[40:43], v[236:239], v[120:123], v[40:43]
    v_mfma_f32_16x16x32_bf16 v[76:79], v[236:239], v[124:127], v[76:79]
    v_lshlrev_b32 v5, 5, v2
    v_add3_u32 v5, v5, s24, v3
    s_mov_b32 s25, 9216
    v_mul_lo_u32 v5, v5, s25
    v_lshlrev_b32 v6, 3, v4
    s_mul_i32 s28, s22, 288
    v_add3_u32 v253, v5, v6, s28
    s_mov_b32 s29, 147456
    v_cvt_pk_bf16_f32 v9, v8, v9
    v_lshlrev_b32 v8, 16, v9
    v_and_b32 v9, 0xffff0000, v9
    v_cvt_pk_bf16_f32 v11, v10, v11
    v_lshlrev_b32 v10, 16, v11
    v_and_b32 v11, 0xffff0000, v11
    v_mul_f32 v5, 0xbfb8aa3b, v8
    v_exp_f32 v5, v5
    s_nop 0
    v_add_f32 v5, 1.0, v5
    v_rcp_f32 v5, v5
    s_nop 0
    v_mul_f32 v8, v5, v8
    v_mul_f32 v6, 0xbfb8aa3b, v9
    v_exp_f32 v6, v6
    s_nop 0
    v_add_f32 v6, 1.0, v6
    v_rcp_f32 v6, v6
    s_nop 0
    v_mul_f32 v9, v6, v9
    v_mul_f32 v5, 0xbfb8aa3b, v10
    v_exp_f32 v5, v5
    s_nop 0
    v_add_f32 v5, 1.0, v5
    v_rcp_f32 v5, v5
    s_nop 0
    v_mul_f32 v10, v5, v10
    v_mul_f32 v6, 0xbfb8aa3b, v11
    v_exp_f32 v6, v6
    s_nop 0
    v_add_f32 v6, 1.0, v6
    v_rcp_f32 v6, v6
    s_nop 0
    v_mul_f32 v11, v6, v11
    v_cvt_pk_bf16_f32 v8, v8, v9
    v_cvt_pk_bf16_f32 v9, v10, v11
    buffer_store_dwordx2 v[8:9], v253, s[16:19], 0 offen offset:0
    v_cvt_pk_bf16_f32 v13, v12, v13
    v_lshlrev_b32 v12, 16, v13
    v_and_b32 v13, 0xffff0000, v13
    v_cvt_pk_bf16_f32 v15, v14, v15
    v_lshlrev_b32 v14, 16, v15
    v_and_b32 v15, 0xffff0000, v15
    v_mul_f32 v5, 0xbfb8aa3b, v12
    v_exp_f32 v5, v5
    s_nop 0
    v_add_f32 v5, 1.0, v5
    v_rcp_f32 v5, v5
    s_nop 0
    v_mul_f32 v12, v5, v12
    v_mul_f32 v6, 0xbfb8aa3b, v13
    v_exp_f32 v6, v6
    s_nop 0
    v_add_f32 v6, 1.0, v6
    v_rcp_f32 v6, v6
    s_nop 0
    v_mul_f32 v13, v6, v13
    v_mul_f32 v5, 0xbfb8aa3b, v14
    v_exp_f32 v5, v5
    s_nop 0
    v_add_f32 v5, 1.0, v5
    v_rcp_f32 v5, v5
    s_nop 0
    v_mul_f32 v14, v5, v14
    v_mul_f32 v6, 0xbfb8aa3b, v15
    v_exp_f32 v6, v6
    s_nop 0
    v_add_f32 v6, 1.0, v6
    v_rcp_f32 v6, v6
    s_nop 0
    v_mul_f32 v15, v6, v15
    v_cvt_pk_bf16_f32 v12, v12, v13
    v_cvt_pk_bf16_f32 v13, v14, v15
    buffer_store_dwordx2 v[12:13], v253, s[16:19], 0 offen offset:32
    v_cvt_pk_bf16_f32 v17, v16, v17
    v_lshlrev_b32 v16, 16, v17
    v_and_b32 v17, 0xffff0000, v17
    v_cvt_pk_bf16_f32 v19, v18, v19
    v_lshlrev_b32 v18, 16, v19
    v_and_b32 v19, 0xffff0000, v19
    v_mul_f32 v5, 0xbfb8aa3b, v16
    v_exp_f32 v5, v5
    s_nop 0
    v_add_f32 v5, 1.0, v5
    v_rcp_f32 v5, v5
    s_nop 0
    v_mul_f32 v16, v5, v16
    v_mul_f32 v6, 0xbfb8aa3b, v17
    v_exp_f32 v6, v6
    s_nop 0
    v_add_f32 v6, 1.0, v6
    v_rcp_f32 v6, v6
    s_nop 0
    v_mul_f32 v17, v6, v17
    v_mul_f32 v5, 0xbfb8aa3b, v18
    v_exp_f32 v5, v5
    s_nop 0
    v_add_f32 v5, 1.0, v5
    v_rcp_f32 v5, v5
    s_nop 0
    v_mul_f32 v18, v5, v18
    v_mul_f32 v6, 0xbfb8aa3b, v19
    v_exp_f32 v6, v6
    s_nop 0
    v_add_f32 v6, 1.0, v6
    v_rcp_f32 v6, v6
    s_nop 0
    v_mul_f32 v19, v6, v19
    v_cvt_pk_bf16_f32 v16, v16, v17
    v_cvt_pk_bf16_f32 v17, v18, v19
    buffer_store_dwordx2 v[16:17], v253, s[16:19], 0 offen offset:64
    v_cvt_pk_bf16_f32 v21, v20, v21
    v_lshlrev_b32 v20, 16, v21
    v_and_b32 v21, 0xffff0000, v21
    v_cvt_pk_bf16_f32 v23, v22, v23
    v_lshlrev_b32 v22, 16, v23
    v_and_b32 v23, 0xffff0000, v23
    v_mul_f32 v5, 0xbfb8aa3b, v20
    v_exp_f32 v5, v5
    s_nop 0
    v_add_f32 v5, 1.0, v5
    v_rcp_f32 v5, v5
    s_nop 0
    v_mul_f32 v20, v5, v20
    v_mul_f32 v6, 0xbfb8aa3b, v21
    v_exp_f32 v6, v6
    s_nop 0
    v_add_f32 v6, 1.0, v6
    v_rcp_f32 v6, v6
    s_nop 0
    v_mul_f32 v21, v6, v21
    v_mul_f32 v5, 0xbfb8aa3b, v22
    v_exp_f32 v5, v5
    s_nop 0
    v_add_f32 v5, 1.0, v5
    v_rcp_f32 v5, v5
    s_nop 0
    v_mul_f32 v22, v5, v22
    v_mul_f32 v6, 0xbfb8aa3b, v23
    v_exp_f32 v6, v6
    s_nop 0
    v_add_f32 v6, 1.0, v6
    v_rcp_f32 v6, v6
    s_nop 0
    v_mul_f32 v23, v6, v23
    v_cvt_pk_bf16_f32 v20, v20, v21
    v_cvt_pk_bf16_f32 v21, v22, v23
    buffer_store_dwordx2 v[20:21], v253, s[16:19], 0 offen offset:96
    v_cvt_pk_bf16_f32 v25, v24, v25
    v_lshlrev_b32 v24, 16, v25
    v_and_b32 v25, 0xffff0000, v25
    v_cvt_pk_bf16_f32 v27, v26, v27
    v_lshlrev_b32 v26, 16, v27
    v_and_b32 v27, 0xffff0000, v27
    v_mul_f32 v5, 0xbfb8aa3b, v24
    v_exp_f32 v5, v5
    s_nop 0
    v_add_f32 v5, 1.0, v5
    v_rcp_f32 v5, v5
    s_nop 0
    v_mul_f32 v24, v5, v24
    v_mul_f32 v6, 0xbfb8aa3b, v25
    v_exp_f32 v6, v6
    s_nop 0
    v_add_f32 v6, 1.0, v6
    v_rcp_f32 v6, v6
    s_nop 0
    v_mul_f32 v25, v6, v25
    v_mul_f32 v5, 0xbfb8aa3b, v26
    v_exp_f32 v5, v5
    s_nop 0
    v_add_f32 v5, 1.0, v5
    v_rcp_f32 v5, v5
    s_nop 0
    v_mul_f32 v26, v5, v26
    v_mul_f32 v6, 0xbfb8aa3b, v27
    v_exp_f32 v6, v6
    s_nop 0
    v_add_f32 v6, 1.0, v6
    v_rcp_f32 v6, v6
    s_nop 0
    v_mul_f32 v27, v6, v27
    v_cvt_pk_bf16_f32 v24, v24, v25
    v_cvt_pk_bf16_f32 v25, v26, v27
    buffer_store_dwordx2 v[24:25], v253, s[16:19], 0 offen offset:128
    v_cvt_pk_bf16_f32 v29, v28, v29
    v_lshlrev_b32 v28, 16, v29
    v_and_b32 v29, 0xffff0000, v29
    v_cvt_pk_bf16_f32 v31, v30, v31
    v_lshlrev_b32 v30, 16, v31
    v_and_b32 v31, 0xffff0000, v31
    v_mul_f32 v5, 0xbfb8aa3b, v28
    v_exp_f32 v5, v5
    s_nop 0
    v_add_f32 v5, 1.0, v5
    v_rcp_f32 v5, v5
    s_nop 0
    v_mul_f32 v28, v5, v28
    v_mul_f32 v6, 0xbfb8aa3b, v29
    v_exp_f32 v6, v6
    s_nop 0
    v_add_f32 v6, 1.0, v6
    v_rcp_f32 v6, v6
    s_nop 0
    v_mul_f32 v29, v6, v29
    v_mul_f32 v5, 0xbfb8aa3b, v30
    v_exp_f32 v5, v5
    s_nop 0
    v_add_f32 v5, 1.0, v5
    v_rcp_f32 v5, v5
    s_nop 0
    v_mul_f32 v30, v5, v30
    v_mul_f32 v6, 0xbfb8aa3b, v31
    v_exp_f32 v6, v6
    s_nop 0
    v_add_f32 v6, 1.0, v6
    v_rcp_f32 v6, v6
    s_nop 0
    v_mul_f32 v31, v6, v31
    v_cvt_pk_bf16_f32 v28, v28, v29
    v_cvt_pk_bf16_f32 v29, v30, v31
    buffer_store_dwordx2 v[28:29], v253, s[16:19], 0 offen offset:160
    v_cvt_pk_bf16_f32 v33, v32, v33
    v_lshlrev_b32 v32, 16, v33
    v_and_b32 v33, 0xffff0000, v33
    v_cvt_pk_bf16_f32 v35, v34, v35
    v_lshlrev_b32 v34, 16, v35
    v_and_b32 v35, 0xffff0000, v35
    v_mul_f32 v5, 0xbfb8aa3b, v32
    v_exp_f32 v5, v5
    s_nop 0
    v_add_f32 v5, 1.0, v5
    v_rcp_f32 v5, v5
    s_nop 0
    v_mul_f32 v32, v5, v32
    v_mul_f32 v6, 0xbfb8aa3b, v33
    v_exp_f32 v6, v6
    s_nop 0
    v_add_f32 v6, 1.0, v6
    v_rcp_f32 v6, v6
    s_nop 0
    v_mul_f32 v33, v6, v33
    v_mul_f32 v5, 0xbfb8aa3b, v34
    v_exp_f32 v5, v5
    s_nop 0
    v_add_f32 v5, 1.0, v5
    v_rcp_f32 v5, v5
    s_nop 0
    v_mul_f32 v34, v5, v34
    v_mul_f32 v6, 0xbfb8aa3b, v35
    v_exp_f32 v6, v6
    s_nop 0
    v_add_f32 v6, 1.0, v6
    v_rcp_f32 v6, v6
    s_nop 0
    v_mul_f32 v35, v6, v35
    v_cvt_pk_bf16_f32 v32, v32, v33
    v_cvt_pk_bf16_f32 v33, v34, v35
    buffer_store_dwordx2 v[32:33], v253, s[16:19], 0 offen offset:192
    v_cvt_pk_bf16_f32 v37, v36, v37
    v_lshlrev_b32 v36, 16, v37
    v_and_b32 v37, 0xffff0000, v37
    v_cvt_pk_bf16_f32 v39, v38, v39
    v_lshlrev_b32 v38, 16, v39
    v_and_b32 v39, 0xffff0000, v39
    v_mul_f32 v5, 0xbfb8aa3b, v36
    v_exp_f32 v5, v5
    s_nop 0
    v_add_f32 v5, 1.0, v5
    v_rcp_f32 v5, v5
    s_nop 0
    v_mul_f32 v36, v5, v36
    v_mul_f32 v6, 0xbfb8aa3b, v37
    v_exp_f32 v6, v6
    s_nop 0
    v_add_f32 v6, 1.0, v6
    v_rcp_f32 v6, v6
    s_nop 0
    v_mul_f32 v37, v6, v37
    v_mul_f32 v5, 0xbfb8aa3b, v38
    v_exp_f32 v5, v5
    s_nop 0
    v_add_f32 v5, 1.0, v5
    v_rcp_f32 v5, v5
    s_nop 0
    v_mul_f32 v38, v5, v38
    v_mul_f32 v6, 0xbfb8aa3b, v39
    v_exp_f32 v6, v6
    s_nop 0
    v_add_f32 v6, 1.0, v6
    v_rcp_f32 v6, v6
    s_nop 0
    v_mul_f32 v39, v6, v39
    v_cvt_pk_bf16_f32 v36, v36, v37
    v_cvt_pk_bf16_f32 v37, v38, v39
    buffer_store_dwordx2 v[36:37], v253, s[16:19], 0 offen offset:224
    v_cvt_pk_bf16_f32 v41, v40, v41
    v_lshlrev_b32 v40, 16, v41
    v_and_b32 v41, 0xffff0000, v41
    v_cvt_pk_bf16_f32 v43, v42, v43
    v_lshlrev_b32 v42, 16, v43
    v_and_b32 v43, 0xffff0000, v43
    v_mul_f32 v5, 0xbfb8aa3b, v40
    v_exp_f32 v5, v5
    s_nop 0
    v_add_f32 v5, 1.0, v5
    v_rcp_f32 v5, v5
    s_nop 0
    v_mul_f32 v40, v5, v40
    v_mul_f32 v6, 0xbfb8aa3b, v41
    v_exp_f32 v6, v6
    s_nop 0
    v_add_f32 v6, 1.0, v6
    v_rcp_f32 v6, v6
    s_nop 0
    v_mul_f32 v41, v6, v41
    v_mul_f32 v5, 0xbfb8aa3b, v42
    v_exp_f32 v5, v5
    s_nop 0
    v_add_f32 v5, 1.0, v5
    v_rcp_f32 v5, v5
    s_nop 0
    v_mul_f32 v42, v5, v42
    v_mul_f32 v6, 0xbfb8aa3b, v43
    v_exp_f32 v6, v6
    s_nop 0
    v_add_f32 v6, 1.0, v6
    v_rcp_f32 v6, v6
    s_nop 0
    v_mul_f32 v43, v6, v43
    v_cvt_pk_bf16_f32 v40, v40, v41
    v_cvt_pk_bf16_f32 v41, v42, v43
    buffer_store_dwordx2 v[40:41], v253, s[16:19], 0 offen offset:256
    v_cvt_pk_bf16_f32 v45, v44, v45
    v_lshlrev_b32 v44, 16, v45
    v_and_b32 v45, 0xffff0000, v45
    v_cvt_pk_bf16_f32 v47, v46, v47
    v_lshlrev_b32 v46, 16, v47
    v_and_b32 v47, 0xffff0000, v47
    v_mul_f32 v5, 0xbfb8aa3b, v44
    v_exp_f32 v5, v5
    s_nop 0
    v_add_f32 v5, 1.0, v5
    v_rcp_f32 v5, v5
    s_nop 0
    v_mul_f32 v44, v5, v44
    v_mul_f32 v6, 0xbfb8aa3b, v45
    v_exp_f32 v6, v6
    s_nop 0
    v_add_f32 v6, 1.0, v6
    v_rcp_f32 v6, v6
    s_nop 0
    v_mul_f32 v45, v6, v45
    v_mul_f32 v5, 0xbfb8aa3b, v46
    v_exp_f32 v5, v5
    s_nop 0
    v_add_f32 v5, 1.0, v5
    v_rcp_f32 v5, v5
    s_nop 0
    v_mul_f32 v46, v5, v46
    v_mul_f32 v6, 0xbfb8aa3b, v47
    v_exp_f32 v6, v6
    s_nop 0
    v_add_f32 v6, 1.0, v6
    v_rcp_f32 v6, v6
    s_nop 0
    v_mul_f32 v47, v6, v47
    v_cvt_pk_bf16_f32 v44, v44, v45
    v_cvt_pk_bf16_f32 v45, v46, v47
    buffer_store_dwordx2 v[44:45], v253, s[16:19], s29 offen offset:0
    v_cvt_pk_bf16_f32 v49, v48, v49
    v_lshlrev_b32 v48, 16, v49
    v_and_b32 v49, 0xffff0000, v49
    v_cvt_pk_bf16_f32 v51, v50, v51
    v_lshlrev_b32 v50, 16, v51
    v_and_b32 v51, 0xffff0000, v51
    v_mul_f32 v5, 0xbfb8aa3b, v48
    v_exp_f32 v5, v5
    s_nop 0
    v_add_f32 v5, 1.0, v5
    v_rcp_f32 v5, v5
    s_nop 0
    v_mul_f32 v48, v5, v48
    v_mul_f32 v6, 0xbfb8aa3b, v49
    v_exp_f32 v6, v6
    s_nop 0
    v_add_f32 v6, 1.0, v6
    v_rcp_f32 v6, v6
    s_nop 0
    v_mul_f32 v49, v6, v49
    v_mul_f32 v5, 0xbfb8aa3b, v50
    v_exp_f32 v5, v5
    s_nop 0
    v_add_f32 v5, 1.0, v5
    v_rcp_f32 v5, v5
    s_nop 0
    v_mul_f32 v50, v5, v50
    v_mul_f32 v6, 0xbfb8aa3b, v51
    v_exp_f32 v6, v6
    s_nop 0
    v_add_f32 v6, 1.0, v6
    v_rcp_f32 v6, v6
    s_nop 0
    v_mul_f32 v51, v6, v51
    v_cvt_pk_bf16_f32 v48, v48, v49
    v_cvt_pk_bf16_f32 v49, v50, v51
    buffer_store_dwordx2 v[48:49], v253, s[16:19], s29 offen offset:32
    v_cvt_pk_bf16_f32 v53, v52, v53
    v_lshlrev_b32 v52, 16, v53
    v_and_b32 v53, 0xffff0000, v53
    v_cvt_pk_bf16_f32 v55, v54, v55
    v_lshlrev_b32 v54, 16, v55
    v_and_b32 v55, 0xffff0000, v55
    v_mul_f32 v5, 0xbfb8aa3b, v52
    v_exp_f32 v5, v5
    s_nop 0
    v_add_f32 v5, 1.0, v5
    v_rcp_f32 v5, v5
    s_nop 0
    v_mul_f32 v52, v5, v52
    v_mul_f32 v6, 0xbfb8aa3b, v53
    v_exp_f32 v6, v6
    s_nop 0
    v_add_f32 v6, 1.0, v6
    v_rcp_f32 v6, v6
    s_nop 0
    v_mul_f32 v53, v6, v53
    v_mul_f32 v5, 0xbfb8aa3b, v54
    v_exp_f32 v5, v5
    s_nop 0
    v_add_f32 v5, 1.0, v5
    v_rcp_f32 v5, v5
    s_nop 0
    v_mul_f32 v54, v5, v54
    v_mul_f32 v6, 0xbfb8aa3b, v55
    v_exp_f32 v6, v6
    s_nop 0
    v_add_f32 v6, 1.0, v6
    v_rcp_f32 v6, v6
    s_nop 0
    v_mul_f32 v55, v6, v55
    v_cvt_pk_bf16_f32 v52, v52, v53
    v_cvt_pk_bf16_f32 v53, v54, v55
    buffer_store_dwordx2 v[52:53], v253, s[16:19], s29 offen offset:64
    v_cvt_pk_bf16_f32 v57, v56, v57
    v_lshlrev_b32 v56, 16, v57
    v_and_b32 v57, 0xffff0000, v57
    v_cvt_pk_bf16_f32 v59, v58, v59
    v_lshlrev_b32 v58, 16, v59
    v_and_b32 v59, 0xffff0000, v59
    v_mul_f32 v5, 0xbfb8aa3b, v56
    v_exp_f32 v5, v5
    s_nop 0
    v_add_f32 v5, 1.0, v5
    v_rcp_f32 v5, v5
    s_nop 0
    v_mul_f32 v56, v5, v56
    v_mul_f32 v6, 0xbfb8aa3b, v57
    v_exp_f32 v6, v6
    s_nop 0
    v_add_f32 v6, 1.0, v6
    v_rcp_f32 v6, v6
    s_nop 0
    v_mul_f32 v57, v6, v57
    v_mul_f32 v5, 0xbfb8aa3b, v58
    v_exp_f32 v5, v5
    s_nop 0
    v_add_f32 v5, 1.0, v5
    v_rcp_f32 v5, v5
    s_nop 0
    v_mul_f32 v58, v5, v58
    v_mul_f32 v6, 0xbfb8aa3b, v59
    v_exp_f32 v6, v6
    s_nop 0
    v_add_f32 v6, 1.0, v6
    v_rcp_f32 v6, v6
    s_nop 0
    v_mul_f32 v59, v6, v59
    v_cvt_pk_bf16_f32 v56, v56, v57
    v_cvt_pk_bf16_f32 v57, v58, v59
    buffer_store_dwordx2 v[56:57], v253, s[16:19], s29 offen offset:96
    v_cvt_pk_bf16_f32 v61, v60, v61
    v_lshlrev_b32 v60, 16, v61
    v_and_b32 v61, 0xffff0000, v61
    v_cvt_pk_bf16_f32 v63, v62, v63
    v_lshlrev_b32 v62, 16, v63
    v_and_b32 v63, 0xffff0000, v63
    v_mul_f32 v5, 0xbfb8aa3b, v60
    v_exp_f32 v5, v5
    s_nop 0
    v_add_f32 v5, 1.0, v5
    v_rcp_f32 v5, v5
    s_nop 0
    v_mul_f32 v60, v5, v60
    v_mul_f32 v6, 0xbfb8aa3b, v61
    v_exp_f32 v6, v6
    s_nop 0
    v_add_f32 v6, 1.0, v6
    v_rcp_f32 v6, v6
    s_nop 0
    v_mul_f32 v61, v6, v61
    v_mul_f32 v5, 0xbfb8aa3b, v62
    v_exp_f32 v5, v5
    s_nop 0
    v_add_f32 v5, 1.0, v5
    v_rcp_f32 v5, v5
    s_nop 0
    v_mul_f32 v62, v5, v62
    v_mul_f32 v6, 0xbfb8aa3b, v63
    v_exp_f32 v6, v6
    s_nop 0
    v_add_f32 v6, 1.0, v6
    v_rcp_f32 v6, v6
    s_nop 0
    v_mul_f32 v63, v6, v63
    v_cvt_pk_bf16_f32 v60, v60, v61
    v_cvt_pk_bf16_f32 v61, v62, v63
    buffer_store_dwordx2 v[60:61], v253, s[16:19], s29 offen offset:128
    v_cvt_pk_bf16_f32 v65, v64, v65
    v_lshlrev_b32 v64, 16, v65
    v_and_b32 v65, 0xffff0000, v65
    v_cvt_pk_bf16_f32 v67, v66, v67
    v_lshlrev_b32 v66, 16, v67
    v_and_b32 v67, 0xffff0000, v67
    v_mul_f32 v5, 0xbfb8aa3b, v64
    v_exp_f32 v5, v5
    s_nop 0
    v_add_f32 v5, 1.0, v5
    v_rcp_f32 v5, v5
    s_nop 0
    v_mul_f32 v64, v5, v64
    v_mul_f32 v6, 0xbfb8aa3b, v65
    v_exp_f32 v6, v6
    s_nop 0
    v_add_f32 v6, 1.0, v6
    v_rcp_f32 v6, v6
    s_nop 0
    v_mul_f32 v65, v6, v65
    v_mul_f32 v5, 0xbfb8aa3b, v66
    v_exp_f32 v5, v5
    s_nop 0
    v_add_f32 v5, 1.0, v5
    v_rcp_f32 v5, v5
    s_nop 0
    v_mul_f32 v66, v5, v66
    v_mul_f32 v6, 0xbfb8aa3b, v67
    v_exp_f32 v6, v6
    s_nop 0
    v_add_f32 v6, 1.0, v6
    v_rcp_f32 v6, v6
    s_nop 0
    v_mul_f32 v67, v6, v67
    v_cvt_pk_bf16_f32 v64, v64, v65
    v_cvt_pk_bf16_f32 v65, v66, v67
    buffer_store_dwordx2 v[64:65], v253, s[16:19], s29 offen offset:160
    v_cvt_pk_bf16_f32 v69, v68, v69
    v_lshlrev_b32 v68, 16, v69
    v_and_b32 v69, 0xffff0000, v69
    v_cvt_pk_bf16_f32 v71, v70, v71
    v_lshlrev_b32 v70, 16, v71
    v_and_b32 v71, 0xffff0000, v71
    v_mul_f32 v5, 0xbfb8aa3b, v68
    v_exp_f32 v5, v5
    s_nop 0
    v_add_f32 v5, 1.0, v5
    v_rcp_f32 v5, v5
    s_nop 0
    v_mul_f32 v68, v5, v68
    v_mul_f32 v6, 0xbfb8aa3b, v69
    v_exp_f32 v6, v6
    s_nop 0
    v_add_f32 v6, 1.0, v6
    v_rcp_f32 v6, v6
    s_nop 0
    v_mul_f32 v69, v6, v69
    v_mul_f32 v5, 0xbfb8aa3b, v70
    v_exp_f32 v5, v5
    s_nop 0
    v_add_f32 v5, 1.0, v5
    v_rcp_f32 v5, v5
    s_nop 0
    v_mul_f32 v70, v5, v70
    v_mul_f32 v6, 0xbfb8aa3b, v71
    v_exp_f32 v6, v6
    s_nop 0
    v_add_f32 v6, 1.0, v6
    v_rcp_f32 v6, v6
    s_nop 0
    v_mul_f32 v71, v6, v71
    v_cvt_pk_bf16_f32 v68, v68, v69
    v_cvt_pk_bf16_f32 v69, v70, v71
    buffer_store_dwordx2 v[68:69], v253, s[16:19], s29 offen offset:192
    v_cvt_pk_bf16_f32 v73, v72, v73
    v_lshlrev_b32 v72, 16, v73
    v_and_b32 v73, 0xffff0000, v73
    v_cvt_pk_bf16_f32 v75, v74, v75
    v_lshlrev_b32 v74, 16, v75
    v_and_b32 v75, 0xffff0000, v75
    v_mul_f32 v5, 0xbfb8aa3b, v72
    v_exp_f32 v5, v5
    s_nop 0
    v_add_f32 v5, 1.0, v5
    v_rcp_f32 v5, v5
    s_nop 0
    v_mul_f32 v72, v5, v72
    v_mul_f32 v6, 0xbfb8aa3b, v73
    v_exp_f32 v6, v6
    s_nop 0
    v_add_f32 v6, 1.0, v6
    v_rcp_f32 v6, v6
    s_nop 0
    v_mul_f32 v73, v6, v73
    v_mul_f32 v5, 0xbfb8aa3b, v74
    v_exp_f32 v5, v5
    s_nop 0
    v_add_f32 v5, 1.0, v5
    v_rcp_f32 v5, v5
    s_nop 0
    v_mul_f32 v74, v5, v74
    v_mul_f32 v6, 0xbfb8aa3b, v75
    v_exp_f32 v6, v6
    s_nop 0
    v_add_f32 v6, 1.0, v6
    v_rcp_f32 v6, v6
    s_nop 0
    v_mul_f32 v75, v6, v75
    v_cvt_pk_bf16_f32 v72, v72, v73
    v_cvt_pk_bf16_f32 v73, v74, v75
    buffer_store_dwordx2 v[72:73], v253, s[16:19], s29 offen offset:224
    v_cvt_pk_bf16_f32 v77, v76, v77
    v_lshlrev_b32 v76, 16, v77
    v_and_b32 v77, 0xffff0000, v77
    v_cvt_pk_bf16_f32 v79, v78, v79
    v_lshlrev_b32 v78, 16, v79
    v_and_b32 v79, 0xffff0000, v79
    v_mul_f32 v5, 0xbfb8aa3b, v76
    v_exp_f32 v5, v5
    s_nop 0
    v_add_f32 v5, 1.0, v5
    v_rcp_f32 v5, v5
    s_nop 0
    v_mul_f32 v76, v5, v76
    v_mul_f32 v6, 0xbfb8aa3b, v77
    v_exp_f32 v6, v6
    s_nop 0
    v_add_f32 v6, 1.0, v6
    v_rcp_f32 v6, v6
    s_nop 0
    v_mul_f32 v77, v6, v77
    v_mul_f32 v5, 0xbfb8aa3b, v78
    v_exp_f32 v5, v5
    s_nop 0
    v_add_f32 v5, 1.0, v5
    v_rcp_f32 v5, v5
    s_nop 0
    v_mul_f32 v78, v5, v78
    v_mul_f32 v6, 0xbfb8aa3b, v79
    v_exp_f32 v6, v6
    s_nop 0
    v_add_f32 v6, 1.0, v6
    v_rcp_f32 v6, v6
    s_nop 0
    v_mul_f32 v79, v6, v79
    v_cvt_pk_bf16_f32 v76, v76, v77
    v_cvt_pk_bf16_f32 v77, v78, v79
    buffer_store_dwordx2 v[76:77], v253, s[16:19], s29 offen offset:256
gemm1_kernel_END:
    s_endpgm
.globl gemm2_kernel
.p2align 8
.type gemm2_kernel,@function
gemm2_kernel:
    s_cmp_ge_u32 s2, 256
    s_cbranch_scc1 gemm2_kernel_END
    s_load_dwordx2 s[4:5], s[0:1], 40
    s_load_dwordx2 s[6:7], s[0:1], 80
    s_and_b32 s20, s2, 3
    s_lshr_b32 s21, s2, 2
    s_and_b32 s22, s21, 3
    s_lshr_b32 s23, s21, 2
    s_waitcnt lgkmcnt(0)
    s_add_u32 s8, s6, 16777216
    s_addc_u32 s9, s7, 0
    s_and_b32 s9, s9, 0xffff
    s_mov_b32 s10, 18874368
    s_mov_b32 s11, 0x20000
    s_mov_b32 s12, s4
    s_and_b32 s13, s5, 0xffff
    s_mov_b32 s14, 5308416
    s_mov_b32 s15, 0x20000
    s_add_u32 s16, s6, 37748736
    s_addc_u32 s17, s7, 0
    s_and_b32 s17, s17, 0xffff
    s_mov_b32 s18, 18874368
    s_mov_b32 s19, 0x20000
    v_and_b32 v1, 63, v0
    v_lshrrev_b32 v2, 6, v0
    v_and_b32 v3, 15, v1
    v_lshrrev_b32 v4, 4, v1
    s_lshl_b32 s24, s23, 7
    v_lshlrev_b32 v5, 5, v2
    v_add3_u32 v5, v5, s24, v3
    s_mov_b32 s25, 9216
    v_mul_lo_u32 v5, v5, s25
    v_lshlrev_b32 v6, 4, v4
    s_mul_i32 s26, s20, 2304
    v_add3_u32 v240, v5, v6, s26
    v_add_u32 v241, 147456, v240
    s_mul_i32 s27, s20, 1327104
    s_mul_i32 s28, s22, 288
    s_add_u32 s27, s27, s28
    v_add_u32 v5, 0, v0
    v_mul_u32_u24 v6, 3641, v5
    v_lshrrev_b32 v6, 16, v6
    v_mul_u32_u24 v7, 18, v6
    v_sub_u32 v7, v5, v7
    s_mov_b32 s29, 1152
    v_mul_lo_u32 v242, v6, s29
    v_lshlrev_b32 v5, 4, v7
    v_add3_u32 v242, v242, v5, s27
    v_mul_u32_u24 v247, 288, v6
    v_lshrrev_b32 v6, 3, v6
    v_lshlrev_b32 v6, 7, v6
    v_add3_u32 v247, v247, v6, v5
    v_add_u32 v5, 256, v0
    v_mul_u32_u24 v6, 3641, v5
    v_lshrrev_b32 v6, 16, v6
    v_mul_u32_u24 v7, 18, v6
    v_sub_u32 v7, v5, v7
    s_mov_b32 s29, 1152
    v_mul_lo_u32 v243, v6, s29
    v_lshlrev_b32 v5, 4, v7
    v_add3_u32 v243, v243, v5, s27
    v_mul_u32_u24 v248, 288, v6
    v_lshrrev_b32 v6, 3, v6
    v_lshlrev_b32 v6, 7, v6
    v_add3_u32 v248, v248, v6, v5
    v_add_u32 v5, 512, v0
    v_mul_u32_u24 v6, 3641, v5
    v_lshrrev_b32 v6, 16, v6
    v_mul_u32_u24 v7, 18, v6
    v_sub_u32 v7, v5, v7
    s_mov_b32 s29, 1152
    v_mul_lo_u32 v244, v6, s29
    v_lshlrev_b32 v5, 4, v7
    v_add3_u32 v244, v244, v5, s27
    v_mul_u32_u24 v249, 288, v6
    v_lshrrev_b32 v6, 3, v6
    v_lshlrev_b32 v6, 7, v6
    v_add3_u32 v249, v249, v6, v5
    v_add_u32 v5, 768, v0
    v_mul_u32_u24 v6, 3641, v5
    v_lshrrev_b32 v6, 16, v6
    v_mul_u32_u24 v7, 18, v6
    v_sub_u32 v7, v5, v7
    s_mov_b32 s29, 1152
    v_mul_lo_u32 v245, v6, s29
    v_lshlrev_b32 v5, 4, v7
    v_add3_u32 v245, v245, v5, s27
    v_mul_u32_u24 v250, 288, v6
    v_lshrrev_b32 v6, 3, v6
    v_lshlrev_b32 v6, 7, v6
    v_add3_u32 v250, v250, v6, v5
    v_add_u32 v5, 1024, v0
    v_mul_u32_u24 v6, 3641, v5
    v_lshrrev_b32 v6, 16, v6
    v_mul_u32_u24 v7, 18, v6
    v_sub_u32 v7, v5, v7
    s_mov_b32 s29, 1152
    v_mul_lo_u32 v246, v6, s29
    v_lshlrev_b32 v5, 4, v7
    v_add3_u32 v246, v246, v5, s27
    v_mul_u32_u24 v251, 288, v6
    v_lshrrev_b32 v6, 3, v6
    v_lshlrev_b32 v6, 7, v6
    v_add3_u32 v251, v251, v6, v5
    v_add_u32 v5, 1024, v0
    v_cmp_gt_u32 vcc, 1152, v5
    v_mov_b32 v6, 0x7ffffff0
    s_nop 0
    v_cndmask_b32 v246, v6, v246, vcc
    v_lshlrev_b32 v6, 4, v1
    v_add_u32 v6, 38912, v6
    v_cndmask_b32 v251, v6, v251, vcc
    v_lshrrev_b32 v5, 2, v3
    v_lshlrev_b32 v6, 3, v4
    v_add_u32 v5, v5, v6
    v_mul_u32_u24 v5, 288, v5
    v_lshlrev_b32 v6, 7, v4
    v_and_b32 v7, 3, v3
    v_lshlrev_b32 v7, 3, v7
    v_add3_u32 v252, v5, v6, v7
    s_mov_b32 s30, 0
    buffer_load_dwordx4 v[128:131], v242, s[12:15], s30 offen
    buffer_load_dwordx4 v[132:135], v243, s[12:15], s30 offen
    buffer_load_dwordx4 v[136:139], v244, s[12:15], s30 offen
    buffer_load_dwordx4 v[140:143], v245, s[12:15], s30 offen
    buffer_load_dwordx4 v[144:147], v246, s[12:15], s30 offen
    buffer_load_dwordx4 v[80:83], v240, s[8:11], 0 offen offset:0
    buffer_load_dwordx4 v[84:87], v241, s[8:11], 0 offen offset:0
    buffer_load_dwordx4 v[88:91], v240, s[8:11], 0 offen offset:64
    buffer_load_dwordx4 v[92:95], v241, s[8:11], 0 offen offset:64
    s_mov_b32 s30, 73728
    buffer_load_dwordx4 v[148:151], v242, s[12:15], s30 offen
    buffer_load_dwordx4 v[152:155], v243, s[12:15], s30 offen
    buffer_load_dwordx4 v[156:159], v244, s[12:15], s30 offen
    buffer_load_dwordx4 v[160:163], v245, s[12:15], s30 offen
    buffer_load_dwordx4 v[164:167], v246, s[12:15], s30 offen
    buffer_load_dwordx4 v[96:99], v240, s[8:11], 0 offen offset:128
    buffer_load_dwordx4 v[100:103], v241, s[8:11], 0 offen offset:128
    buffer_load_dwordx4 v[104:107], v240, s[8:11], 0 offen offset:192
    buffer_load_dwordx4 v[108:111], v241, s[8:11], 0 offen offset:192
    s_waitcnt vmcnt(13)
    ds_write_b128 v247, v[128:131] offset:0
    ds_write_b128 v248, v[132:135] offset:0
    ds_write_b128 v249, v[136:139] offset:0
    ds_write_b128 v250, v[140:143] offset:0
    ds_write_b128 v251, v[144:147] offset:0
    s_mov_b32 s30, 147456
    buffer_load_dwordx4 v[128:131], v242, s[12:15], s30 offen
    buffer_load_dwordx4 v[132:135], v243, s[12:15], s30 offen
    buffer_load_dwordx4 v[136:139], v244, s[12:15], s30 offen
    buffer_load_dwordx4 v[140:143], v245, s[12:15], s30 offen
    buffer_load_dwordx4 v[144:147], v246, s[12:15], s30 offen
    s_waitcnt lgkmcnt(0)
    s_barrier
    ds_read_b64_tr_b16 v[168:169], v252 offset:0
    ds_read_b64_tr_b16 v[170:171], v252 offset:1152
    ds_read_b64_tr_b16 v[172:173], v252 offset:32
    ds_read_b64_tr_b16 v[174:175], v252 offset:1184
    ds_read_b64_tr_b16 v[176:177], v252 offset:64
    ds_read_b64_tr_b16 v[178:179], v252 offset:1216
    ds_read_b64_tr_b16 v[180:181], v252 offset:96
    ds_read_b64_tr_b16 v[182:183], v252 offset:1248
    ds_read_b64_tr_b16 v[184:185], v252 offset:128
    ds_read_b64_tr_b16 v[186:187], v252 offset:1280
    ds_read_b64_tr_b16 v[188:189], v252 offset:160
    ds_read_b64_tr_b16 v[190:191], v252 offset:1312
    ds_read_b64_tr_b16 v[192:193], v252 offset:192
    ds_read_b64_tr_b16 v[194:195], v252 offset:1344
    ds_read_b64_tr_b16 v[196:197], v252 offset:224
    ds_read_b64_tr_b16 v[198:199], v252 offset:1376
    ds_read_b64_tr_b16 v[200:201], v252 offset:256
    ds_read_b64_tr_b16 v[202:203], v252 offset:1408
    s_waitcnt vmcnt(14)
    s_waitcnt lgkmcnt(15)
    v_mfma_f32_16x16x32_bf16 v[8:11], v[168:171], v[80:83], 0
    v_mfma_f32_16x16x32_bf16 v[44:47], v[168:171], v[84:87], 0
    ds_read_b64_tr_b16 v[204:205], v252 offset:9728
    ds_read_b64_tr_b16 v[206:207], v252 offset:10880
    s_waitcnt lgkmcnt(15)
    v_mfma_f32_16x16x32_bf16 v[12:15], v[172:175], v[80:83], 0
    v_mfma_f32_16x16x32_bf16 v[48:51], v[172:175], v[84:87], 0
    ds_read_b64_tr_b16 v[208:209], v252 offset:9760
    ds_read_b64_tr_b16 v[210:211], v252 offset:10912
    s_waitcnt lgkmcnt(15)
    v_mfma_f32_16x16x32_bf16 v[16:19], v[176:179], v[80:83], 0
    v_mfma_f32_16x16x32_bf16 v[52:55], v[176:179], v[84:87], 0
    ds_read_b64_tr_b16 v[212:213], v252 offset:9792
    ds_read_b64_tr_b16 v[214:215], v252 offset:10944
    s_waitcnt lgkmcnt(15)
    v_mfma_f32_16x16x32_bf16 v[20:23], v[180:183], v[80:83], 0
    v_mfma_f32_16x16x32_bf16 v[56:59], v[180:183], v[84:87], 0
    ds_read_b64_tr_b16 v[216:217], v252 offset:9824
    ds_read_b64_tr_b16 v[218:219], v252 offset:10976
    s_waitcnt lgkmcnt(15)
    v_mfma_f32_16x16x32_bf16 v[24:27], v[184:187], v[80:83], 0
    v_mfma_f32_16x16x32_bf16 v[60:63], v[184:187], v[84:87], 0
    ds_read_b64_tr_b16 v[220:221], v252 offset:9856
    ds_read_b64_tr_b16 v[222:223], v252 offset:11008
    s_waitcnt lgkmcnt(15)
    v_mfma_f32_16x16x32_bf16 v[28:31], v[188:191], v[80:83], 0
    v_mfma_f32_16x16x32_bf16 v[64:67], v[188:191], v[84:87], 0
    ds_read_b64_tr_b16 v[224:225], v252 offset:9888
    ds_read_b64_tr_b16 v[226:227], v252 offset:11040
    s_waitcnt lgkmcnt(15)
    v_mfma_f32_16x16x32_bf16 v[32:35], v[192:195], v[80:83], 0
    v_mfma_f32_16x16x32_bf16 v[68:71], v[192:195], v[84:87], 0
    ds_read_b64_tr_b16 v[228:229], v252 offset:9920
    ds_read_b64_tr_b16 v[230:231], v252 offset:11072
    s_waitcnt lgkmcnt(15)
    v_mfma_f32_16x16x32_bf16 v[36:39], v[196:199], v[80:83], 0
    v_mfma_f32_16x16x32_bf16 v[72:75], v[196:199], v[84:87], 0
    ds_read_b64_tr_b16 v[232:233], v252 offset:9952
    ds_read_b64_tr_b16 v[234:235], v252 offset:11104
    s_waitcnt lgkmcnt(15)
    v_mfma_f32_16x16x32_bf16 v[40:43], v[200:203], v[80:83], 0
    v_mfma_f32_16x16x32_bf16 v[76:79], v[200:203], v[84:87], 0
    ds_read_b64_tr_b16 v[236:237], v252 offset:9984
    ds_read_b64_tr_b16 v[238:239], v252 offset:11136
    s_waitcnt lgkmcnt(15)
    v_mfma_f32_16x16x32_bf16 v[8:11], v[204:207], v[88:91], v[8:11]
    v_mfma_f32_16x16x32_bf16 v[44:47], v[204:207], v[92:95], v[44:47]
    s_waitcnt vmcnt(9)
    ds_write_b128 v247, v[148:151] offset:19456
    s_waitcnt lgkmcnt(15)
    v_mfma_f32_16x16x32_bf16 v[12:15], v[208:211], v[88:91], v[12:15]
    v_mfma_f32_16x16x32_bf16 v[48:51], v[208:211], v[92:95], v[48:51]
    ds_write_b128 v248, v[152:155] offset:19456
    ds_write_b128 v249, v[156:159] offset:19456
    s_waitcnt lgkmcnt(15)
    v_mfma_f32_16x16x32_bf16 v[16:19], v[212:215], v[88:91], v[16:19]
    v_mfma_f32_16x16x32_bf16 v[52:55], v[212:215], v[92:95], v[52:55]
    ds_write_b128 v250, v[160:163] offset:19456
    ds_write_b128 v251, v[164:167] offset:19456
    s_waitcnt lgkmcnt(15)
    v_mfma_f32_16x16x32_bf16 v[20:23], v[216:219], v[88:91], v[20:23]
    v_mfma_f32_16x16x32_bf16 v[56:59], v[216:219], v[92:95], v[56:59]
    s_mov_b32 s30, 221184
    buffer_load_dwordx4 v[148:151], v242, s[12:15], s30 offen
    s_waitcnt lgkmcnt(13)
    v_mfma_f32_16x16x32_bf16 v[24:27], v[220:223], v[88:91], v[24:27]
    v_mfma_f32_16x16x32_bf16 v[60:63], v[220:223], v[92:95], v[60:63]
    buffer_load_dwordx4 v[152:155], v243, s[12:15], s30 offen
    buffer_load_dwordx4 v[156:159], v244, s[12:15], s30 offen
    s_waitcnt lgkmcnt(11)
    v_mfma_f32_16x16x32_bf16 v[28:31], v[224:227], v[88:91], v[28:31]
    v_mfma_f32_16x16x32_bf16 v[64:67], v[224:227], v[92:95], v[64:67]
    buffer_load_dwordx4 v[160:163], v245, s[12:15], s30 offen
    buffer_load_dwordx4 v[164:167], v246, s[12:15], s30 offen
    s_waitcnt lgkmcnt(9)
    v_mfma_f32_16x16x32_bf16 v[32:35], v[228:231], v[88:91], v[32:35]
    v_mfma_f32_16x16x32_bf16 v[68:71], v[228:231], v[92:95], v[68:71]
    buffer_load_dwordx4 v[112:115], v240, s[8:11], 0 offen offset:256
    buffer_load_dwordx4 v[116:119], v241, s[8:11], 0 offen offset:256
    s_waitcnt lgkmcnt(7)
    v_mfma_f32_16x16x32_bf16 v[36:39], v[232:235], v[88:91], v[36:39]
    v_mfma_f32_16x16x32_bf16 v[72:75], v[232:235], v[92:95], v[72:75]
    buffer_load_dwordx4 v[120:123], v240, s[8:11], 0 offen offset:320
    buffer_load_dwordx4 v[124:127], v241, s[8:11], 0 offen offset:320
    s_waitcnt lgkmcnt(5)
    v_mfma_f32_16x16x32_bf16 v[40:43], v[236:239], v[88:91], v[40:43]
    v_mfma_f32_16x16x32_bf16 v[76:79], v[236:239], v[92:95], v[76:79]
    s_waitcnt lgkmcnt(0)
    s_barrier
    ds_read_b64_tr_b16 v[168:169], v252 offset:19456
    ds_read_b64_tr_b16 v[170:171], v252 offset:20608
    ds_read_b64_tr_b16 v[172:173], v252 offset:19488
    ds_read_b64_tr_b16 v[174:175], v252 offset:20640
    ds_read_b64_tr_b16 v[176:177], v252 offset:19520
    ds_read_b64_tr_b16 v[178:179], v252 offset:20672
    ds_read_b64_tr_b16 v[180:181], v252 offset:19552
    ds_read_b64_tr_b16 v[182:183], v252 offset:20704
    ds_read_b64_tr_b16 v[184:185], v252 offset:19584
    ds_read_b64_tr_b16 v[186:187], v252 offset:20736
    ds_read_b64_tr_b16 v[188:189], v252 offset:19616
    ds_read_b64_tr_b16 v[190:191], v252 offset:20768
    ds_read_b64_tr_b16 v[192:193], v252 offset:19648
    ds_read_b64_tr_b16 v[194:195], v252 offset:20800
    ds_read_b64_tr_b16 v[196:197], v252 offset:19680
    ds_read_b64_tr_b16 v[198:199], v252 offset:20832
    ds_read_b64_tr_b16 v[200:201], v252 offset:19712
    ds_read_b64_tr_b16 v[202:203], v252 offset:20864
    s_waitcnt vmcnt(14)
    s_waitcnt lgkmcnt(15)
    v_mfma_f32_16x16x32_bf16 v[8:11], v[168:171], v[96:99], v[8:11]
    v_mfma_f32_16x16x32_bf16 v[44:47], v[168:171], v[100:103], v[44:47]
    ds_read_b64_tr_b16 v[204:205], v252 offset:29184
    ds_read_b64_tr_b16 v[206:207], v252 offset:30336
    s_waitcnt lgkmcnt(15)
    v_mfma_f32_16x16x32_bf16 v[12:15], v[172:175], v[96:99], v[12:15]
    v_mfma_f32_16x16x32_bf16 v[48:51], v[172:175], v[100:103], v[48:51]
    ds_read_b64_tr_b16 v[208:209], v252 offset:29216
    ds_read_b64_tr_b16 v[210:211], v252 offset:30368
    s_waitcnt lgkmcnt(15)
    v_mfma_f32_16x16x32_bf16 v[16:19], v[176:179], v[96:99], v[16:19]
    v_mfma_f32_16x16x32_bf16 v[52:55], v[176:179], v[100:103], v[52:55]
    ds_read_b64_tr_b16 v[212:213], v252 offset:29248
    ds_read_b64_tr_b16 v[214:215], v252 offset:30400
    s_waitcnt lgkmcnt(15)
    v_mfma_f32_16x16x32_bf16 v[20:23], v[180:183], v[96:99], v[20:23]
    v_mfma_f32_16x16x32_bf16 v[56:59], v[180:183], v[100:103], v[56:59]
    ds_read_b64_tr_b16 v[216:217], v252 offset:29280
    ds_read_b64_tr_b16 v[218:219], v252 offset:30432
    s_waitcnt lgkmcnt(15)
    v_mfma_f32_16x16x32_bf16 v[24:27], v[184:187], v[96:99], v[24:27]
    v_mfma_f32_16x16x32_bf16 v[60:63], v[184:187], v[100:103], v[60:63]
    ds_read_b64_tr_b16 v[220:221], v252 offset:29312
    ds_read_b64_tr_b16 v[222:223], v252 offset:30464
    s_waitcnt lgkmcnt(15)
    v_mfma_f32_16x16x32_bf16 v[28:31], v[188:191], v[96:99], v[28:31]
    v_mfma_f32_16x16x32_bf16 v[64:67], v[188:191], v[100:103], v[64:67]
    ds_read_b64_tr_b16 v[224:225], v252 offset:29344
    ds_read_b64_tr_b16 v[226:227], v252 offset:30496
    s_waitcnt lgkmcnt(15)
    v_mfma_f32_16x16x32_bf16 v[32:35], v[192:195], v[96:99], v[32:35]
    v_mfma_f32_16x16x32_bf16 v[68:71], v[192:195], v[100:103], v[68:71]
    ds_read_b64_tr_b16 v[228:229], v252 offset:29376
    ds_read_b64_tr_b16 v[230:231], v252 offset:30528
    s_waitcnt lgkmcnt(15)
    v_mfma_f32_16x16x32_bf16 v[36:39], v[196:199], v[96:99], v[36:39]
    v_mfma_f32_16x16x32_bf16 v[72:75], v[196:199], v[100:103], v[72:75]
    ds_read_b64_tr_b16 v[232:233], v252 offset:29408
    ds_read_b64_tr_b16 v[234:235], v252 offset:30560
    s_waitcnt lgkmcnt(15)
    v_mfma_f32_16x16x32_bf16 v[40:43], v[200:203], v[96:99], v[40:43]
    v_mfma_f32_16x16x32_bf16 v[76:79], v[200:203], v[100:103], v[76:79]
    ds_read_b64_tr_b16 v[236:237], v252 offset:29440
    ds_read_b64_tr_b16 v[238:239], v252 offset:30592
    s_waitcnt lgkmcnt(15)
    v_mfma_f32_16x16x32_bf16 v[8:11], v[204:207], v[104:107], v[8:11]
    v_mfma_f32_16x16x32_bf16 v[44:47], v[204:207], v[108:111], v[44:47]
    s_waitcnt vmcnt(9)
    ds_write_b128 v247, v[128:131] offset:0
    s_waitcnt lgkmcnt(15)
    v_mfma_f32_16x16x32_bf16 v[12:15], v[208:211], v[104:107], v[12:15]
    v_mfma_f32_16x16x32_bf16 v[48:51], v[208:211], v[108:111], v[48:51]
    ds_write_b128 v248, v[132:135] offset:0
    ds_write_b128 v249, v[136:139] offset:0
    s_waitcnt lgkmcnt(15)
    v_mfma_f32_16x16x32_bf16 v[16:19], v[212:215], v[104:107], v[16:19]
    v_mfma_f32_16x16x32_bf16 v[52:55], v[212:215], v[108:111], v[52:55]
    ds_write_b128 v250, v[140:143] offset:0
    ds_write_b128 v251, v[144:147] offset:0
    s_waitcnt lgkmcnt(15)
    v_mfma_f32_16x16x32_bf16 v[20:23], v[216:219], v[104:107], v[20:23]
    v_mfma_f32_16x16x32_bf16 v[56:59], v[216:219], v[108:111], v[56:59]
    s_mov_b32 s30, 294912
    buffer_load_dwordx4 v[128:131], v242, s[12:15], s30 offen
    s_waitcnt lgkmcnt(13)
    v_mfma_f32_16x16x32_bf16 v[24:27], v[220:223], v[104:107], v[24:27]
    v_mfma_f32_16x16x32_bf16 v[60:63], v[220:223], v[108:111], v[60:63]
    buffer_load_dwordx4 v[132:135], v243, s[12:15], s30 offen
    buffer_load_dwordx4 v[136:139], v244, s[12:15], s30 offen
    s_waitcnt lgkmcnt(11)
    v_mfma_f32_16x16x32_bf16 v[28:31], v[224:227], v[104:107], v[28:31]
    v_mfma_f32_16x16x32_bf16 v[64:67], v[224:227], v[108:111], v[64:67]
    buffer_load_dwordx4 v[140:143], v245, s[12:15], s30 offen
    buffer_load_dwordx4 v[144:147], v246, s[12:15], s30 offen
    s_waitcnt lgkmcnt(9)
    v_mfma_f32_16x16x32_bf16 v[32:35], v[228:231], v[104:107], v[32:35]
    v_mfma_f32_16x16x32_bf16 v[68:71], v[228:231], v[108:111], v[68:71]
    buffer_load_dwordx4 v[80:83], v240, s[8:11], 0 offen offset:384
    buffer_load_dwordx4 v[84:87], v241, s[8:11], 0 offen offset:384
    s_waitcnt lgkmcnt(7)
    v_mfma_f32_16x16x32_bf16 v[36:39], v[232:235], v[104:107], v[36:39]
    v_mfma_f32_16x16x32_bf16 v[72:75], v[232:235], v[108:111], v[72:75]
    buffer_load_dwordx4 v[88:91], v240, s[8:11], 0 offen offset:448
    buffer_load_dwordx4 v[92:95], v241, s[8:11], 0 offen offset:448
    s_waitcnt lgkmcnt(5)
    v_mfma_f32_16x16x32_bf16 v[40:43], v[236:239], v[104:107], v[40:43]
    v_mfma_f32_16x16x32_bf16 v[76:79], v[236:239], v[108:111], v[76:79]
    s_waitcnt lgkmcnt(0)
    s_barrier
    ds_read_b64_tr_b16 v[168:169], v252 offset:0
    ds_read_b64_tr_b16 v[170:171], v252 offset:1152
    ds_read_b64_tr_b16 v[172:173], v252 offset:32
    ds_read_b64_tr_b16 v[174:175], v252 offset:1184
    ds_read_b64_tr_b16 v[176:177], v252 offset:64
    ds_read_b64_tr_b16 v[178:179], v252 offset:1216
    ds_read_b64_tr_b16 v[180:181], v252 offset:96
    ds_read_b64_tr_b16 v[182:183], v252 offset:1248
    ds_read_b64_tr_b16 v[184:185], v252 offset:128
    ds_read_b64_tr_b16 v[186:187], v252 offset:1280
    ds_read_b64_tr_b16 v[188:189], v252 offset:160
    ds_read_b64_tr_b16 v[190:191], v252 offset:1312
    ds_read_b64_tr_b16 v[192:193], v252 offset:192
    ds_read_b64_tr_b16 v[194:195], v252 offset:1344
    ds_read_b64_tr_b16 v[196:197], v252 offset:224
    ds_read_b64_tr_b16 v[198:199], v252 offset:1376
    ds_read_b64_tr_b16 v[200:201], v252 offset:256
    ds_read_b64_tr_b16 v[202:203], v252 offset:1408
    s_waitcnt vmcnt(9)
    s_waitcnt lgkmcnt(15)
    v_mfma_f32_16x16x32_bf16 v[8:11], v[168:171], v[112:115], v[8:11]
    v_mfma_f32_16x16x32_bf16 v[44:47], v[168:171], v[116:119], v[44:47]
    ds_read_b64_tr_b16 v[204:205], v252 offset:9728
    ds_read_b64_tr_b16 v[206:207], v252 offset:10880
    s_waitcnt lgkmcnt(15)
    v_mfma_f32_16x16x32_bf16 v[12:15], v[172:175], v[112:115], v[12:15]
    v_mfma_f32_16x16x32_bf16 v[48:51], v[172:175], v[116:119], v[48:51]
    ds_read_b64_tr_b16 v[208:209], v252 offset:9760
    ds_read_b64_tr_b16 v[210:211], v252 offset:10912
    s_waitcnt lgkmcnt(15)
    v_mfma_f32_16x16x32_bf16 v[16:19], v[176:179], v[112:115], v[16:19]
    v_mfma_f32_16x16x32_bf16 v[52:55], v[176:179], v[116:119], v[52:55]
    ds_read_b64_tr_b16 v[212:213], v252 offset:9792
    ds_read_b64_tr_b16 v[214:215], v252 offset:10944
    s_waitcnt lgkmcnt(15)
    v_mfma_f32_16x16x32_bf16 v[20:23], v[180:183], v[112:115], v[20:23]
    v_mfma_f32_16x16x32_bf16 v[56:59], v[180:183], v[116:119], v[56:59]
    ds_read_b64_tr_b16 v[216:217], v252 offset:9824
    ds_read_b64_tr_b16 v[218:219], v252 offset:10976
    s_waitcnt lgkmcnt(15)
    v_mfma_f32_16x16x32_bf16 v[24:27], v[184:187], v[112:115], v[24:27]
    v_mfma_f32_16x16x32_bf16 v[60:63], v[184:187], v[116:119], v[60:63]
    ds_read_b64_tr_b16 v[220:221], v252 offset:9856
    ds_read_b64_tr_b16 v[222:223], v252 offset:11008
    s_waitcnt lgkmcnt(15)
    v_mfma_f32_16x16x32_bf16 v[28:31], v[188:191], v[112:115], v[28:31]
    v_mfma_f32_16x16x32_bf16 v[64:67], v[188:191], v[116:119], v[64:67]
    ds_read_b64_tr_b16 v[224:225], v252 offset:9888
    ds_read_b64_tr_b16 v[226:227], v252 offset:11040
    s_waitcnt lgkmcnt(15)
    v_mfma_f32_16x16x32_bf16 v[32:35], v[192:195], v[112:115], v[32:35]
    v_mfma_f32_16x16x32_bf16 v[68:71], v[192:195], v[116:119], v[68:71]
    ds_read_b64_tr_b16 v[228:229], v252 offset:9920
    ds_read_b64_tr_b16 v[230:231], v252 offset:11072
    s_waitcnt lgkmcnt(15)
    v_mfma_f32_16x16x32_bf16 v[36:39], v[196:199], v[112:115], v[36:39]
    v_mfma_f32_16x16x32_bf16 v[72:75], v[196:199], v[116:119], v[72:75]
    ds_read_b64_tr_b16 v[232:233], v252 offset:9952
    ds_read_b64_tr_b16 v[234:235], v252 offset:11104
    s_waitcnt lgkmcnt(15)
    v_mfma_f32_16x16x32_bf16 v[40:43], v[200:203], v[112:115], v[40:43]
    v_mfma_f32_16x16x32_bf16 v[76:79], v[200:203], v[116:119], v[76:79]
    ds_read_b64_tr_b16 v[236:237], v252 offset:9984
    ds_read_b64_tr_b16 v[238:239], v252 offset:11136
    s_waitcnt lgkmcnt(15)
    v_mfma_f32_16x16x32_bf16 v[8:11], v[204:207], v[120:123], v[8:11]
    v_mfma_f32_16x16x32_bf16 v[44:47], v[204:207], v[124:127], v[44:47]
    s_waitcnt vmcnt(13)
    ds_write_b128 v247, v[148:151] offset:19456
    s_waitcnt lgkmcnt(15)
    v_mfma_f32_16x16x32_bf16 v[12:15], v[208:211], v[120:123], v[12:15]
    v_mfma_f32_16x16x32_bf16 v[48:51], v[208:211], v[124:127], v[48:51]
    ds_write_b128 v248, v[152:155] offset:19456
    ds_write_b128 v249, v[156:159] offset:19456
    s_waitcnt lgkmcnt(15)
    v_mfma_f32_16x16x32_bf16 v[16:19], v[212:215], v[120:123], v[16:19]
    v_mfma_f32_16x16x32_bf16 v[52:55], v[212:215], v[124:127], v[52:55]
    ds_write_b128 v250, v[160:163] offset:19456
    ds_write_b128 v251, v[164:167] offset:19456
    s_waitcnt lgkmcnt(15)
    v_mfma_f32_16x16x32_bf16 v[20:23], v[216:219], v[120:123], v[20:23]
    v_mfma_f32_16x16x32_bf16 v[56:59], v[216:219], v[124:127], v[56:59]
    s_mov_b32 s30, 368640
    buffer_load_dwordx4 v[148:151], v242, s[12:15], s30 offen
    s_waitcnt lgkmcnt(13)
    v_mfma_f32_16x16x32_bf16 v[24:27], v[220:223], v[120:123], v[24:27]
    v_mfma_f32_16x16x32_bf16 v[60:63], v[220:223], v[124:127], v[60:63]
    buffer_load_dwordx4 v[152:155], v243, s[12:15], s30 offen
    buffer_load_dwordx4 v[156:159], v244, s[12:15], s30 offen
    s_waitcnt lgkmcnt(11)
    v_mfma_f32_16x16x32_bf16 v[28:31], v[224:227], v[120:123], v[28:31]
    v_mfma_f32_16x16x32_bf16 v[64:67], v[224:227], v[124:127], v[64:67]
    buffer_load_dwordx4 v[160:163], v245, s[12:15], s30 offen
    buffer_load_dwordx4 v[164:167], v246, s[12:15], s30 offen
    s_waitcnt lgkmcnt(9)
    v_mfma_f32_16x16x32_bf16 v[32:35], v[228:231], v[120:123], v[32:35]
    v_mfma_f32_16x16x32_bf16 v[68:71], v[228:231], v[124:127], v[68:71]
    buffer_load_dwordx4 v[96:99], v240, s[8:11], 0 offen offset:512
    buffer_load_dwordx4 v[100:103], v241, s[8:11], 0 offen offset:512
    s_waitcnt lgkmcnt(7)
    v_mfma_f32_16x16x32_bf16 v[36:39], v[232:235], v[120:123], v[36:39]
    v_mfma_f32_16x16x32_bf16 v[72:75], v[232:235], v[124:127], v[72:75]
    buffer_load_dwordx4 v[104:107], v240, s[8:11], 0 offen offset:576
    buffer_load_dwordx4 v[108:111], v241, s[8:11], 0 offen offset:576
    s_waitcnt lgkmcnt(5)
    v_mfma_f32_16x16x32_bf16 v[40:43], v[236:239], v[120:123], v[40:43]
    v_mfma_f32_16x16x32_bf16 v[76:79], v[236:239], v[124:127], v[76:79]
    s_waitcnt lgkmcnt(0)
    s_barrier
    ds_read_b64_tr_b16 v[168:169], v252 offset:19456
    ds_read_b64_tr_b16 v[170:171], v252 offset:20608
    ds_read_b64_tr_b16 v[172:173], v252 offset:19488
    ds_read_b64_tr_b16 v[174:175], v252 offset:20640
    ds_read_b64_tr_b16 v[176:177], v252 offset:19520
    ds_read_b64_tr_b16 v[178:179], v252 offset:20672
    ds_read_b64_tr_b16 v[180:181], v252 offset:19552
    ds_read_b64_tr_b16 v[182:183], v252 offset:20704
    ds_read_b64_tr_b16 v[184:185], v252 offset:19584
    ds_read_b64_tr_b16 v[186:187], v252 offset:20736
    ds_read_b64_tr_b16 v[188:189], v252 offset:19616
    ds_read_b64_tr_b16 v[190:191], v252 offset:20768
    ds_read_b64_tr_b16 v[192:193], v252 offset:19648
    ds_read_b64_tr_b16 v[194:195], v252 offset:20800
    ds_read_b64_tr_b16 v[196:197], v252 offset:19680
    ds_read_b64_tr_b16 v[198:199], v252 offset:20832
    ds_read_b64_tr_b16 v[200:201], v252 offset:19712
    ds_read_b64_tr_b16 v[202:203], v252 offset:20864
    s_waitcnt vmcnt(9)
    s_waitcnt lgkmcnt(15)
    v_mfma_f32_16x16x32_bf16 v[8:11], v[168:171], v[80:83], v[8:11]
    v_mfma_f32_16x16x32_bf16 v[44:47], v[168:171], v[84:87], v[44:47]
    ds_read_b64_tr_b16 v[204:205], v252 offset:29184
    ds_read_b64_tr_b16 v[206:207], v252 offset:30336
    s_waitcnt lgkmcnt(15)
    v_mfma_f32_16x16x32_bf16 v[12:15], v[172:175], v[80:83], v[12:15]
    v_mfma_f32_16x16x32_bf16 v[48:51], v[172:175], v[84:87], v[48:51]
    ds_read_b64_tr_b16 v[208:209], v252 offset:29216
    ds_read_b64_tr_b16 v[210:211], v252 offset:30368
    s_waitcnt lgkmcnt(15)
    v_mfma_f32_16x16x32_bf16 v[16:19], v[176:179], v[80:83], v[16:19]
    v_mfma_f32_16x16x32_bf16 v[52:55], v[176:179], v[84:87], v[52:55]
    ds_read_b64_tr_b16 v[212:213], v252 offset:29248
    ds_read_b64_tr_b16 v[214:215], v252 offset:30400
    s_waitcnt lgkmcnt(15)
    v_mfma_f32_16x16x32_bf16 v[20:23], v[180:183], v[80:83], v[20:23]
    v_mfma_f32_16x16x32_bf16 v[56:59], v[180:183], v[84:87], v[56:59]
    ds_read_b64_tr_b16 v[216:217], v252 offset:29280
    ds_read_b64_tr_b16 v[218:219], v252 offset:30432
    s_waitcnt lgkmcnt(15)
    v_mfma_f32_16x16x32_bf16 v[24:27], v[184:187], v[80:83], v[24:27]
    v_mfma_f32_16x16x32_bf16 v[60:63], v[184:187], v[84:87], v[60:63]
    ds_read_b64_tr_b16 v[220:221], v252 offset:29312
    ds_read_b64_tr_b16 v[222:223], v252 offset:30464
    s_waitcnt lgkmcnt(15)
    v_mfma_f32_16x16x32_bf16 v[28:31], v[188:191], v[80:83], v[28:31]
    v_mfma_f32_16x16x32_bf16 v[64:67], v[188:191], v[84:87], v[64:67]
    ds_read_b64_tr_b16 v[224:225], v252 offset:29344
    ds_read_b64_tr_b16 v[226:227], v252 offset:30496
    s_waitcnt lgkmcnt(15)
    v_mfma_f32_16x16x32_bf16 v[32:35], v[192:195], v[80:83], v[32:35]
    v_mfma_f32_16x16x32_bf16 v[68:71], v[192:195], v[84:87], v[68:71]
    ds_read_b64_tr_b16 v[228:229], v252 offset:29376
    ds_read_b64_tr_b16 v[230:231], v252 offset:30528
    s_waitcnt lgkmcnt(15)
    v_mfma_f32_16x16x32_bf16 v[36:39], v[196:199], v[80:83], v[36:39]
    v_mfma_f32_16x16x32_bf16 v[72:75], v[196:199], v[84:87], v[72:75]
    ds_read_b64_tr_b16 v[232:233], v252 offset:29408
    ds_read_b64_tr_b16 v[234:235], v252 offset:30560
    s_waitcnt lgkmcnt(15)
    v_mfma_f32_16x16x32_bf16 v[40:43], v[200:203], v[80:83], v[40:43]
    v_mfma_f32_16x16x32_bf16 v[76:79], v[200:203], v[84:87], v[76:79]
    ds_read_b64_tr_b16 v[236:237], v252 offset:29440
    ds_read_b64_tr_b16 v[238:239], v252 offset:30592
    s_waitcnt lgkmcnt(15)
    v_mfma_f32_16x16x32_bf16 v[8:11], v[204:207], v[88:91], v[8:11]
    v_mfma_f32_16x16x32_bf16 v[44:47], v[204:207], v[92:95], v[44:47]
    s_waitcnt vmcnt(13)
    ds_write_b128 v247, v[128:131] offset:0
    s_waitcnt lgkmcnt(15)
    v_mfma_f32_16x16x32_bf16 v[12:15], v[208:211], v[88:91], v[12:15]
    v_mfma_f32_16x16x32_bf16 v[48:51], v[208:211], v[92:95], v[48:51]
    ds_write_b128 v248, v[132:135] offset:0
    ds_write_b128 v249, v[136:139] offset:0
    s_waitcnt lgkmcnt(15)
    v_mfma_f32_16x16x32_bf16 v[16:19], v[212:215], v[88:91], v[16:19]
    v_mfma_f32_16x16x32_bf16 v[52:55], v[212:215], v[92:95], v[52:55]
    ds_write_b128 v250, v[140:143] offset:0
    ds_write_b128 v251, v[144:147] offset:0
    s_waitcnt lgkmcnt(15)
    v_mfma_f32_16x16x32_bf16 v[20:23], v[216:219], v[88:91], v[20:23]
    v_mfma_f32_16x16x32_bf16 v[56:59], v[216:219], v[92:95], v[56:59]
    s_mov_b32 s30, 442368
    buffer_load_dwordx4 v[128:131], v242, s[12:15], s30 offen
    s_waitcnt lgkmcnt(13)
    v_mfma_f32_16x16x32_bf16 v[24:27], v[220:223], v[88:91], v[24:27]
    v_mfma_f32_16x16x32_bf16 v[60:63], v[220:223], v[92:95], v[60:63]
    buffer_load_dwordx4 v[132:135], v243, s[12:15], s30 offen
    buffer_load_dwordx4 v[136:139], v244, s[12:15], s30 offen
    s_waitcnt lgkmcnt(11)
    v_mfma_f32_16x16x32_bf16 v[28:31], v[224:227], v[88:91], v[28:31]
    v_mfma_f32_16x16x32_bf16 v[64:67], v[224:227], v[92:95], v[64:67]
    buffer_load_dwordx4 v[140:143], v245, s[12:15], s30 offen
    buffer_load_dwordx4 v[144:147], v246, s[12:15], s30 offen
    s_waitcnt lgkmcnt(9)
    v_mfma_f32_16x16x32_bf16 v[32:35], v[228:231], v[88:91], v[32:35]
    v_mfma_f32_16x16x32_bf16 v[68:71], v[228:231], v[92:95], v[68:71]
    buffer_load_dwordx4 v[112:115], v240, s[8:11], 0 offen offset:640
    buffer_load_dwordx4 v[116:119], v241, s[8:11], 0 offen offset:640
    s_waitcnt lgkmcnt(7)
    v_mfma_f32_16x16x32_bf16 v[36:39], v[232:235], v[88:91], v[36:39]
    v_mfma_f32_16x16x32_bf16 v[72:75], v[232:235], v[92:95], v[72:75]
    buffer_load_dwordx4 v[120:123], v240, s[8:11], 0 offen offset:704
    buffer_load_dwordx4 v[124:127], v241, s[8:11], 0 offen offset:704
    s_waitcnt lgkmcnt(5)
    v_mfma_f32_16x16x32_bf16 v[40:43], v[236:239], v[88:91], v[40:43]
    v_mfma_f32_16x16x32_bf16 v[76:79], v[236:239], v[92:95], v[76:79]
    s_waitcnt lgkmcnt(0)
    s_barrier
    ds_read_b64_tr_b16 v[168:169], v252 offset:0
    ds_read_b64_tr_b16 v[170:171], v252 offset:1152
    ds_read_b64_tr_b16 v[172:173], v252 offset:32
    ds_read_b64_tr_b16 v[174:175], v252 offset:1184
    ds_read_b64_tr_b16 v[176:177], v252 offset:64
    ds_read_b64_tr_b16 v[178:179], v252 offset:1216
    ds_read_b64_tr_b16 v[180:181], v252 offset:96
    ds_read_b64_tr_b16 v[182:183], v252 offset:1248
    ds_read_b64_tr_b16 v[184:185], v252 offset:128
    ds_read_b64_tr_b16 v[186:187], v252 offset:1280
    ds_read_b64_tr_b16 v[188:189], v252 offset:160
    ds_read_b64_tr_b16 v[190:191], v252 offset:1312
    ds_read_b64_tr_b16 v[192:193], v252 offset:192
    ds_read_b64_tr_b16 v[194:195], v252 offset:1344
    ds_read_b64_tr_b16 v[196:197], v252 offset:224
    ds_read_b64_tr_b16 v[198:199], v252 offset:1376
    ds_read_b64_tr_b16 v[200:201], v252 offset:256
    ds_read_b64_tr_b16 v[202:203], v252 offset:1408
    s_waitcnt vmcnt(9)
    s_waitcnt lgkmcnt(15)
    v_mfma_f32_16x16x32_bf16 v[8:11], v[168:171], v[96:99], v[8:11]
    v_mfma_f32_16x16x32_bf16 v[44:47], v[168:171], v[100:103], v[44:47]
    ds_read_b64_tr_b16 v[204:205], v252 offset:9728
    ds_read_b64_tr_b16 v[206:207], v252 offset:10880
    s_waitcnt lgkmcnt(15)
    v_mfma_f32_16x16x32_bf16 v[12:15], v[172:175], v[96:99], v[12:15]
    v_mfma_f32_16x16x32_bf16 v[48:51], v[172:175], v[100:103], v[48:51]
    ds_read_b64_tr_b16 v[208:209], v252 offset:9760
    ds_read_b64_tr_b16 v[210:211], v252 offset:10912
    s_waitcnt lgkmcnt(15)
    v_mfma_f32_16x16x32_bf16 v[16:19], v[176:179], v[96:99], v[16:19]
    v_mfma_f32_16x16x32_bf16 v[52:55], v[176:179], v[100:103], v[52:55]
    ds_read_b64_tr_b16 v[212:213], v252 offset:9792
    ds_read_b64_tr_b16 v[214:215], v252 offset:10944
    s_waitcnt lgkmcnt(15)
    v_mfma_f32_16x16x32_bf16 v[20:23], v[180:183], v[96:99], v[20:23]
    v_mfma_f32_16x16x32_bf16 v[56:59], v[180:183], v[100:103], v[56:59]
    ds_read_b64_tr_b16 v[216:217], v252 offset:9824
    ds_read_b64_tr_b16 v[218:219], v252 offset:10976
    s_waitcnt lgkmcnt(15)
    v_mfma_f32_16x16x32_bf16 v[24:27], v[184:187], v[96:99], v[24:27]
    v_mfma_f32_16x16x32_bf16 v[60:63], v[184:187], v[100:103], v[60:63]
    ds_read_b64_tr_b16 v[220:221], v252 offset:9856
    ds_read_b64_tr_b16 v[222:223], v252 offset:11008
    s_waitcnt lgkmcnt(15)
    v_mfma_f32_16x16x32_bf16 v[28:31], v[188:191], v[96:99], v[28:31]
    v_mfma_f32_16x16x32_bf16 v[64:67], v[188:191], v[100:103], v[64:67]
    ds_read_b64_tr_b16 v[224:225], v252 offset:9888
    ds_read_b64_tr_b16 v[226:227], v252 offset:11040
    s_waitcnt lgkmcnt(15)
    v_mfma_f32_16x16x32_bf16 v[32:35], v[192:195], v[96:99], v[32:35]
    v_mfma_f32_16x16x32_bf16 v[68:71], v[192:195], v[100:103], v[68:71]
    ds_read_b64_tr_b16 v[228:229], v252 offset:9920
    ds_read_b64_tr_b16 v[230:231], v252 offset:11072
    s_waitcnt lgkmcnt(15)
    v_mfma_f32_16x16x32_bf16 v[36:39], v[196:199], v[96:99], v[36:39]
    v_mfma_f32_16x16x32_bf16 v[72:75], v[196:199], v[100:103], v[72:75]
    ds_read_b64_tr_b16 v[232:233], v252 offset:9952
    ds_read_b64_tr_b16 v[234:235], v252 offset:11104
    s_waitcnt lgkmcnt(15)
    v_mfma_f32_16x16x32_bf16 v[40:43], v[200:203], v[96:99], v[40:43]
    v_mfma_f32_16x16x32_bf16 v[76:79], v[200:203], v[100:103], v[76:79]
    ds_read_b64_tr_b16 v[236:237], v252 offset:9984
    ds_read_b64_tr_b16 v[238:239], v252 offset:11136
    s_waitcnt lgkmcnt(15)
    v_mfma_f32_16x16x32_bf16 v[8:11], v[204:207], v[104:107], v[8:11]
    v_mfma_f32_16x16x32_bf16 v[44:47], v[204:207], v[108:111], v[44:47]
    s_waitcnt vmcnt(13)
    ds_write_b128 v247, v[148:151] offset:19456
    s_waitcnt lgkmcnt(15)
    v_mfma_f32_16x16x32_bf16 v[12:15], v[208:211], v[104:107], v[12:15]
    v_mfma_f32_16x16x32_bf16 v[48:51], v[208:211], v[108:111], v[48:51]
    ds_write_b128 v248, v[152:155] offset:19456
    ds_write_b128 v249, v[156:159] offset:19456
    s_waitcnt lgkmcnt(15)
    v_mfma_f32_16x16x32_bf16 v[16:19], v[212:215], v[104:107], v[16:19]
    v_mfma_f32_16x16x32_bf16 v[52:55], v[212:215], v[108:111], v[52:55]
    ds_write_b128 v250, v[160:163] offset:19456
    ds_write_b128 v251, v[164:167] offset:19456
    s_waitcnt lgkmcnt(15)
    v_mfma_f32_16x16x32_bf16 v[20:23], v[216:219], v[104:107], v[20:23]
    v_mfma_f32_16x16x32_bf16 v[56:59], v[216:219], v[108:111], v[56:59]
    s_mov_b32 s30, 516096
    buffer_load_dwordx4 v[148:151], v242, s[12:15], s30 offen
    s_waitcnt lgkmcnt(13)
    v_mfma_f32_16x16x32_bf16 v[24:27], v[220:223], v[104:107], v[24:27]
    v_mfma_f32_16x16x32_bf16 v[60:63], v[220:223], v[108:111], v[60:63]
    buffer_load_dwordx4 v[152:155], v243, s[12:15], s30 offen
    buffer_load_dwordx4 v[156:159], v244, s[12:15], s30 offen
    s_waitcnt lgkmcnt(11)
    v_mfma_f32_16x16x32_bf16 v[28:31], v[224:227], v[104:107], v[28:31]
    v_mfma_f32_16x16x32_bf16 v[64:67], v[224:227], v[108:111], v[64:67]
    buffer_load_dwordx4 v[160:163], v245, s[12:15], s30 offen
    buffer_load_dwordx4 v[164:167], v246, s[12:15], s30 offen
    s_waitcnt lgkmcnt(9)
    v_mfma_f32_16x16x32_bf16 v[32:35], v[228:231], v[104:107], v[32:35]
    v_mfma_f32_16x16x32_bf16 v[68:71], v[228:231], v[108:111], v[68:71]
    buffer_load_dwordx4 v[80:83], v240, s[8:11], 0 offen offset:768
    buffer_load_dwordx4 v[84:87], v241, s[8:11], 0 offen offset:768
    s_waitcnt lgkmcnt(7)
    v_mfma_f32_16x16x32_bf16 v[36:39], v[232:235], v[104:107], v[36:39]
    v_mfma_f32_16x16x32_bf16 v[72:75], v[232:235], v[108:111], v[72:75]
    buffer_load_dwordx4 v[88:91], v240, s[8:11], 0 offen offset:832
    buffer_load_dwordx4 v[92:95], v241, s[8:11], 0 offen offset:832
    s_waitcnt lgkmcnt(5)
    v_mfma_f32_16x16x32_bf16 v[40:43], v[236:239], v[104:107], v[40:43]
    v_mfma_f32_16x16x32_bf16 v[76:79], v[236:239], v[108:111], v[76:79]
    s_waitcnt lgkmcnt(0)
    s_barrier
    ds_read_b64_tr_b16 v[168:169], v252 offset:19456
    ds_read_b64_tr_b16 v[170:171], v252 offset:20608
    ds_read_b64_tr_b16 v[172:173], v252 offset:19488
    ds_read_b64_tr_b16 v[174:175], v252 offset:20640
    ds_read_b64_tr_b16 v[176:177], v252 offset:19520
    ds_read_b64_tr_b16 v[178:179], v252 offset:20672
    ds_read_b64_tr_b16 v[180:181], v252 offset:19552
    ds_read_b64_tr_b16 v[182:183], v252 offset:20704
    ds_read_b64_tr_b16 v[184:185], v252 offset:19584
    ds_read_b64_tr_b16 v[186:187], v252 offset:20736
    ds_read_b64_tr_b16 v[188:189], v252 offset:19616
    ds_read_b64_tr_b16 v[190:191], v252 offset:20768
    ds_read_b64_tr_b16 v[192:193], v252 offset:19648
    ds_read_b64_tr_b16 v[194:195], v252 offset:20800
    ds_read_b64_tr_b16 v[196:197], v252 offset:19680
    ds_read_b64_tr_b16 v[198:199], v252 offset:20832
    ds_read_b64_tr_b16 v[200:201], v252 offset:19712
    ds_read_b64_tr_b16 v[202:203], v252 offset:20864
    s_waitcnt vmcnt(9)
    s_waitcnt lgkmcnt(15)
    v_mfma_f32_16x16x32_bf16 v[8:11], v[168:171], v[112:115], v[8:11]
    v_mfma_f32_16x16x32_bf16 v[44:47], v[168:171], v[116:119], v[44:47]
    ds_read_b64_tr_b16 v[204:205], v252 offset:29184
    ds_read_b64_tr_b16 v[206:207], v252 offset:30336
    s_waitcnt lgkmcnt(15)
    v_mfma_f32_16x16x32_bf16 v[12:15], v[172:175], v[112:115], v[12:15]
    v_mfma_f32_16x16x32_bf16 v[48:51], v[172:175], v[116:119], v[48:51]
    ds_read_b64_tr_b16 v[208:209], v252 offset:29216
    ds_read_b64_tr_b16 v[210:211], v252 offset:30368
    s_waitcnt lgkmcnt(15)
    v_mfma_f32_16x16x32_bf16 v[16:19], v[176:179], v[112:115], v[16:19]
    v_mfma_f32_16x16x32_bf16 v[52:55], v[176:179], v[116:119], v[52:55]
    ds_read_b64_tr_b16 v[212:213], v252 offset:29248
    ds_read_b64_tr_b16 v[214:215], v252 offset:30400
    s_waitcnt lgkmcnt(15)
    v_mfma_f32_16x16x32_bf16 v[20:23], v[180:183], v[112:115], v[20:23]
    v_mfma_f32_16x16x32_bf16 v[56:59], v[180:183], v[116:119], v[56:59]
    ds_read_b64_tr_b16 v[216:217], v252 offset:29280
    ds_read_b64_tr_b16 v[218:219], v252 offset:30432
    s_waitcnt lgkmcnt(15)
    v_mfma_f32_16x16x32_bf16 v[24:27], v[184:187], v[112:115], v[24:27]
    v_mfma_f32_16x16x32_bf16 v[60:63], v[184:187], v[116:119], v[60:63]
    ds_read_b64_tr_b16 v[220:221], v252 offset:29312
    ds_read_b64_tr_b16 v[222:223], v252 offset:30464
    s_waitcnt lgkmcnt(15)
    v_mfma_f32_16x16x32_bf16 v[28:31], v[188:191], v[112:115], v[28:31]
    v_mfma_f32_16x16x32_bf16 v[64:67], v[188:191], v[116:119], v[64:67]
    ds_read_b64_tr_b16 v[224:225], v252 offset:29344
    ds_read_b64_tr_b16 v[226:227], v252 offset:30496
    s_waitcnt lgkmcnt(15)
    v_mfma_f32_16x16x32_bf16 v[32:35], v[192:195], v[112:115], v[32:35]
    v_mfma_f32_16x16x32_bf16 v[68:71], v[192:195], v[116:119], v[68:71]
    ds_read_b64_tr_b16 v[228:229], v252 offset:29376
    ds_read_b64_tr_b16 v[230:231], v252 offset:30528
    s_waitcnt lgkmcnt(15)
    v_mfma_f32_16x16x32_bf16 v[36:39], v[196:199], v[112:115], v[36:39]
    v_mfma_f32_16x16x32_bf16 v[72:75], v[196:199], v[116:119], v[72:75]
    ds_read_b64_tr_b16 v[232:233], v252 offset:29408
    ds_read_b64_tr_b16 v[234:235], v252 offset:30560
    s_waitcnt lgkmcnt(15)
    v_mfma_f32_16x16x32_bf16 v[40:43], v[200:203], v[112:115], v[40:43]
    v_mfma_f32_16x16x32_bf16 v[76:79], v[200:203], v[116:119], v[76:79]
    ds_read_b64_tr_b16 v[236:237], v252 offset:29440
    ds_read_b64_tr_b16 v[238:239], v252 offset:30592
    s_waitcnt lgkmcnt(15)
    v_mfma_f32_16x16x32_bf16 v[8:11], v[204:207], v[120:123], v[8:11]
    v_mfma_f32_16x16x32_bf16 v[44:47], v[204:207], v[124:127], v[44:47]
    s_waitcnt vmcnt(13)
    ds_write_b128 v247, v[128:131] offset:0
    s_waitcnt lgkmcnt(15)
    v_mfma_f32_16x16x32_bf16 v[12:15], v[208:211], v[120:123], v[12:15]
    v_mfma_f32_16x16x32_bf16 v[48:51], v[208:211], v[124:127], v[48:51]
    ds_write_b128 v248, v[132:135] offset:0
    ds_write_b128 v249, v[136:139] offset:0
    s_waitcnt lgkmcnt(15)
    v_mfma_f32_16x16x32_bf16 v[16:19], v[212:215], v[120:123], v[16:19]
    v_mfma_f32_16x16x32_bf16 v[52:55], v[212:215], v[124:127], v[52:55]
    ds_write_b128 v250, v[140:143] offset:0
    ds_write_b128 v251, v[144:147] offset:0
    s_waitcnt lgkmcnt(15)
    v_mfma_f32_16x16x32_bf16 v[20:23], v[216:219], v[120:123], v[20:23]
    v_mfma_f32_16x16x32_bf16 v[56:59], v[216:219], v[124:127], v[56:59]
    s_mov_b32 s30, 589824
    buffer_load_dwordx4 v[128:131], v242, s[12:15], s30 offen
    s_waitcnt lgkmcnt(13)
    v_mfma_f32_16x16x32_bf16 v[24:27], v[220:223], v[120:123], v[24:27]
    v_mfma_f32_16x16x32_bf16 v[60:63], v[220:223], v[124:127], v[60:63]
    buffer_load_dwordx4 v[132:135], v243, s[12:15], s30 offen
    buffer_load_dwordx4 v[136:139], v244, s[12:15], s30 offen
    s_waitcnt lgkmcnt(11)
    v_mfma_f32_16x16x32_bf16 v[28:31], v[224:227], v[120:123], v[28:31]
    v_mfma_f32_16x16x32_bf16 v[64:67], v[224:227], v[124:127], v[64:67]
    buffer_load_dwordx4 v[140:143], v245, s[12:15], s30 offen
    buffer_load_dwordx4 v[144:147], v246, s[12:15], s30 offen
    s_waitcnt lgkmcnt(9)
    v_mfma_f32_16x16x32_bf16 v[32:35], v[228:231], v[120:123], v[32:35]
    v_mfma_f32_16x16x32_bf16 v[68:71], v[228:231], v[124:127], v[68:71]
    buffer_load_dwordx4 v[96:99], v240, s[8:11], 0 offen offset:896
    buffer_load_dwordx4 v[100:103], v241, s[8:11], 0 offen offset:896
    s_waitcnt lgkmcnt(7)
    v_mfma_f32_16x16x32_bf16 v[36:39], v[232:235], v[120:123], v[36:39]
    v_mfma_f32_16x16x32_bf16 v[72:75], v[232:235], v[124:127], v[72:75]
    buffer_load_dwordx4 v[104:107], v240, s[8:11], 0 offen offset:960
    buffer_load_dwordx4 v[108:111], v241, s[8:11], 0 offen offset:960
    s_waitcnt lgkmcnt(5)
    v_mfma_f32_16x16x32_bf16 v[40:43], v[236:239], v[120:123], v[40:43]
    v_mfma_f32_16x16x32_bf16 v[76:79], v[236:239], v[124:127], v[76:79]
    s_waitcnt lgkmcnt(0)
    s_barrier
    ds_read_b64_tr_b16 v[168:169], v252 offset:0
    ds_read_b64_tr_b16 v[170:171], v252 offset:1152
    ds_read_b64_tr_b16 v[172:173], v252 offset:32
    ds_read_b64_tr_b16 v[174:175], v252 offset:1184
    ds_read_b64_tr_b16 v[176:177], v252 offset:64
    ds_read_b64_tr_b16 v[178:179], v252 offset:1216
    ds_read_b64_tr_b16 v[180:181], v252 offset:96
    ds_read_b64_tr_b16 v[182:183], v252 offset:1248
    ds_read_b64_tr_b16 v[184:185], v252 offset:128
    ds_read_b64_tr_b16 v[186:187], v252 offset:1280
    ds_read_b64_tr_b16 v[188:189], v252 offset:160
    ds_read_b64_tr_b16 v[190:191], v252 offset:1312
    ds_read_b64_tr_b16 v[192:193], v252 offset:192
    ds_read_b64_tr_b16 v[194:195], v252 offset:1344
    ds_read_b64_tr_b16 v[196:197], v252 offset:224
    ds_read_b64_tr_b16 v[198:199], v252 offset:1376
    ds_read_b64_tr_b16 v[200:201], v252 offset:256
    ds_read_b64_tr_b16 v[202:203], v252 offset:1408
    s_waitcnt vmcnt(9)
    s_waitcnt lgkmcnt(15)
    v_mfma_f32_16x16x32_bf16 v[8:11], v[168:171], v[80:83], v[8:11]
    v_mfma_f32_16x16x32_bf16 v[44:47], v[168:171], v[84:87], v[44:47]
    ds_read_b64_tr_b16 v[204:205], v252 offset:9728
    ds_read_b64_tr_b16 v[206:207], v252 offset:10880
    s_waitcnt lgkmcnt(15)
    v_mfma_f32_16x16x32_bf16 v[12:15], v[172:175], v[80:83], v[12:15]
    v_mfma_f32_16x16x32_bf16 v[48:51], v[172:175], v[84:87], v[48:51]
    ds_read_b64_tr_b16 v[208:209], v252 offset:9760
    ds_read_b64_tr_b16 v[210:211], v252 offset:10912
    s_waitcnt lgkmcnt(15)
    v_mfma_f32_16x16x32_bf16 v[16:19], v[176:179], v[80:83], v[16:19]
    v_mfma_f32_16x16x32_bf16 v[52:55], v[176:179], v[84:87], v[52:55]
    ds_read_b64_tr_b16 v[212:213], v252 offset:9792
    ds_read_b64_tr_b16 v[214:215], v252 offset:10944
    s_waitcnt lgkmcnt(15)
    v_mfma_f32_16x16x32_bf16 v[20:23], v[180:183], v[80:83], v[20:23]
    v_mfma_f32_16x16x32_bf16 v[56:59], v[180:183], v[84:87], v[56:59]
    ds_read_b64_tr_b16 v[216:217], v252 offset:9824
    ds_read_b64_tr_b16 v[218:219], v252 offset:10976
    s_waitcnt lgkmcnt(15)
    v_mfma_f32_16x16x32_bf16 v[24:27], v[184:187], v[80:83], v[24:27]
    v_mfma_f32_16x16x32_bf16 v[60:63], v[184:187], v[84:87], v[60:63]
    ds_read_b64_tr_b16 v[220:221], v252 offset:9856
    ds_read_b64_tr_b16 v[222:223], v252 offset:11008
    s_waitcnt lgkmcnt(15)
    v_mfma_f32_16x16x32_bf16 v[28:31], v[188:191], v[80:83], v[28:31]
    v_mfma_f32_16x16x32_bf16 v[64:67], v[188:191], v[84:87], v[64:67]
    ds_read_b64_tr_b16 v[224:225], v252 offset:9888
    ds_read_b64_tr_b16 v[226:227], v252 offset:11040
    s_waitcnt lgkmcnt(15)
    v_mfma_f32_16x16x32_bf16 v[32:35], v[192:195], v[80:83], v[32:35]
    v_mfma_f32_16x16x32_bf16 v[68:71], v[192:195], v[84:87], v[68:71]
    ds_read_b64_tr_b16 v[228:229], v252 offset:9920
    ds_read_b64_tr_b16 v[230:231], v252 offset:11072
    s_waitcnt lgkmcnt(15)
    v_mfma_f32_16x16x32_bf16 v[36:39], v[196:199], v[80:83], v[36:39]
    v_mfma_f32_16x16x32_bf16 v[72:75], v[196:199], v[84:87], v[72:75]
    ds_read_b64_tr_b16 v[232:233], v252 offset:9952
    ds_read_b64_tr_b16 v[234:235], v252 offset:11104
    s_waitcnt lgkmcnt(15)
    v_mfma_f32_16x16x32_bf16 v[40:43], v[200:203], v[80:83], v[40:43]
    v_mfma_f32_16x16x32_bf16 v[76:79], v[200:203], v[84:87], v[76:79]
    ds_read_b64_tr_b16 v[236:237], v252 offset:9984
    ds_read_b64_tr_b16 v[238:239], v252 offset:11136
    s_waitcnt lgkmcnt(15)
    v_mfma_f32_16x16x32_bf16 v[8:11], v[204:207], v[88:91], v[8:11]
    v_mfma_f32_16x16x32_bf16 v[44:47], v[204:207], v[92:95], v[44:47]
    s_waitcnt vmcnt(13)
    ds_write_b128 v247, v[148:151] offset:19456
    s_waitcnt lgkmcnt(15)
    v_mfma_f32_16x16x32_bf16 v[12:15], v[208:211], v[88:91], v[12:15]
    v_mfma_f32_16x16x32_bf16 v[48:51], v[208:211], v[92:95], v[48:51]
    ds_write_b128 v248, v[152:155] offset:19456
    ds_write_b128 v249, v[156:159] offset:19456
    s_waitcnt lgkmcnt(15)
    v_mfma_f32_16x16x32_bf16 v[16:19], v[212:215], v[88:91], v[16:19]
    v_mfma_f32_16x16x32_bf16 v[52:55], v[212:215], v[92:95], v[52:55]
    ds_write_b128 v250, v[160:163] offset:19456
    ds_write_b128 v251, v[164:167] offset:19456
    s_waitcnt lgkmcnt(15)
    v_mfma_f32_16x16x32_bf16 v[20:23], v[216:219], v[88:91], v[20:23]
    v_mfma_f32_16x16x32_bf16 v[56:59], v[216:219], v[92:95], v[56:59]
    s_mov_b32 s30, 663552
    buffer_load_dwordx4 v[148:151], v242, s[12:15], s30 offen
    s_waitcnt lgkmcnt(13)
    v_mfma_f32_16x16x32_bf16 v[24:27], v[220:223], v[88:91], v[24:27]
    v_mfma_f32_16x16x32_bf16 v[60:63], v[220:223], v[92:95], v[60:63]
    buffer_load_dwordx4 v[152:155], v243, s[12:15], s30 offen
    buffer_load_dwordx4 v[156:159], v244, s[12:15], s30 offen
    s_waitcnt lgkmcnt(11)
    v_mfma_f32_16x16x32_bf16 v[28:31], v[224:227], v[88:91], v[28:31]
    v_mfma_f32_16x16x32_bf16 v[64:67], v[224:227], v[92:95], v[64:67]
    buffer_load_dwordx4 v[160:163], v245, s[12:15], s30 offen
    buffer_load_dwordx4 v[164:167], v246, s[12:15], s30 offen
    s_waitcnt lgkmcnt(9)
    v_mfma_f32_16x16x32_bf16 v[32:35], v[228:231], v[88:91], v[32:35]
    v_mfma_f32_16x16x32_bf16 v[68:71], v[228:231], v[92:95], v[68:71]
    buffer_load_dwordx4 v[112:115], v240, s[8:11], 0 offen offset:1024
    buffer_load_dwordx4 v[116:119], v241, s[8:11], 0 offen offset:1024
    s_waitcnt lgkmcnt(7)
    v_mfma_f32_16x16x32_bf16 v[36:39], v[232:235], v[88:91], v[36:39]
    v_mfma_f32_16x16x32_bf16 v[72:75], v[232:235], v[92:95], v[72:75]
    buffer_load_dwordx4 v[120:123], v240, s[8:11], 0 offen offset:1088
    buffer_load_dwordx4 v[124:127], v241, s[8:11], 0 offen offset:1088
    s_waitcnt lgkmcnt(5)
    v_mfma_f32_16x16x32_bf16 v[40:43], v[236:239], v[88:91], v[40:43]
    v_mfma_f32_16x16x32_bf16 v[76:79], v[236:239], v[92:95], v[76:79]
    s_waitcnt lgkmcnt(0)
    s_barrier
    ds_read_b64_tr_b16 v[168:169], v252 offset:19456
    ds_read_b64_tr_b16 v[170:171], v252 offset:20608
    ds_read_b64_tr_b16 v[172:173], v252 offset:19488
    ds_read_b64_tr_b16 v[174:175], v252 offset:20640
    ds_read_b64_tr_b16 v[176:177], v252 offset:19520
    ds_read_b64_tr_b16 v[178:179], v252 offset:20672
    ds_read_b64_tr_b16 v[180:181], v252 offset:19552
    ds_read_b64_tr_b16 v[182:183], v252 offset:20704
    ds_read_b64_tr_b16 v[184:185], v252 offset:19584
    ds_read_b64_tr_b16 v[186:187], v252 offset:20736
    ds_read_b64_tr_b16 v[188:189], v252 offset:19616
    ds_read_b64_tr_b16 v[190:191], v252 offset:20768
    ds_read_b64_tr_b16 v[192:193], v252 offset:19648
    ds_read_b64_tr_b16 v[194:195], v252 offset:20800
    ds_read_b64_tr_b16 v[196:197], v252 offset:19680
    ds_read_b64_tr_b16 v[198:199], v252 offset:20832
    ds_read_b64_tr_b16 v[200:201], v252 offset:19712
    ds_read_b64_tr_b16 v[202:203], v252 offset:20864
    s_waitcnt vmcnt(9)
    s_waitcnt lgkmcnt(15)
    v_mfma_f32_16x16x32_bf16 v[8:11], v[168:171], v[96:99], v[8:11]
    v_mfma_f32_16x16x32_bf16 v[44:47], v[168:171], v[100:103], v[44:47]
    ds_read_b64_tr_b16 v[204:205], v252 offset:29184
    ds_read_b64_tr_b16 v[206:207], v252 offset:30336
    s_waitcnt lgkmcnt(15)
    v_mfma_f32_16x16x32_bf16 v[12:15], v[172:175], v[96:99], v[12:15]
    v_mfma_f32_16x16x32_bf16 v[48:51], v[172:175], v[100:103], v[48:51]
    ds_read_b64_tr_b16 v[208:209], v252 offset:29216
    ds_read_b64_tr_b16 v[210:211], v252 offset:30368
    s_waitcnt lgkmcnt(15)
    v_mfma_f32_16x16x32_bf16 v[16:19], v[176:179], v[96:99], v[16:19]
    v_mfma_f32_16x16x32_bf16 v[52:55], v[176:179], v[100:103], v[52:55]
    ds_read_b64_tr_b16 v[212:213], v252 offset:29248
    ds_read_b64_tr_b16 v[214:215], v252 offset:30400
    s_waitcnt lgkmcnt(15)
    v_mfma_f32_16x16x32_bf16 v[20:23], v[180:183], v[96:99], v[20:23]
    v_mfma_f32_16x16x32_bf16 v[56:59], v[180:183], v[100:103], v[56:59]
    ds_read_b64_tr_b16 v[216:217], v252 offset:29280
    ds_read_b64_tr_b16 v[218:219], v252 offset:30432
    s_waitcnt lgkmcnt(15)
    v_mfma_f32_16x16x32_bf16 v[24:27], v[184:187], v[96:99], v[24:27]
    v_mfma_f32_16x16x32_bf16 v[60:63], v[184:187], v[100:103], v[60:63]
    ds_read_b64_tr_b16 v[220:221], v252 offset:29312
    ds_read_b64_tr_b16 v[222:223], v252 offset:30464
    s_waitcnt lgkmcnt(15)
    v_mfma_f32_16x16x32_bf16 v[28:31], v[188:191], v[96:99], v[28:31]
    v_mfma_f32_16x16x32_bf16 v[64:67], v[188:191], v[100:103], v[64:67]
    ds_read_b64_tr_b16 v[224:225], v252 offset:29344
    ds_read_b64_tr_b16 v[226:227], v252 offset:30496
    s_waitcnt lgkmcnt(15)
    v_mfma_f32_16x16x32_bf16 v[32:35], v[192:195], v[96:99], v[32:35]
    v_mfma_f32_16x16x32_bf16 v[68:71], v[192:195], v[100:103], v[68:71]
    ds_read_b64_tr_b16 v[228:229], v252 offset:29376
    ds_read_b64_tr_b16 v[230:231], v252 offset:30528
    s_waitcnt lgkmcnt(15)
    v_mfma_f32_16x16x32_bf16 v[36:39], v[196:199], v[96:99], v[36:39]
    v_mfma_f32_16x16x32_bf16 v[72:75], v[196:199], v[100:103], v[72:75]
    ds_read_b64_tr_b16 v[232:233], v252 offset:29408
    ds_read_b64_tr_b16 v[234:235], v252 offset:30560
    s_waitcnt lgkmcnt(15)
    v_mfma_f32_16x16x32_bf16 v[40:43], v[200:203], v[96:99], v[40:43]
    v_mfma_f32_16x16x32_bf16 v[76:79], v[200:203], v[100:103], v[76:79]
    ds_read_b64_tr_b16 v[236:237], v252 offset:29440
    ds_read_b64_tr_b16 v[238:239], v252 offset:30592
    s_waitcnt lgkmcnt(15)
    v_mfma_f32_16x16x32_bf16 v[8:11], v[204:207], v[104:107], v[8:11]
    v_mfma_f32_16x16x32_bf16 v[44:47], v[204:207], v[108:111], v[44:47]
    s_waitcnt vmcnt(13)
    ds_write_b128 v247, v[128:131] offset:0
    s_waitcnt lgkmcnt(15)
    v_mfma_f32_16x16x32_bf16 v[12:15], v[208:211], v[104:107], v[12:15]
    v_mfma_f32_16x16x32_bf16 v[48:51], v[208:211], v[108:111], v[48:51]
    ds_write_b128 v248, v[132:135] offset:0
    ds_write_b128 v249, v[136:139] offset:0
    s_waitcnt lgkmcnt(15)
    v_mfma_f32_16x16x32_bf16 v[16:19], v[212:215], v[104:107], v[16:19]
    v_mfma_f32_16x16x32_bf16 v[52:55], v[212:215], v[108:111], v[52:55]
    ds_write_b128 v250, v[140:143] offset:0
    ds_write_b128 v251, v[144:147] offset:0
    s_waitcnt lgkmcnt(15)
    v_mfma_f32_16x16x32_bf16 v[20:23], v[216:219], v[104:107], v[20:23]
    v_mfma_f32_16x16x32_bf16 v[56:59], v[216:219], v[108:111], v[56:59]
    s_mov_b32 s30, 737280
    buffer_load_dwordx4 v[128:131], v242, s[12:15], s30 offen
    s_waitcnt lgkmcnt(13)
    v_mfma_f32_16x16x32_bf16 v[24:27], v[220:223], v[104:107], v[24:27]
    v_mfma_f32_16x16x32_bf16 v[60:63], v[220:223], v[108:111], v[60:63]
    buffer_load_dwordx4 v[132:135], v243, s[12:15], s30 offen
    buffer_load_dwordx4 v[136:139], v244, s[12:15], s30 offen
    s_waitcnt lgkmcnt(11)
    v_mfma_f32_16x16x32_bf16 v[28:31], v[224:227], v[104:107], v[28:31]
    v_mfma_f32_16x16x32_bf16 v[64:67], v[224:227], v[108:111], v[64:67]
    buffer_load_dwordx4 v[140:143], v245, s[12:15], s30 offen
    buffer_load_dwordx4 v[144:147], v246, s[12:15], s30 offen
    s_waitcnt lgkmcnt(9)
    v_mfma_f32_16x16x32_bf16 v[32:35], v[228:231], v[104:107], v[32:35]
    v_mfma_f32_16x16x32_bf16 v[68:71], v[228:231], v[108:111], v[68:71]
    buffer_load_dwordx4 v[80:83], v240, s[8:11], 0 offen offset:1152
    buffer_load_dwordx4 v[84:87], v241, s[8:11], 0 offen offset:1152
    s_waitcnt lgkmcnt(7)
    v_mfma_f32_16x16x32_bf16 v[36:39], v[232:235], v[104:107], v[36:39]
    v_mfma_f32_16x16x32_bf16 v[72:75], v[232:235], v[108:111], v[72:75]
    buffer_load_dwordx4 v[88:91], v240, s[8:11], 0 offen offset:1216
    buffer_load_dwordx4 v[92:95], v241, s[8:11], 0 offen offset:1216
    s_waitcnt lgkmcnt(5)
    v_mfma_f32_16x16x32_bf16 v[40:43], v[236:239], v[104:107], v[40:43]
    v_mfma_f32_16x16x32_bf16 v[76:79], v[236:239], v[108:111], v[76:79]
    s_waitcnt lgkmcnt(0)
    s_barrier
    ds_read_b64_tr_b16 v[168:169], v252 offset:0
    ds_read_b64_tr_b16 v[170:171], v252 offset:1152
    ds_read_b64_tr_b16 v[172:173], v252 offset:32
    ds_read_b64_tr_b16 v[174:175], v252 offset:1184
    ds_read_b64_tr_b16 v[176:177], v252 offset:64
    ds_read_b64_tr_b16 v[178:179], v252 offset:1216
    ds_read_b64_tr_b16 v[180:181], v252 offset:96
    ds_read_b64_tr_b16 v[182:183], v252 offset:1248
    ds_read_b64_tr_b16 v[184:185], v252 offset:128
    ds_read_b64_tr_b16 v[186:187], v252 offset:1280
    ds_read_b64_tr_b16 v[188:189], v252 offset:160
    ds_read_b64_tr_b16 v[190:191], v252 offset:1312
    ds_read_b64_tr_b16 v[192:193], v252 offset:192
    ds_read_b64_tr_b16 v[194:195], v252 offset:1344
    ds_read_b64_tr_b16 v[196:197], v252 offset:224
    ds_read_b64_tr_b16 v[198:199], v252 offset:1376
    ds_read_b64_tr_b16 v[200:201], v252 offset:256
    ds_read_b64_tr_b16 v[202:203], v252 offset:1408
    s_waitcnt vmcnt(9)
    s_waitcnt lgkmcnt(15)
    v_mfma_f32_16x16x32_bf16 v[8:11], v[168:171], v[112:115], v[8:11]
    v_mfma_f32_16x16x32_bf16 v[44:47], v[168:171], v[116:119], v[44:47]
    ds_read_b64_tr_b16 v[204:205], v252 offset:9728
    ds_read_b64_tr_b16 v[206:207], v252 offset:10880
    s_waitcnt lgkmcnt(15)
    v_mfma_f32_16x16x32_bf16 v[12:15], v[172:175], v[112:115], v[12:15]
    v_mfma_f32_16x16x32_bf16 v[48:51], v[172:175], v[116:119], v[48:51]
    ds_read_b64_tr_b16 v[208:209], v252 offset:9760
    ds_read_b64_tr_b16 v[210:211], v252 offset:10912
    s_waitcnt lgkmcnt(15)
    v_mfma_f32_16x16x32_bf16 v[16:19], v[176:179], v[112:115], v[16:19]
    v_mfma_f32_16x16x32_bf16 v[52:55], v[176:179], v[116:119], v[52:55]
    ds_read_b64_tr_b16 v[212:213], v252 offset:9792
    ds_read_b64_tr_b16 v[214:215], v252 offset:10944
    s_waitcnt lgkmcnt(15)
    v_mfma_f32_16x16x32_bf16 v[20:23], v[180:183], v[112:115], v[20:23]
    v_mfma_f32_16x16x32_bf16 v[56:59], v[180:183], v[116:119], v[56:59]
    ds_read_b64_tr_b16 v[216:217], v252 offset:9824
    ds_read_b64_tr_b16 v[218:219], v252 offset:10976
    s_waitcnt lgkmcnt(15)
    v_mfma_f32_16x16x32_bf16 v[24:27], v[184:187], v[112:115], v[24:27]
    v_mfma_f32_16x16x32_bf16 v[60:63], v[184:187], v[116:119], v[60:63]
    ds_read_b64_tr_b16 v[220:221], v252 offset:9856
    ds_read_b64_tr_b16 v[222:223], v252 offset:11008
    s_waitcnt lgkmcnt(15)
    v_mfma_f32_16x16x32_bf16 v[28:31], v[188:191], v[112:115], v[28:31]
    v_mfma_f32_16x16x32_bf16 v[64:67], v[188:191], v[116:119], v[64:67]
    ds_read_b64_tr_b16 v[224:225], v252 offset:9888
    ds_read_b64_tr_b16 v[226:227], v252 offset:11040
    s_waitcnt lgkmcnt(15)
    v_mfma_f32_16x16x32_bf16 v[32:35], v[192:195], v[112:115], v[32:35]
    v_mfma_f32_16x16x32_bf16 v[68:71], v[192:195], v[116:119], v[68:71]
    ds_read_b64_tr_b16 v[228:229], v252 offset:9920
    ds_read_b64_tr_b16 v[230:231], v252 offset:11072
    s_waitcnt lgkmcnt(15)
    v_mfma_f32_16x16x32_bf16 v[36:39], v[196:199], v[112:115], v[36:39]
    v_mfma_f32_16x16x32_bf16 v[72:75], v[196:199], v[116:119], v[72:75]
    ds_read_b64_tr_b16 v[232:233], v252 offset:9952
    ds_read_b64_tr_b16 v[234:235], v252 offset:11104
    s_waitcnt lgkmcnt(15)
    v_mfma_f32_16x16x32_bf16 v[40:43], v[200:203], v[112:115], v[40:43]
    v_mfma_f32_16x16x32_bf16 v[76:79], v[200:203], v[116:119], v[76:79]
    ds_read_b64_tr_b16 v[236:237], v252 offset:9984
    ds_read_b64_tr_b16 v[238:239], v252 offset:11136
    s_waitcnt lgkmcnt(15)
    v_mfma_f32_16x16x32_bf16 v[8:11], v[204:207], v[120:123], v[8:11]
    v_mfma_f32_16x16x32_bf16 v[44:47], v[204:207], v[124:127], v[44:47]
    s_waitcnt vmcnt(13)
    ds_write_b128 v247, v[148:151] offset:19456
    s_waitcnt lgkmcnt(15)
    v_mfma_f32_16x16x32_bf16 v[12:15], v[208:211], v[120:123], v[12:15]
    v_mfma_f32_16x16x32_bf16 v[48:51], v[208:211], v[124:127], v[48:51]
    ds_write_b128 v248, v[152:155] offset:19456
    ds_write_b128 v249, v[156:159] offset:19456
    s_waitcnt lgkmcnt(15)
    v_mfma_f32_16x16x32_bf16 v[16:19], v[212:215], v[120:123], v[16:19]
    v_mfma_f32_16x16x32_bf16 v[52:55], v[212:215], v[124:127], v[52:55]
    ds_write_b128 v250, v[160:163] offset:19456
    ds_write_b128 v251, v[164:167] offset:19456
    s_waitcnt lgkmcnt(15)
    v_mfma_f32_16x16x32_bf16 v[20:23], v[216:219], v[120:123], v[20:23]
    v_mfma_f32_16x16x32_bf16 v[56:59], v[216:219], v[124:127], v[56:59]
    s_mov_b32 s30, 811008
    buffer_load_dwordx4 v[148:151], v242, s[12:15], s30 offen
    s_waitcnt lgkmcnt(13)
    v_mfma_f32_16x16x32_bf16 v[24:27], v[220:223], v[120:123], v[24:27]
    v_mfma_f32_16x16x32_bf16 v[60:63], v[220:223], v[124:127], v[60:63]
    buffer_load_dwordx4 v[152:155], v243, s[12:15], s30 offen
    buffer_load_dwordx4 v[156:159], v244, s[12:15], s30 offen
    s_waitcnt lgkmcnt(11)
    v_mfma_f32_16x16x32_bf16 v[28:31], v[224:227], v[120:123], v[28:31]
    v_mfma_f32_16x16x32_bf16 v[64:67], v[224:227], v[124:127], v[64:67]
    buffer_load_dwordx4 v[160:163], v245, s[12:15], s30 offen
    buffer_load_dwordx4 v[164:167], v246, s[12:15], s30 offen
    s_waitcnt lgkmcnt(9)
    v_mfma_f32_16x16x32_bf16 v[32:35], v[228:231], v[120:123], v[32:35]
    v_mfma_f32_16x16x32_bf16 v[68:71], v[228:231], v[124:127], v[68:71]
    buffer_load_dwordx4 v[96:99], v240, s[8:11], 0 offen offset:1280
    buffer_load_dwordx4 v[100:103], v241, s[8:11], 0 offen offset:1280
    s_waitcnt lgkmcnt(7)
    v_mfma_f32_16x16x32_bf16 v[36:39], v[232:235], v[120:123], v[36:39]
    v_mfma_f32_16x16x32_bf16 v[72:75], v[232:235], v[124:127], v[72:75]
    buffer_load_dwordx4 v[104:107], v240, s[8:11], 0 offen offset:1344
    buffer_load_dwordx4 v[108:111], v241, s[8:11], 0 offen offset:1344
    s_waitcnt lgkmcnt(5)
    v_mfma_f32_16x16x32_bf16 v[40:43], v[236:239], v[120:123], v[40:43]
    v_mfma_f32_16x16x32_bf16 v[76:79], v[236:239], v[124:127], v[76:79]
    s_waitcnt lgkmcnt(0)
    s_barrier
    ds_read_b64_tr_b16 v[168:169], v252 offset:19456
    ds_read_b64_tr_b16 v[170:171], v252 offset:20608
    ds_read_b64_tr_b16 v[172:173], v252 offset:19488
    ds_read_b64_tr_b16 v[174:175], v252 offset:20640
    ds_read_b64_tr_b16 v[176:177], v252 offset:19520
    ds_read_b64_tr_b16 v[178:179], v252 offset:20672
    ds_read_b64_tr_b16 v[180:181], v252 offset:19552
    ds_read_b64_tr_b16 v[182:183], v252 offset:20704
    ds_read_b64_tr_b16 v[184:185], v252 offset:19584
    ds_read_b64_tr_b16 v[186:187], v252 offset:20736
    ds_read_b64_tr_b16 v[188:189], v252 offset:19616
    ds_read_b64_tr_b16 v[190:191], v252 offset:20768
    ds_read_b64_tr_b16 v[192:193], v252 offset:19648
    ds_read_b64_tr_b16 v[194:195], v252 offset:20800
    ds_read_b64_tr_b16 v[196:197], v252 offset:19680
    ds_read_b64_tr_b16 v[198:199], v252 offset:20832
    ds_read_b64_tr_b16 v[200:201], v252 offset:19712
    ds_read_b64_tr_b16 v[202:203], v252 offset:20864
    s_waitcnt vmcnt(9)
    s_waitcnt lgkmcnt(15)
    v_mfma_f32_16x16x32_bf16 v[8:11], v[168:171], v[80:83], v[8:11]
    v_mfma_f32_16x16x32_bf16 v[44:47], v[168:171], v[84:87], v[44:47]
    ds_read_b64_tr_b16 v[204:205], v252 offset:29184
    ds_read_b64_tr_b16 v[206:207], v252 offset:30336
    s_waitcnt lgkmcnt(15)
    v_mfma_f32_16x16x32_bf16 v[12:15], v[172:175], v[80:83], v[12:15]
    v_mfma_f32_16x16x32_bf16 v[48:51], v[172:175], v[84:87], v[48:51]
    ds_read_b64_tr_b16 v[208:209], v252 offset:29216
    ds_read_b64_tr_b16 v[210:211], v252 offset:30368
    s_waitcnt lgkmcnt(15)
    v_mfma_f32_16x16x32_bf16 v[16:19], v[176:179], v[80:83], v[16:19]
    v_mfma_f32_16x16x32_bf16 v[52:55], v[176:179], v[84:87], v[52:55]
    ds_read_b64_tr_b16 v[212:213], v252 offset:29248
    ds_read_b64_tr_b16 v[214:215], v252 offset:30400
    s_waitcnt lgkmcnt(15)
    v_mfma_f32_16x16x32_bf16 v[20:23], v[180:183], v[80:83], v[20:23]
    v_mfma_f32_16x16x32_bf16 v[56:59], v[180:183], v[84:87], v[56:59]
    ds_read_b64_tr_b16 v[216:217], v252 offset:29280
    ds_read_b64_tr_b16 v[218:219], v252 offset:30432
    s_waitcnt lgkmcnt(15)
    v_mfma_f32_16x16x32_bf16 v[24:27], v[184:187], v[80:83], v[24:27]
    v_mfma_f32_16x16x32_bf16 v[60:63], v[184:187], v[84:87], v[60:63]
    ds_read_b64_tr_b16 v[220:221], v252 offset:29312
    ds_read_b64_tr_b16 v[222:223], v252 offset:30464
    s_waitcnt lgkmcnt(15)
    v_mfma_f32_16x16x32_bf16 v[28:31], v[188:191], v[80:83], v[28:31]
    v_mfma_f32_16x16x32_bf16 v[64:67], v[188:191], v[84:87], v[64:67]
    ds_read_b64_tr_b16 v[224:225], v252 offset:29344
    ds_read_b64_tr_b16 v[226:227], v252 offset:30496
    s_waitcnt lgkmcnt(15)
    v_mfma_f32_16x16x32_bf16 v[32:35], v[192:195], v[80:83], v[32:35]
    v_mfma_f32_16x16x32_bf16 v[68:71], v[192:195], v[84:87], v[68:71]
    ds_read_b64_tr_b16 v[228:229], v252 offset:29376
    ds_read_b64_tr_b16 v[230:231], v252 offset:30528
    s_waitcnt lgkmcnt(15)
    v_mfma_f32_16x16x32_bf16 v[36:39], v[196:199], v[80:83], v[36:39]
    v_mfma_f32_16x16x32_bf16 v[72:75], v[196:199], v[84:87], v[72:75]
    ds_read_b64_tr_b16 v[232:233], v252 offset:29408
    ds_read_b64_tr_b16 v[234:235], v252 offset:30560
    s_waitcnt lgkmcnt(15)
    v_mfma_f32_16x16x32_bf16 v[40:43], v[200:203], v[80:83], v[40:43]
    v_mfma_f32_16x16x32_bf16 v[76:79], v[200:203], v[84:87], v[76:79]
    ds_read_b64_tr_b16 v[236:237], v252 offset:29440
    ds_read_b64_tr_b16 v[238:239], v252 offset:30592
    s_waitcnt lgkmcnt(15)
    v_mfma_f32_16x16x32_bf16 v[8:11], v[204:207], v[88:91], v[8:11]
    v_mfma_f32_16x16x32_bf16 v[44:47], v[204:207], v[92:95], v[44:47]
    s_waitcnt vmcnt(13)
    ds_write_b128 v247, v[128:131] offset:0
    s_waitcnt lgkmcnt(15)
    v_mfma_f32_16x16x32_bf16 v[12:15], v[208:211], v[88:91], v[12:15]
    v_mfma_f32_16x16x32_bf16 v[48:51], v[208:211], v[92:95], v[48:51]
    ds_write_b128 v248, v[132:135] offset:0
    ds_write_b128 v249, v[136:139] offset:0
    s_waitcnt lgkmcnt(15)
    v_mfma_f32_16x16x32_bf16 v[16:19], v[212:215], v[88:91], v[16:19]
    v_mfma_f32_16x16x32_bf16 v[52:55], v[212:215], v[92:95], v[52:55]
    ds_write_b128 v250, v[140:143] offset:0
    ds_write_b128 v251, v[144:147] offset:0
    s_waitcnt lgkmcnt(15)
    v_mfma_f32_16x16x32_bf16 v[20:23], v[216:219], v[88:91], v[20:23]
    v_mfma_f32_16x16x32_bf16 v[56:59], v[216:219], v[92:95], v[56:59]
    s_mov_b32 s30, 884736
    buffer_load_dwordx4 v[128:131], v242, s[12:15], s30 offen
    s_waitcnt lgkmcnt(13)
    v_mfma_f32_16x16x32_bf16 v[24:27], v[220:223], v[88:91], v[24:27]
    v_mfma_f32_16x16x32_bf16 v[60:63], v[220:223], v[92:95], v[60:63]
    buffer_load_dwordx4 v[132:135], v243, s[12:15], s30 offen
    buffer_load_dwordx4 v[136:139], v244, s[12:15], s30 offen
    s_waitcnt lgkmcnt(11)
    v_mfma_f32_16x16x32_bf16 v[28:31], v[224:227], v[88:91], v[28:31]
    v_mfma_f32_16x16x32_bf16 v[64:67], v[224:227], v[92:95], v[64:67]
    buffer_load_dwordx4 v[140:143], v245, s[12:15], s30 offen
    buffer_load_dwordx4 v[144:147], v246, s[12:15], s30 offen
    s_waitcnt lgkmcnt(9)
    v_mfma_f32_16x16x32_bf16 v[32:35], v[228:231], v[88:91], v[32:35]
    v_mfma_f32_16x16x32_bf16 v[68:71], v[228:231], v[92:95], v[68:71]
    buffer_load_dwordx4 v[112:115], v240, s[8:11], 0 offen offset:1408
    buffer_load_dwordx4 v[116:119], v241, s[8:11], 0 offen offset:1408
    s_waitcnt lgkmcnt(7)
    v_mfma_f32_16x16x32_bf16 v[36:39], v[232:235], v[88:91], v[36:39]
    v_mfma_f32_16x16x32_bf16 v[72:75], v[232:235], v[92:95], v[72:75]
    buffer_load_dwordx4 v[120:123], v240, s[8:11], 0 offen offset:1472
    buffer_load_dwordx4 v[124:127], v241, s[8:11], 0 offen offset:1472
    s_waitcnt lgkmcnt(5)
    v_mfma_f32_16x16x32_bf16 v[40:43], v[236:239], v[88:91], v[40:43]
    v_mfma_f32_16x16x32_bf16 v[76:79], v[236:239], v[92:95], v[76:79]
    s_waitcnt lgkmcnt(0)
    s_barrier
    ds_read_b64_tr_b16 v[168:169], v252 offset:0
    ds_read_b64_tr_b16 v[170:171], v252 offset:1152
    ds_read_b64_tr_b16 v[172:173], v252 offset:32
    ds_read_b64_tr_b16 v[174:175], v252 offset:1184
    ds_read_b64_tr_b16 v[176:177], v252 offset:64
    ds_read_b64_tr_b16 v[178:179], v252 offset:1216
    ds_read_b64_tr_b16 v[180:181], v252 offset:96
    ds_read_b64_tr_b16 v[182:183], v252 offset:1248
    ds_read_b64_tr_b16 v[184:185], v252 offset:128
    ds_read_b64_tr_b16 v[186:187], v252 offset:1280
    ds_read_b64_tr_b16 v[188:189], v252 offset:160
    ds_read_b64_tr_b16 v[190:191], v252 offset:1312
    ds_read_b64_tr_b16 v[192:193], v252 offset:192
    ds_read_b64_tr_b16 v[194:195], v252 offset:1344
    ds_read_b64_tr_b16 v[196:197], v252 offset:224
    ds_read_b64_tr_b16 v[198:199], v252 offset:1376
    ds_read_b64_tr_b16 v[200:201], v252 offset:256
    ds_read_b64_tr_b16 v[202:203], v252 offset:1408
    s_waitcnt vmcnt(9)
    s_waitcnt lgkmcnt(15)
    v_mfma_f32_16x16x32_bf16 v[8:11], v[168:171], v[96:99], v[8:11]
    v_mfma_f32_16x16x32_bf16 v[44:47], v[168:171], v[100:103], v[44:47]
    ds_read_b64_tr_b16 v[204:205], v252 offset:9728
    ds_read_b64_tr_b16 v[206:207], v252 offset:10880
    s_waitcnt lgkmcnt(15)
    v_mfma_f32_16x16x32_bf16 v[12:15], v[172:175], v[96:99], v[12:15]
    v_mfma_f32_16x16x32_bf16 v[48:51], v[172:175], v[100:103], v[48:51]
    ds_read_b64_tr_b16 v[208:209], v252 offset:9760
    ds_read_b64_tr_b16 v[210:211], v252 offset:10912
    s_waitcnt lgkmcnt(15)
    v_mfma_f32_16x16x32_bf16 v[16:19], v[176:179], v[96:99], v[16:19]
    v_mfma_f32_16x16x32_bf16 v[52:55], v[176:179], v[100:103], v[52:55]
    ds_read_b64_tr_b16 v[212:213], v252 offset:9792
    ds_read_b64_tr_b16 v[214:215], v252 offset:10944
    s_waitcnt lgkmcnt(15)
    v_mfma_f32_16x16x32_bf16 v[20:23], v[180:183], v[96:99], v[20:23]
    v_mfma_f32_16x16x32_bf16 v[56:59], v[180:183], v[100:103], v[56:59]
    ds_read_b64_tr_b16 v[216:217], v252 offset:9824
    ds_read_b64_tr_b16 v[218:219], v252 offset:10976
    s_waitcnt lgkmcnt(15)
    v_mfma_f32_16x16x32_bf16 v[24:27], v[184:187], v[96:99], v[24:27]
    v_mfma_f32_16x16x32_bf16 v[60:63], v[184:187], v[100:103], v[60:63]
    ds_read_b64_tr_b16 v[220:221], v252 offset:9856
    ds_read_b64_tr_b16 v[222:223], v252 offset:11008
    s_waitcnt lgkmcnt(15)
    v_mfma_f32_16x16x32_bf16 v[28:31], v[188:191], v[96:99], v[28:31]
    v_mfma_f32_16x16x32_bf16 v[64:67], v[188:191], v[100:103], v[64:67]
    ds_read_b64_tr_b16 v[224:225], v252 offset:9888
    ds_read_b64_tr_b16 v[226:227], v252 offset:11040
    s_waitcnt lgkmcnt(15)
    v_mfma_f32_16x16x32_bf16 v[32:35], v[192:195], v[96:99], v[32:35]
    v_mfma_f32_16x16x32_bf16 v[68:71], v[192:195], v[100:103], v[68:71]
    ds_read_b64_tr_b16 v[228:229], v252 offset:9920
    ds_read_b64_tr_b16 v[230:231], v252 offset:11072
    s_waitcnt lgkmcnt(15)
    v_mfma_f32_16x16x32_bf16 v[36:39], v[196:199], v[96:99], v[36:39]
    v_mfma_f32_16x16x32_bf16 v[72:75], v[196:199], v[100:103], v[72:75]
    ds_read_b64_tr_b16 v[232:233], v252 offset:9952
    ds_read_b64_tr_b16 v[234:235], v252 offset:11104
    s_waitcnt lgkmcnt(15)
    v_mfma_f32_16x16x32_bf16 v[40:43], v[200:203], v[96:99], v[40:43]
    v_mfma_f32_16x16x32_bf16 v[76:79], v[200:203], v[100:103], v[76:79]
    ds_read_b64_tr_b16 v[236:237], v252 offset:9984
    ds_read_b64_tr_b16 v[238:239], v252 offset:11136
    s_waitcnt lgkmcnt(15)
    v_mfma_f32_16x16x32_bf16 v[8:11], v[204:207], v[104:107], v[8:11]
    v_mfma_f32_16x16x32_bf16 v[44:47], v[204:207], v[108:111], v[44:47]
    s_waitcnt vmcnt(13)
    ds_write_b128 v247, v[148:151] offset:19456
    s_waitcnt lgkmcnt(15)
    v_mfma_f32_16x16x32_bf16 v[12:15], v[208:211], v[104:107], v[12:15]
    v_mfma_f32_16x16x32_bf16 v[48:51], v[208:211], v[108:111], v[48:51]
    ds_write_b128 v248, v[152:155] offset:19456
    ds_write_b128 v249, v[156:159] offset:19456
    s_waitcnt lgkmcnt(15)
    v_mfma_f32_16x16x32_bf16 v[16:19], v[212:215], v[104:107], v[16:19]
    v_mfma_f32_16x16x32_bf16 v[52:55], v[212:215], v[108:111], v[52:55]
    ds_write_b128 v250, v[160:163] offset:19456
    ds_write_b128 v251, v[164:167] offset:19456
    s_waitcnt lgkmcnt(15)
    v_mfma_f32_16x16x32_bf16 v[20:23], v[216:219], v[104:107], v[20:23]
    v_mfma_f32_16x16x32_bf16 v[56:59], v[216:219], v[108:111], v[56:59]
    s_mov_b32 s30, 958464
    buffer_load_dwordx4 v[148:151], v242, s[12:15], s30 offen
    s_waitcnt lgkmcnt(13)
    v_mfma_f32_16x16x32_bf16 v[24:27], v[220:223], v[104:107], v[24:27]
    v_mfma_f32_16x16x32_bf16 v[60:63], v[220:223], v[108:111], v[60:63]
    buffer_load_dwordx4 v[152:155], v243, s[12:15], s30 offen
    buffer_load_dwordx4 v[156:159], v244, s[12:15], s30 offen
    s_waitcnt lgkmcnt(11)
    v_mfma_f32_16x16x32_bf16 v[28:31], v[224:227], v[104:107], v[28:31]
    v_mfma_f32_16x16x32_bf16 v[64:67], v[224:227], v[108:111], v[64:67]
    buffer_load_dwordx4 v[160:163], v245, s[12:15], s30 offen
    buffer_load_dwordx4 v[164:167], v246, s[12:15], s30 offen
    s_waitcnt lgkmcnt(9)
    v_mfma_f32_16x16x32_bf16 v[32:35], v[228:231], v[104:107], v[32:35]
    v_mfma_f32_16x16x32_bf16 v[68:71], v[228:231], v[108:111], v[68:71]
    buffer_load_dwordx4 v[80:83], v240, s[8:11], 0 offen offset:1536
    buffer_load_dwordx4 v[84:87], v241, s[8:11], 0 offen offset:1536
    s_waitcnt lgkmcnt(7)
    v_mfma_f32_16x16x32_bf16 v[36:39], v[232:235], v[104:107], v[36:39]
    v_mfma_f32_16x16x32_bf16 v[72:75], v[232:235], v[108:111], v[72:75]
    buffer_load_dwordx4 v[88:91], v240, s[8:11], 0 offen offset:1600
    buffer_load_dwordx4 v[92:95], v241, s[8:11], 0 offen offset:1600
    s_waitcnt lgkmcnt(5)
    v_mfma_f32_16x16x32_bf16 v[40:43], v[236:239], v[104:107], v[40:43]
    v_mfma_f32_16x16x32_bf16 v[76:79], v[236:239], v[108:111], v[76:79]
    s_waitcnt lgkmcnt(0)
    s_barrier
    ds_read_b64_tr_b16 v[168:169], v252 offset:19456
    ds_read_b64_tr_b16 v[170:171], v252 offset:20608
    ds_read_b64_tr_b16 v[172:173], v252 offset:19488
    ds_read_b64_tr_b16 v[174:175], v252 offset:20640
    ds_read_b64_tr_b16 v[176:177], v252 offset:19520
    ds_read_b64_tr_b16 v[178:179], v252 offset:20672
    ds_read_b64_tr_b16 v[180:181], v252 offset:19552
    ds_read_b64_tr_b16 v[182:183], v252 offset:20704
    ds_read_b64_tr_b16 v[184:185], v252 offset:19584
    ds_read_b64_tr_b16 v[186:187], v252 offset:20736
    ds_read_b64_tr_b16 v[188:189], v252 offset:19616
    ds_read_b64_tr_b16 v[190:191], v252 offset:20768
    ds_read_b64_tr_b16 v[192:193], v252 offset:19648
    ds_read_b64_tr_b16 v[194:195], v252 offset:20800
    ds_read_b64_tr_b16 v[196:197], v252 offset:19680
    ds_read_b64_tr_b16 v[198:199], v252 offset:20832
    ds_read_b64_tr_b16 v[200:201], v252 offset:19712
    ds_read_b64_tr_b16 v[202:203], v252 offset:20864
    s_waitcnt vmcnt(9)
    s_waitcnt lgkmcnt(15)
    v_mfma_f32_16x16x32_bf16 v[8:11], v[168:171], v[112:115], v[8:11]
    v_mfma_f32_16x16x32_bf16 v[44:47], v[168:171], v[116:119], v[44:47]
    ds_read_b64_tr_b16 v[204:205], v252 offset:29184
    ds_read_b64_tr_b16 v[206:207], v252 offset:30336
    s_waitcnt lgkmcnt(15)
    v_mfma_f32_16x16x32_bf16 v[12:15], v[172:175], v[112:115], v[12:15]
    v_mfma_f32_16x16x32_bf16 v[48:51], v[172:175], v[116:119], v[48:51]
    ds_read_b64_tr_b16 v[208:209], v252 offset:29216
    ds_read_b64_tr_b16 v[210:211], v252 offset:30368
    s_waitcnt lgkmcnt(15)
    v_mfma_f32_16x16x32_bf16 v[16:19], v[176:179], v[112:115], v[16:19]
    v_mfma_f32_16x16x32_bf16 v[52:55], v[176:179], v[116:119], v[52:55]
    ds_read_b64_tr_b16 v[212:213], v252 offset:29248
    ds_read_b64_tr_b16 v[214:215], v252 offset:30400
    s_waitcnt lgkmcnt(15)
    v_mfma_f32_16x16x32_bf16 v[20:23], v[180:183], v[112:115], v[20:23]
    v_mfma_f32_16x16x32_bf16 v[56:59], v[180:183], v[116:119], v[56:59]
    ds_read_b64_tr_b16 v[216:217], v252 offset:29280
    ds_read_b64_tr_b16 v[218:219], v252 offset:30432
    s_waitcnt lgkmcnt(15)
    v_mfma_f32_16x16x32_bf16 v[24:27], v[184:187], v[112:115], v[24:27]
    v_mfma_f32_16x16x32_bf16 v[60:63], v[184:187], v[116:119], v[60:63]
    ds_read_b64_tr_b16 v[220:221], v252 offset:29312
    ds_read_b64_tr_b16 v[222:223], v252 offset:30464
    s_waitcnt lgkmcnt(15)
    v_mfma_f32_16x16x32_bf16 v[28:31], v[188:191], v[112:115], v[28:31]
    v_mfma_f32_16x16x32_bf16 v[64:67], v[188:191], v[116:119], v[64:67]
    ds_read_b64_tr_b16 v[224:225], v252 offset:29344
    ds_read_b64_tr_b16 v[226:227], v252 offset:30496
    s_waitcnt lgkmcnt(15)
    v_mfma_f32_16x16x32_bf16 v[32:35], v[192:195], v[112:115], v[32:35]
    v_mfma_f32_16x16x32_bf16 v[68:71], v[192:195], v[116:119], v[68:71]
    ds_read_b64_tr_b16 v[228:229], v252 offset:29376
    ds_read_b64_tr_b16 v[230:231], v252 offset:30528
    s_waitcnt lgkmcnt(15)
    v_mfma_f32_16x16x32_bf16 v[36:39], v[196:199], v[112:115], v[36:39]
    v_mfma_f32_16x16x32_bf16 v[72:75], v[196:199], v[116:119], v[72:75]
    ds_read_b64_tr_b16 v[232:233], v252 offset:29408
    ds_read_b64_tr_b16 v[234:235], v252 offset:30560
    s_waitcnt lgkmcnt(15)
    v_mfma_f32_16x16x32_bf16 v[40:43], v[200:203], v[112:115], v[40:43]
    v_mfma_f32_16x16x32_bf16 v[76:79], v[200:203], v[116:119], v[76:79]
    ds_read_b64_tr_b16 v[236:237], v252 offset:29440
    ds_read_b64_tr_b16 v[238:239], v252 offset:30592
    s_waitcnt lgkmcnt(15)
    v_mfma_f32_16x16x32_bf16 v[8:11], v[204:207], v[120:123], v[8:11]
    v_mfma_f32_16x16x32_bf16 v[44:47], v[204:207], v[124:127], v[44:47]
    s_waitcnt vmcnt(13)
    ds_write_b128 v247, v[128:131] offset:0
    s_waitcnt lgkmcnt(15)
    v_mfma_f32_16x16x32_bf16 v[12:15], v[208:211], v[120:123], v[12:15]
    v_mfma_f32_16x16x32_bf16 v[48:51], v[208:211], v[124:127], v[48:51]
    ds_write_b128 v248, v[132:135] offset:0
    ds_write_b128 v249, v[136:139] offset:0
    s_waitcnt lgkmcnt(15)
    v_mfma_f32_16x16x32_bf16 v[16:19], v[212:215], v[120:123], v[16:19]
    v_mfma_f32_16x16x32_bf16 v[52:55], v[212:215], v[124:127], v[52:55]
    ds_write_b128 v250, v[140:143] offset:0
    ds_write_b128 v251, v[144:147] offset:0
    s_waitcnt lgkmcnt(15)
    v_mfma_f32_16x16x32_bf16 v[20:23], v[216:219], v[120:123], v[20:23]
    v_mfma_f32_16x16x32_bf16 v[56:59], v[216:219], v[124:127], v[56:59]
    s_mov_b32 s30, 1032192
    buffer_load_dwordx4 v[128:131], v242, s[12:15], s30 offen
    s_waitcnt lgkmcnt(13)
    v_mfma_f32_16x16x32_bf16 v[24:27], v[220:223], v[120:123], v[24:27]
    v_mfma_f32_16x16x32_bf16 v[60:63], v[220:223], v[124:127], v[60:63]
    buffer_load_dwordx4 v[132:135], v243, s[12:15], s30 offen
    buffer_load_dwordx4 v[136:139], v244, s[12:15], s30 offen
    s_waitcnt lgkmcnt(11)
    v_mfma_f32_16x16x32_bf16 v[28:31], v[224:227], v[120:123], v[28:31]
    v_mfma_f32_16x16x32_bf16 v[64:67], v[224:227], v[124:127], v[64:67]
    buffer_load_dwordx4 v[140:143], v245, s[12:15], s30 offen
    buffer_load_dwordx4 v[144:147], v246, s[12:15], s30 offen
    s_waitcnt lgkmcnt(9)
    v_mfma_f32_16x16x32_bf16 v[32:35], v[228:231], v[120:123], v[32:35]
    v_mfma_f32_16x16x32_bf16 v[68:71], v[228:231], v[124:127], v[68:71]
    buffer_load_dwordx4 v[96:99], v240, s[8:11], 0 offen offset:1664
    buffer_load_dwordx4 v[100:103], v241, s[8:11], 0 offen offset:1664
    s_waitcnt lgkmcnt(7)
    v_mfma_f32_16x16x32_bf16 v[36:39], v[232:235], v[120:123], v[36:39]
    v_mfma_f32_16x16x32_bf16 v[72:75], v[232:235], v[124:127], v[72:75]
    buffer_load_dwordx4 v[104:107], v240, s[8:11], 0 offen offset:1728
    buffer_load_dwordx4 v[108:111], v241, s[8:11], 0 offen offset:1728
    s_waitcnt lgkmcnt(5)
    v_mfma_f32_16x16x32_bf16 v[40:43], v[236:239], v[120:123], v[40:43]
    v_mfma_f32_16x16x32_bf16 v[76:79], v[236:239], v[124:127], v[76:79]
    s_waitcnt lgkmcnt(0)
    s_barrier
    ds_read_b64_tr_b16 v[168:169], v252 offset:0
    ds_read_b64_tr_b16 v[170:171], v252 offset:1152
    ds_read_b64_tr_b16 v[172:173], v252 offset:32
    ds_read_b64_tr_b16 v[174:175], v252 offset:1184
    ds_read_b64_tr_b16 v[176:177], v252 offset:64
    ds_read_b64_tr_b16 v[178:179], v252 offset:1216
    ds_read_b64_tr_b16 v[180:181], v252 offset:96
    ds_read_b64_tr_b16 v[182:183], v252 offset:1248
    ds_read_b64_tr_b16 v[184:185], v252 offset:128
    ds_read_b64_tr_b16 v[186:187], v252 offset:1280
    ds_read_b64_tr_b16 v[188:189], v252 offset:160
    ds_read_b64_tr_b16 v[190:191], v252 offset:1312
    ds_read_b64_tr_b16 v[192:193], v252 offset:192
    ds_read_b64_tr_b16 v[194:195], v252 offset:1344
    ds_read_b64_tr_b16 v[196:197], v252 offset:224
    ds_read_b64_tr_b16 v[198:199], v252 offset:1376
    ds_read_b64_tr_b16 v[200:201], v252 offset:256
    ds_read_b64_tr_b16 v[202:203], v252 offset:1408
    s_waitcnt vmcnt(9)
    s_waitcnt lgkmcnt(15)
    v_mfma_f32_16x16x32_bf16 v[8:11], v[168:171], v[80:83], v[8:11]
    v_mfma_f32_16x16x32_bf16 v[44:47], v[168:171], v[84:87], v[44:47]
    ds_read_b64_tr_b16 v[204:205], v252 offset:9728
    ds_read_b64_tr_b16 v[206:207], v252 offset:10880
    s_waitcnt lgkmcnt(15)
    v_mfma_f32_16x16x32_bf16 v[12:15], v[172:175], v[80:83], v[12:15]
    v_mfma_f32_16x16x32_bf16 v[48:51], v[172:175], v[84:87], v[48:51]
    ds_read_b64_tr_b16 v[208:209], v252 offset:9760
    ds_read_b64_tr_b16 v[210:211], v252 offset:10912
    s_waitcnt lgkmcnt(15)
    v_mfma_f32_16x16x32_bf16 v[16:19], v[176:179], v[80:83], v[16:19]
    v_mfma_f32_16x16x32_bf16 v[52:55], v[176:179], v[84:87], v[52:55]
    ds_read_b64_tr_b16 v[212:213], v252 offset:9792
    ds_read_b64_tr_b16 v[214:215], v252 offset:10944
    s_waitcnt lgkmcnt(15)
    v_mfma_f32_16x16x32_bf16 v[20:23], v[180:183], v[80:83], v[20:23]
    v_mfma_f32_16x16x32_bf16 v[56:59], v[180:183], v[84:87], v[56:59]
    ds_read_b64_tr_b16 v[216:217], v252 offset:9824
    ds_read_b64_tr_b16 v[218:219], v252 offset:10976
    s_waitcnt lgkmcnt(15)
    v_mfma_f32_16x16x32_bf16 v[24:27], v[184:187], v[80:83], v[24:27]
    v_mfma_f32_16x16x32_bf16 v[60:63], v[184:187], v[84:87], v[60:63]
    ds_read_b64_tr_b16 v[220:221], v252 offset:9856
    ds_read_b64_tr_b16 v[222:223], v252 offset:11008
    s_waitcnt lgkmcnt(15)
    v_mfma_f32_16x16x32_bf16 v[28:31], v[188:191], v[80:83], v[28:31]
    v_mfma_f32_16x16x32_bf16 v[64:67], v[188:191], v[84:87], v[64:67]
    ds_read_b64_tr_b16 v[224:225], v252 offset:9888
    ds_read_b64_tr_b16 v[226:227], v252 offset:11040
    s_waitcnt lgkmcnt(15)
    v_mfma_f32_16x16x32_bf16 v[32:35], v[192:195], v[80:83], v[32:35]
    v_mfma_f32_16x16x32_bf16 v[68:71], v[192:195], v[84:87], v[68:71]
    ds_read_b64_tr_b16 v[228:229], v252 offset:9920
    ds_read_b64_tr_b16 v[230:231], v252 offset:11072
    s_waitcnt lgkmcnt(15)
    v_mfma_f32_16x16x32_bf16 v[36:39], v[196:199], v[80:83], v[36:39]
    v_mfma_f32_16x16x32_bf16 v[72:75], v[196:199], v[84:87], v[72:75]
    ds_read_b64_tr_b16 v[232:233], v252 offset:9952
    ds_read_b64_tr_b16 v[234:235], v252 offset:11104
    s_waitcnt lgkmcnt(15)
    v_mfma_f32_16x16x32_bf16 v[40:43], v[200:203], v[80:83], v[40:43]
    v_mfma_f32_16x16x32_bf16 v[76:79], v[200:203], v[84:87], v[76:79]
    ds_read_b64_tr_b16 v[236:237], v252 offset:9984
    ds_read_b64_tr_b16 v[238:239], v252 offset:11136
    s_waitcnt lgkmcnt(15)
    v_mfma_f32_16x16x32_bf16 v[8:11], v[204:207], v[88:91], v[8:11]
    v_mfma_f32_16x16x32_bf16 v[44:47], v[204:207], v[92:95], v[44:47]
    s_waitcnt vmcnt(13)
    ds_write_b128 v247, v[148:151] offset:19456
    s_waitcnt lgkmcnt(15)
    v_mfma_f32_16x16x32_bf16 v[12:15], v[208:211], v[88:91], v[12:15]
    v_mfma_f32_16x16x32_bf16 v[48:51], v[208:211], v[92:95], v[48:51]
    ds_write_b128 v248, v[152:155] offset:19456
    ds_write_b128 v249, v[156:159] offset:19456
    s_waitcnt lgkmcnt(15)
    v_mfma_f32_16x16x32_bf16 v[16:19], v[212:215], v[88:91], v[16:19]
    v_mfma_f32_16x16x32_bf16 v[52:55], v[212:215], v[92:95], v[52:55]
    ds_write_b128 v250, v[160:163] offset:19456
    ds_write_b128 v251, v[164:167] offset:19456
    s_waitcnt lgkmcnt(15)
    v_mfma_f32_16x16x32_bf16 v[20:23], v[216:219], v[88:91], v[20:23]
    v_mfma_f32_16x16x32_bf16 v[56:59], v[216:219], v[92:95], v[56:59]
    s_mov_b32 s30, 1105920
    buffer_load_dwordx4 v[148:151], v242, s[12:15], s30 offen
    s_waitcnt lgkmcnt(13)
    v_mfma_f32_16x16x32_bf16 v[24:27], v[220:223], v[88:91], v[24:27]
    v_mfma_f32_16x16x32_bf16 v[60:63], v[220:223], v[92:95], v[60:63]
    buffer_load_dwordx4 v[152:155], v243, s[12:15], s30 offen
    buffer_load_dwordx4 v[156:159], v244, s[12:15], s30 offen
    s_waitcnt lgkmcnt(11)
    v_mfma_f32_16x16x32_bf16 v[28:31], v[224:227], v[88:91], v[28:31]
    v_mfma_f32_16x16x32_bf16 v[64:67], v[224:227], v[92:95], v[64:67]
    buffer_load_dwordx4 v[160:163], v245, s[12:15], s30 offen
    buffer_load_dwordx4 v[164:167], v246, s[12:15], s30 offen
    s_waitcnt lgkmcnt(9)
    v_mfma_f32_16x16x32_bf16 v[32:35], v[228:231], v[88:91], v[32:35]
    v_mfma_f32_16x16x32_bf16 v[68:71], v[228:231], v[92:95], v[68:71]
    buffer_load_dwordx4 v[112:115], v240, s[8:11], 0 offen offset:1792
    buffer_load_dwordx4 v[116:119], v241, s[8:11], 0 offen offset:1792
    s_waitcnt lgkmcnt(7)
    v_mfma_f32_16x16x32_bf16 v[36:39], v[232:235], v[88:91], v[36:39]
    v_mfma_f32_16x16x32_bf16 v[72:75], v[232:235], v[92:95], v[72:75]
    buffer_load_dwordx4 v[120:123], v240, s[8:11], 0 offen offset:1856
    buffer_load_dwordx4 v[124:127], v241, s[8:11], 0 offen offset:1856
    s_waitcnt lgkmcnt(5)
    v_mfma_f32_16x16x32_bf16 v[40:43], v[236:239], v[88:91], v[40:43]
    v_mfma_f32_16x16x32_bf16 v[76:79], v[236:239], v[92:95], v[76:79]
    s_waitcnt lgkmcnt(0)
    s_barrier
    ds_read_b64_tr_b16 v[168:169], v252 offset:19456
    ds_read_b64_tr_b16 v[170:171], v252 offset:20608
    ds_read_b64_tr_b16 v[172:173], v252 offset:19488
    ds_read_b64_tr_b16 v[174:175], v252 offset:20640
    ds_read_b64_tr_b16 v[176:177], v252 offset:19520
    ds_read_b64_tr_b16 v[178:179], v252 offset:20672
    ds_read_b64_tr_b16 v[180:181], v252 offset:19552
    ds_read_b64_tr_b16 v[182:183], v252 offset:20704
    ds_read_b64_tr_b16 v[184:185], v252 offset:19584
    ds_read_b64_tr_b16 v[186:187], v252 offset:20736
    ds_read_b64_tr_b16 v[188:189], v252 offset:19616
    ds_read_b64_tr_b16 v[190:191], v252 offset:20768
    ds_read_b64_tr_b16 v[192:193], v252 offset:19648
    ds_read_b64_tr_b16 v[194:195], v252 offset:20800
    ds_read_b64_tr_b16 v[196:197], v252 offset:19680
    ds_read_b64_tr_b16 v[198:199], v252 offset:20832
    ds_read_b64_tr_b16 v[200:201], v252 offset:19712
    ds_read_b64_tr_b16 v[202:203], v252 offset:20864
    s_waitcnt vmcnt(9)
    s_waitcnt lgkmcnt(15)
    v_mfma_f32_16x16x32_bf16 v[8:11], v[168:171], v[96:99], v[8:11]
    v_mfma_f32_16x16x32_bf16 v[44:47], v[168:171], v[100:103], v[44:47]
    ds_read_b64_tr_b16 v[204:205], v252 offset:29184
    ds_read_b64_tr_b16 v[206:207], v252 offset:30336
    s_waitcnt lgkmcnt(15)
    v_mfma_f32_16x16x32_bf16 v[12:15], v[172:175], v[96:99], v[12:15]
    v_mfma_f32_16x16x32_bf16 v[48:51], v[172:175], v[100:103], v[48:51]
    ds_read_b64_tr_b16 v[208:209], v252 offset:29216
    ds_read_b64_tr_b16 v[210:211], v252 offset:30368
    s_waitcnt lgkmcnt(15)
    v_mfma_f32_16x16x32_bf16 v[16:19], v[176:179], v[96:99], v[16:19]
    v_mfma_f32_16x16x32_bf16 v[52:55], v[176:179], v[100:103], v[52:55]
    ds_read_b64_tr_b16 v[212:213], v252 offset:29248
    ds_read_b64_tr_b16 v[214:215], v252 offset:30400
    s_waitcnt lgkmcnt(15)
    v_mfma_f32_16x16x32_bf16 v[20:23], v[180:183], v[96:99], v[20:23]
    v_mfma_f32_16x16x32_bf16 v[56:59], v[180:183], v[100:103], v[56:59]
    ds_read_b64_tr_b16 v[216:217], v252 offset:29280
    ds_read_b64_tr_b16 v[218:219], v252 offset:30432
    s_waitcnt lgkmcnt(15)
    v_mfma_f32_16x16x32_bf16 v[24:27], v[184:187], v[96:99], v[24:27]
    v_mfma_f32_16x16x32_bf16 v[60:63], v[184:187], v[100:103], v[60:63]
    ds_read_b64_tr_b16 v[220:221], v252 offset:29312
    ds_read_b64_tr_b16 v[222:223], v252 offset:30464
    s_waitcnt lgkmcnt(15)
    v_mfma_f32_16x16x32_bf16 v[28:31], v[188:191], v[96:99], v[28:31]
    v_mfma_f32_16x16x32_bf16 v[64:67], v[188:191], v[100:103], v[64:67]
    ds_read_b64_tr_b16 v[224:225], v252 offset:29344
    ds_read_b64_tr_b16 v[226:227], v252 offset:30496
    s_waitcnt lgkmcnt(15)
    v_mfma_f32_16x16x32_bf16 v[32:35], v[192:195], v[96:99], v[32:35]
    v_mfma_f32_16x16x32_bf16 v[68:71], v[192:195], v[100:103], v[68:71]
    ds_read_b64_tr_b16 v[228:229], v252 offset:29376
    ds_read_b64_tr_b16 v[230:231], v252 offset:30528
    s_waitcnt lgkmcnt(15)
    v_mfma_f32_16x16x32_bf16 v[36:39], v[196:199], v[96:99], v[36:39]
    v_mfma_f32_16x16x32_bf16 v[72:75], v[196:199], v[100:103], v[72:75]
    ds_read_b64_tr_b16 v[232:233], v252 offset:29408
    ds_read_b64_tr_b16 v[234:235], v252 offset:30560
    s_waitcnt lgkmcnt(15)
    v_mfma_f32_16x16x32_bf16 v[40:43], v[200:203], v[96:99], v[40:43]
    v_mfma_f32_16x16x32_bf16 v[76:79], v[200:203], v[100:103], v[76:79]
    ds_read_b64_tr_b16 v[236:237], v252 offset:29440
    ds_read_b64_tr_b16 v[238:239], v252 offset:30592
    s_waitcnt lgkmcnt(15)
    v_mfma_f32_16x16x32_bf16 v[8:11], v[204:207], v[104:107], v[8:11]
    v_mfma_f32_16x16x32_bf16 v[44:47], v[204:207], v[108:111], v[44:47]
    s_waitcnt vmcnt(13)
    ds_write_b128 v247, v[128:131] offset:0
    s_waitcnt lgkmcnt(15)
    v_mfma_f32_16x16x32_bf16 v[12:15], v[208:211], v[104:107], v[12:15]
    v_mfma_f32_16x16x32_bf16 v[48:51], v[208:211], v[108:111], v[48:51]
    ds_write_b128 v248, v[132:135] offset:0
    ds_write_b128 v249, v[136:139] offset:0
    s_waitcnt lgkmcnt(15)
    v_mfma_f32_16x16x32_bf16 v[16:19], v[212:215], v[104:107], v[16:19]
    v_mfma_f32_16x16x32_bf16 v[52:55], v[212:215], v[108:111], v[52:55]
    ds_write_b128 v250, v[140:143] offset:0
    ds_write_b128 v251, v[144:147] offset:0
    s_waitcnt lgkmcnt(15)
    v_mfma_f32_16x16x32_bf16 v[20:23], v[216:219], v[104:107], v[20:23]
    v_mfma_f32_16x16x32_bf16 v[56:59], v[216:219], v[108:111], v[56:59]
    s_mov_b32 s30, 1179648
    buffer_load_dwordx4 v[128:131], v242, s[12:15], s30 offen
    s_waitcnt lgkmcnt(13)
    v_mfma_f32_16x16x32_bf16 v[24:27], v[220:223], v[104:107], v[24:27]
    v_mfma_f32_16x16x32_bf16 v[60:63], v[220:223], v[108:111], v[60:63]
    buffer_load_dwordx4 v[132:135], v243, s[12:15], s30 offen
    buffer_load_dwordx4 v[136:139], v244, s[12:15], s30 offen
    s_waitcnt lgkmcnt(11)
    v_mfma_f32_16x16x32_bf16 v[28:31], v[224:227], v[104:107], v[28:31]
    v_mfma_f32_16x16x32_bf16 v[64:67], v[224:227], v[108:111], v[64:67]
    buffer_load_dwordx4 v[140:143], v245, s[12:15], s30 offen
    buffer_load_dwordx4 v[144:147], v246, s[12:15], s30 offen
    s_waitcnt lgkmcnt(9)
    v_mfma_f32_16x16x32_bf16 v[32:35], v[228:231], v[104:107], v[32:35]
    v_mfma_f32_16x16x32_bf16 v[68:71], v[228:231], v[108:111], v[68:71]
    buffer_load_dwordx4 v[80:83], v240, s[8:11], 0 offen offset:1920
    buffer_load_dwordx4 v[84:87], v241, s[8:11], 0 offen offset:1920
    s_waitcnt lgkmcnt(7)
    v_mfma_f32_16x16x32_bf16 v[36:39], v[232:235], v[104:107], v[36:39]
    v_mfma_f32_16x16x32_bf16 v[72:75], v[232:235], v[108:111], v[72:75]
    buffer_load_dwordx4 v[88:91], v240, s[8:11], 0 offen offset:1984
    buffer_load_dwordx4 v[92:95], v241, s[8:11], 0 offen offset:1984
    s_waitcnt lgkmcnt(5)
    v_mfma_f32_16x16x32_bf16 v[40:43], v[236:239], v[104:107], v[40:43]
    v_mfma_f32_16x16x32_bf16 v[76:79], v[236:239], v[108:111], v[76:79]
    s_waitcnt lgkmcnt(0)
    s_barrier
    ds_read_b64_tr_b16 v[168:169], v252 offset:0
    ds_read_b64_tr_b16 v[170:171], v252 offset:1152
    ds_read_b64_tr_b16 v[172:173], v252 offset:32
    ds_read_b64_tr_b16 v[174:175], v252 offset:1184
    ds_read_b64_tr_b16 v[176:177], v252 offset:64
    ds_read_b64_tr_b16 v[178:179], v252 offset:1216
    ds_read_b64_tr_b16 v[180:181], v252 offset:96
    ds_read_b64_tr_b16 v[182:183], v252 offset:1248
    ds_read_b64_tr_b16 v[184:185], v252 offset:128
    ds_read_b64_tr_b16 v[186:187], v252 offset:1280
    ds_read_b64_tr_b16 v[188:189], v252 offset:160
    ds_read_b64_tr_b16 v[190:191], v252 offset:1312
    ds_read_b64_tr_b16 v[192:193], v252 offset:192
    ds_read_b64_tr_b16 v[194:195], v252 offset:1344
    ds_read_b64_tr_b16 v[196:197], v252 offset:224
    ds_read_b64_tr_b16 v[198:199], v252 offset:1376
    ds_read_b64_tr_b16 v[200:201], v252 offset:256
    ds_read_b64_tr_b16 v[202:203], v252 offset:1408
    s_waitcnt vmcnt(9)
    s_waitcnt lgkmcnt(15)
    v_mfma_f32_16x16x32_bf16 v[8:11], v[168:171], v[112:115], v[8:11]
    v_mfma_f32_16x16x32_bf16 v[44:47], v[168:171], v[116:119], v[44:47]
    ds_read_b64_tr_b16 v[204:205], v252 offset:9728
    ds_read_b64_tr_b16 v[206:207], v252 offset:10880
    s_waitcnt lgkmcnt(15)
    v_mfma_f32_16x16x32_bf16 v[12:15], v[172:175], v[112:115], v[12:15]
    v_mfma_f32_16x16x32_bf16 v[48:51], v[172:175], v[116:119], v[48:51]
    ds_read_b64_tr_b16 v[208:209], v252 offset:9760
    ds_read_b64_tr_b16 v[210:211], v252 offset:10912
    s_waitcnt lgkmcnt(15)
    v_mfma_f32_16x16x32_bf16 v[16:19], v[176:179], v[112:115], v[16:19]
    v_mfma_f32_16x16x32_bf16 v[52:55], v[176:179], v[116:119], v[52:55]
    ds_read_b64_tr_b16 v[212:213], v252 offset:9792
    ds_read_b64_tr_b16 v[214:215], v252 offset:10944
    s_waitcnt lgkmcnt(15)
    v_mfma_f32_16x16x32_bf16 v[20:23], v[180:183], v[112:115], v[20:23]
    v_mfma_f32_16x16x32_bf16 v[56:59], v[180:183], v[116:119], v[56:59]
    ds_read_b64_tr_b16 v[216:217], v252 offset:9824
    ds_read_b64_tr_b16 v[218:219], v252 offset:10976
    s_waitcnt lgkmcnt(15)
    v_mfma_f32_16x16x32_bf16 v[24:27], v[184:187], v[112:115], v[24:27]
    v_mfma_f32_16x16x32_bf16 v[60:63], v[184:187], v[116:119], v[60:63]
    ds_read_b64_tr_b16 v[220:221], v252 offset:9856
    ds_read_b64_tr_b16 v[222:223], v252 offset:11008
    s_waitcnt lgkmcnt(15)
    v_mfma_f32_16x16x32_bf16 v[28:31], v[188:191], v[112:115], v[28:31]
    v_mfma_f32_16x16x32_bf16 v[64:67], v[188:191], v[116:119], v[64:67]
    ds_read_b64_tr_b16 v[224:225], v252 offset:9888
    ds_read_b64_tr_b16 v[226:227], v252 offset:11040
    s_waitcnt lgkmcnt(15)
    v_mfma_f32_16x16x32_bf16 v[32:35], v[192:195], v[112:115], v[32:35]
    v_mfma_f32_16x16x32_bf16 v[68:71], v[192:195], v[116:119], v[68:71]
    ds_read_b64_tr_b16 v[228:229], v252 offset:9920
    ds_read_b64_tr_b16 v[230:231], v252 offset:11072
    s_waitcnt lgkmcnt(15)
    v_mfma_f32_16x16x32_bf16 v[36:39], v[196:199], v[112:115], v[36:39]
    v_mfma_f32_16x16x32_bf16 v[72:75], v[196:199], v[116:119], v[72:75]
    ds_read_b64_tr_b16 v[232:233], v252 offset:9952
    ds_read_b64_tr_b16 v[234:235], v252 offset:11104
    s_waitcnt lgkmcnt(15)
    v_mfma_f32_16x16x32_bf16 v[40:43], v[200:203], v[112:115], v[40:43]
    v_mfma_f32_16x16x32_bf16 v[76:79], v[200:203], v[116:119], v[76:79]
    ds_read_b64_tr_b16 v[236:237], v252 offset:9984
    ds_read_b64_tr_b16 v[238:239], v252 offset:11136
    s_waitcnt lgkmcnt(15)
    v_mfma_f32_16x16x32_bf16 v[8:11], v[204:207], v[120:123], v[8:11]
    v_mfma_f32_16x16x32_bf16 v[44:47], v[204:207], v[124:127], v[44:47]
    s_waitcnt vmcnt(13)
    ds_write_b128 v247, v[148:151] offset:19456
    s_waitcnt lgkmcnt(15)
    v_mfma_f32_16x16x32_bf16 v[12:15], v[208:211], v[120:123], v[12:15]
    v_mfma_f32_16x16x32_bf16 v[48:51], v[208:211], v[124:127], v[48:51]
    ds_write_b128 v248, v[152:155] offset:19456
    ds_write_b128 v249, v[156:159] offset:19456
    s_waitcnt lgkmcnt(15)
    v_mfma_f32_16x16x32_bf16 v[16:19], v[212:215], v[120:123], v[16:19]
    v_mfma_f32_16x16x32_bf16 v[52:55], v[212:215], v[124:127], v[52:55]
    ds_write_b128 v250, v[160:163] offset:19456
    ds_write_b128 v251, v[164:167] offset:19456
    s_waitcnt lgkmcnt(15)
    v_mfma_f32_16x16x32_bf16 v[20:23], v[216:219], v[120:123], v[20:23]
    v_mfma_f32_16x16x32_bf16 v[56:59], v[216:219], v[124:127], v[56:59]
    s_mov_b32 s30, 1253376
    buffer_load_dwordx4 v[148:151], v242, s[12:15], s30 offen
    s_waitcnt lgkmcnt(13)
    v_mfma_f32_16x16x32_bf16 v[24:27], v[220:223], v[120:123], v[24:27]
    v_mfma_f32_16x16x32_bf16 v[60:63], v[220:223], v[124:127], v[60:63]
    buffer_load_dwordx4 v[152:155], v243, s[12:15], s30 offen
    buffer_load_dwordx4 v[156:159], v244, s[12:15], s30 offen
    s_waitcnt lgkmcnt(11)
    v_mfma_f32_16x16x32_bf16 v[28:31], v[224:227], v[120:123], v[28:31]
    v_mfma_f32_16x16x32_bf16 v[64:67], v[224:227], v[124:127], v[64:67]
    buffer_load_dwordx4 v[160:163], v245, s[12:15], s30 offen
    buffer_load_dwordx4 v[164:167], v246, s[12:15], s30 offen
    s_waitcnt lgkmcnt(9)
    v_mfma_f32_16x16x32_bf16 v[32:35], v[228:231], v[120:123], v[32:35]
    v_mfma_f32_16x16x32_bf16 v[68:71], v[228:231], v[124:127], v[68:71]
    buffer_load_dwordx4 v[96:99], v240, s[8:11], 0 offen offset:2048
    buffer_load_dwordx4 v[100:103], v241, s[8:11], 0 offen offset:2048
    s_waitcnt lgkmcnt(7)
    v_mfma_f32_16x16x32_bf16 v[36:39], v[232:235], v[120:123], v[36:39]
    v_mfma_f32_16x16x32_bf16 v[72:75], v[232:235], v[124:127], v[72:75]
    buffer_load_dwordx4 v[104:107], v240, s[8:11], 0 offen offset:2112
    buffer_load_dwordx4 v[108:111], v241, s[8:11], 0 offen offset:2112
    s_waitcnt lgkmcnt(5)
    v_mfma_f32_16x16x32_bf16 v[40:43], v[236:239], v[120:123], v[40:43]
    v_mfma_f32_16x16x32_bf16 v[76:79], v[236:239], v[124:127], v[76:79]
    s_waitcnt lgkmcnt(0)
    s_barrier
    ds_read_b64_tr_b16 v[168:169], v252 offset:19456
    ds_read_b64_tr_b16 v[170:171], v252 offset:20608
    ds_read_b64_tr_b16 v[172:173], v252 offset:19488
    ds_read_b64_tr_b16 v[174:175], v252 offset:20640
    ds_read_b64_tr_b16 v[176:177], v252 offset:19520
    ds_read_b64_tr_b16 v[178:179], v252 offset:20672
    ds_read_b64_tr_b16 v[180:181], v252 offset:19552
    ds_read_b64_tr_b16 v[182:183], v252 offset:20704
    ds_read_b64_tr_b16 v[184:185], v252 offset:19584
    ds_read_b64_tr_b16 v[186:187], v252 offset:20736
    ds_read_b64_tr_b16 v[188:189], v252 offset:19616
    ds_read_b64_tr_b16 v[190:191], v252 offset:20768
    ds_read_b64_tr_b16 v[192:193], v252 offset:19648
    ds_read_b64_tr_b16 v[194:195], v252 offset:20800
    ds_read_b64_tr_b16 v[196:197], v252 offset:19680
    ds_read_b64_tr_b16 v[198:199], v252 offset:20832
    ds_read_b64_tr_b16 v[200:201], v252 offset:19712
    ds_read_b64_tr_b16 v[202:203], v252 offset:20864
    s_waitcnt vmcnt(9)
    s_waitcnt lgkmcnt(15)
    v_mfma_f32_16x16x32_bf16 v[8:11], v[168:171], v[80:83], v[8:11]
    v_mfma_f32_16x16x32_bf16 v[44:47], v[168:171], v[84:87], v[44:47]
    ds_read_b64_tr_b16 v[204:205], v252 offset:29184
    ds_read_b64_tr_b16 v[206:207], v252 offset:30336
    s_waitcnt lgkmcnt(15)
    v_mfma_f32_16x16x32_bf16 v[12:15], v[172:175], v[80:83], v[12:15]
    v_mfma_f32_16x16x32_bf16 v[48:51], v[172:175], v[84:87], v[48:51]
    ds_read_b64_tr_b16 v[208:209], v252 offset:29216
    ds_read_b64_tr_b16 v[210:211], v252 offset:30368
    s_waitcnt lgkmcnt(15)
    v_mfma_f32_16x16x32_bf16 v[16:19], v[176:179], v[80:83], v[16:19]
    v_mfma_f32_16x16x32_bf16 v[52:55], v[176:179], v[84:87], v[52:55]
    ds_read_b64_tr_b16 v[212:213], v252 offset:29248
    ds_read_b64_tr_b16 v[214:215], v252 offset:30400
    s_waitcnt lgkmcnt(15)
    v_mfma_f32_16x16x32_bf16 v[20:23], v[180:183], v[80:83], v[20:23]
    v_mfma_f32_16x16x32_bf16 v[56:59], v[180:183], v[84:87], v[56:59]
    ds_read_b64_tr_b16 v[216:217], v252 offset:29280
    ds_read_b64_tr_b16 v[218:219], v252 offset:30432
    s_waitcnt lgkmcnt(15)
    v_mfma_f32_16x16x32_bf16 v[24:27], v[184:187], v[80:83], v[24:27]
    v_mfma_f32_16x16x32_bf16 v[60:63], v[184:187], v[84:87], v[60:63]
    ds_read_b64_tr_b16 v[220:221], v252 offset:29312
    ds_read_b64_tr_b16 v[222:223], v252 offset:30464
    s_waitcnt lgkmcnt(15)
    v_mfma_f32_16x16x32_bf16 v[28:31], v[188:191], v[80:83], v[28:31]
    v_mfma_f32_16x16x32_bf16 v[64:67], v[188:191], v[84:87], v[64:67]
    ds_read_b64_tr_b16 v[224:225], v252 offset:29344
    ds_read_b64_tr_b16 v[226:227], v252 offset:30496
    s_waitcnt lgkmcnt(15)
    v_mfma_f32_16x16x32_bf16 v[32:35], v[192:195], v[80:83], v[32:35]
    v_mfma_f32_16x16x32_bf16 v[68:71], v[192:195], v[84:87], v[68:71]
    ds_read_b64_tr_b16 v[228:229], v252 offset:29376
    ds_read_b64_tr_b16 v[230:231], v252 offset:30528
    s_waitcnt lgkmcnt(15)
    v_mfma_f32_16x16x32_bf16 v[36:39], v[196:199], v[80:83], v[36:39]
    v_mfma_f32_16x16x32_bf16 v[72:75], v[196:199], v[84:87], v[72:75]
    ds_read_b64_tr_b16 v[232:233], v252 offset:29408
    ds_read_b64_tr_b16 v[234:235], v252 offset:30560
    s_waitcnt lgkmcnt(15)
    v_mfma_f32_16x16x32_bf16 v[40:43], v[200:203], v[80:83], v[40:43]
    v_mfma_f32_16x16x32_bf16 v[76:79], v[200:203], v[84:87], v[76:79]
    ds_read_b64_tr_b16 v[236:237], v252 offset:29440
    ds_read_b64_tr_b16 v[238:239], v252 offset:30592
    s_waitcnt lgkmcnt(15)
    v_mfma_f32_16x16x32_bf16 v[8:11], v[204:207], v[88:91], v[8:11]
    v_mfma_f32_16x16x32_bf16 v[44:47], v[204:207], v[92:95], v[44:47]
    s_waitcnt vmcnt(13)
    ds_write_b128 v247, v[128:131] offset:0
    s_waitcnt lgkmcnt(15)
    v_mfma_f32_16x16x32_bf16 v[12:15], v[208:211], v[88:91], v[12:15]
    v_mfma_f32_16x16x32_bf16 v[48:51], v[208:211], v[92:95], v[48:51]
    ds_write_b128 v248, v[132:135] offset:0
    ds_write_b128 v249, v[136:139] offset:0
    s_waitcnt lgkmcnt(15)
    v_mfma_f32_16x16x32_bf16 v[16:19], v[212:215], v[88:91], v[16:19]
    v_mfma_f32_16x16x32_bf16 v[52:55], v[212:215], v[92:95], v[52:55]
    ds_write_b128 v250, v[140:143] offset:0
    ds_write_b128 v251, v[144:147] offset:0
    s_waitcnt lgkmcnt(15)
    v_mfma_f32_16x16x32_bf16 v[20:23], v[216:219], v[88:91], v[20:23]
    v_mfma_f32_16x16x32_bf16 v[56:59], v[216:219], v[92:95], v[56:59]
    buffer_load_dwordx4 v[112:115], v240, s[8:11], 0 offen offset:2176
    buffer_load_dwordx4 v[116:119], v241, s[8:11], 0 offen offset:2176
    s_waitcnt lgkmcnt(13)
    v_mfma_f32_16x16x32_bf16 v[24:27], v[220:223], v[88:91], v[24:27]
    v_mfma_f32_16x16x32_bf16 v[60:63], v[220:223], v[92:95], v[60:63]
    buffer_load_dwordx4 v[120:123], v240, s[8:11], 0 offen offset:2240
    buffer_load_dwordx4 v[124:127], v241, s[8:11], 0 offen offset:2240
    s_waitcnt lgkmcnt(11)
    v_mfma_f32_16x16x32_bf16 v[28:31], v[224:227], v[88:91], v[28:31]
    v_mfma_f32_16x16x32_bf16 v[64:67], v[224:227], v[92:95], v[64:67]
    s_waitcnt lgkmcnt(9)
    v_mfma_f32_16x16x32_bf16 v[32:35], v[228:231], v[88:91], v[32:35]
    v_mfma_f32_16x16x32_bf16 v[68:71], v[228:231], v[92:95], v[68:71]
    s_waitcnt lgkmcnt(7)
    v_mfma_f32_16x16x32_bf16 v[36:39], v[232:235], v[88:91], v[36:39]
    v_mfma_f32_16x16x32_bf16 v[72:75], v[232:235], v[92:95], v[72:75]
    s_waitcnt lgkmcnt(5)
    v_mfma_f32_16x16x32_bf16 v[40:43], v[236:239], v[88:91], v[40:43]
    v_mfma_f32_16x16x32_bf16 v[76:79], v[236:239], v[92:95], v[76:79]
    s_waitcnt lgkmcnt(0)
    s_barrier
    ds_read_b64_tr_b16 v[168:169], v252 offset:0
    ds_read_b64_tr_b16 v[170:171], v252 offset:1152
    ds_read_b64_tr_b16 v[172:173], v252 offset:32
    ds_read_b64_tr_b16 v[174:175], v252 offset:1184
    ds_read_b64_tr_b16 v[176:177], v252 offset:64
    ds_read_b64_tr_b16 v[178:179], v252 offset:1216
    ds_read_b64_tr_b16 v[180:181], v252 offset:96
    ds_read_b64_tr_b16 v[182:183], v252 offset:1248
    ds_read_b64_tr_b16 v[184:185], v252 offset:128
    ds_read_b64_tr_b16 v[186:187], v252 offset:1280
    ds_read_b64_tr_b16 v[188:189], v252 offset:160
    ds_read_b64_tr_b16 v[190:191], v252 offset:1312
    ds_read_b64_tr_b16 v[192:193], v252 offset:192
    ds_read_b64_tr_b16 v[194:195], v252 offset:1344
    ds_read_b64_tr_b16 v[196:197], v252 offset:224
    ds_read_b64_tr_b16 v[198:199], v252 offset:1376
    ds_read_b64_tr_b16 v[200:201], v252 offset:256
    ds_read_b64_tr_b16 v[202:203], v252 offset:1408
    s_waitcnt vmcnt(4)
    s_waitcnt lgkmcnt(15)
    v_mfma_f32_16x16x32_bf16 v[8:11], v[168:171], v[96:99], v[8:11]
    v_mfma_f32_16x16x32_bf16 v[44:47], v[168:171], v[100:103], v[44:47]
    ds_read_b64_tr_b16 v[204:205], v252 offset:9728
    ds_read_b64_tr_b16 v[206:207], v252 offset:10880
    s_waitcnt lgkmcnt(15)
    v_mfma_f32_16x16x32_bf16 v[12:15], v[172:175], v[96:99], v[12:15]
    v_mfma_f32_16x16x32_bf16 v[48:51], v[172:175], v[100:103], v[48:51]
    ds_read_b64_tr_b16 v[208:209], v252 offset:9760
    ds_read_b64_tr_b16 v[210:211], v252 offset:10912
    s_waitcnt lgkmcnt(15)
    v_mfma_f32_16x16x32_bf16 v[16:19], v[176:179], v[96:99], v[16:19]
    v_mfma_f32_16x16x32_bf16 v[52:55], v[176:179], v[100:103], v[52:55]
    ds_read_b64_tr_b16 v[212:213], v252 offset:9792
    ds_read_b64_tr_b16 v[214:215], v252 offset:10944
    s_waitcnt lgkmcnt(15)
    v_mfma_f32_16x16x32_bf16 v[20:23], v[180:183], v[96:99], v[20:23]
    v_mfma_f32_16x16x32_bf16 v[56:59], v[180:183], v[100:103], v[56:59]
    ds_read_b64_tr_b16 v[216:217], v252 offset:9824
    ds_read_b64_tr_b16 v[218:219], v252 offset:10976
    s_waitcnt lgkmcnt(15)
    v_mfma_f32_16x16x32_bf16 v[24:27], v[184:187], v[96:99], v[24:27]
    v_mfma_f32_16x16x32_bf16 v[60:63], v[184:187], v[100:103], v[60:63]
    ds_read_b64_tr_b16 v[220:221], v252 offset:9856
    ds_read_b64_tr_b16 v[222:223], v252 offset:11008
    s_waitcnt lgkmcnt(15)
    v_mfma_f32_16x16x32_bf16 v[28:31], v[188:191], v[96:99], v[28:31]
    v_mfma_f32_16x16x32_bf16 v[64:67], v[188:191], v[100:103], v[64:67]
    ds_read_b64_tr_b16 v[224:225], v252 offset:9888
    ds_read_b64_tr_b16 v[226:227], v252 offset:11040
    s_waitcnt lgkmcnt(15)
    v_mfma_f32_16x16x32_bf16 v[32:35], v[192:195], v[96:99], v[32:35]
    v_mfma_f32_16x16x32_bf16 v[68:71], v[192:195], v[100:103], v[68:71]
    ds_read_b64_tr_b16 v[228:229], v252 offset:9920
    ds_read_b64_tr_b16 v[230:231], v252 offset:11072
    s_waitcnt lgkmcnt(15)
    v_mfma_f32_16x16x32_bf16 v[36:39], v[196:199], v[96:99], v[36:39]
    v_mfma_f32_16x16x32_bf16 v[72:75], v[196:199], v[100:103], v[72:75]
    ds_read_b64_tr_b16 v[232:233], v252 offset:9952
    ds_read_b64_tr_b16 v[234:235], v252 offset:11104
    s_waitcnt lgkmcnt(15)
    v_mfma_f32_16x16x32_bf16 v[40:43], v[200:203], v[96:99], v[40:43]
    v_mfma_f32_16x16x32_bf16 v[76:79], v[200:203], v[100:103], v[76:79]
    ds_read_b64_tr_b16 v[236:237], v252 offset:9984
    ds_read_b64_tr_b16 v[238:239], v252 offset:11136
    s_waitcnt lgkmcnt(15)
    v_mfma_f32_16x16x32_bf16 v[8:11], v[204:207], v[104:107], v[8:11]
    v_mfma_f32_16x16x32_bf16 v[44:47], v[204:207], v[108:111], v[44:47]
    s_waitcnt vmcnt(8)
    s_waitcnt lgkmcnt(14)
    v_mfma_f32_16x16x32_bf16 v[12:15], v[208:211], v[104:107], v[12:15]
    v_mfma_f32_16x16x32_bf16 v[48:51], v[208:211], v[108:111], v[48:51]
    ds_write_b128 v247, v[148:151] offset:19456
    s_waitcnt lgkmcnt(13)
    v_mfma_f32_16x16x32_bf16 v[16:19], v[212:215], v[104:107], v[16:19]
    v_mfma_f32_16x16x32_bf16 v[52:55], v[212:215], v[108:111], v[52:55]
    ds_write_b128 v248, v[152:155] offset:19456
    s_waitcnt lgkmcnt(12)
    v_mfma_f32_16x16x32_bf16 v[20:23], v[216:219], v[104:107], v[20:23]
    v_mfma_f32_16x16x32_bf16 v[56:59], v[216:219], v[108:111], v[56:59]
    ds_write_b128 v249, v[156:159] offset:19456
    s_waitcnt lgkmcnt(11)
    v_mfma_f32_16x16x32_bf16 v[24:27], v[220:223], v[104:107], v[24:27]
    v_mfma_f32_16x16x32_bf16 v[60:63], v[220:223], v[108:111], v[60:63]
    ds_write_b128 v250, v[160:163] offset:19456
    s_waitcnt lgkmcnt(10)
    v_mfma_f32_16x16x32_bf16 v[28:31], v[224:227], v[104:107], v[28:31]
    v_mfma_f32_16x16x32_bf16 v[64:67], v[224:227], v[108:111], v[64:67]
    ds_write_b128 v251, v[164:167] offset:19456
    s_waitcnt lgkmcnt(9)
    v_mfma_f32_16x16x32_bf16 v[32:35], v[228:231], v[104:107], v[32:35]
    v_mfma_f32_16x16x32_bf16 v[68:71], v[228:231], v[108:111], v[68:71]
    s_waitcnt lgkmcnt(7)
    v_mfma_f32_16x16x32_bf16 v[36:39], v[232:235], v[104:107], v[36:39]
    v_mfma_f32_16x16x32_bf16 v[72:75], v[232:235], v[108:111], v[72:75]
    s_waitcnt lgkmcnt(5)
    v_mfma_f32_16x16x32_bf16 v[40:43], v[236:239], v[104:107], v[40:43]
    v_mfma_f32_16x16x32_bf16 v[76:79], v[236:239], v[108:111], v[76:79]
    s_waitcnt lgkmcnt(0)
    s_barrier
    ds_read_b64_tr_b16 v[168:169], v252 offset:19456
    ds_read_b64_tr_b16 v[170:171], v252 offset:20608
    ds_read_b64_tr_b16 v[172:173], v252 offset:19488
    ds_read_b64_tr_b16 v[174:175], v252 offset:20640
    ds_read_b64_tr_b16 v[176:177], v252 offset:19520
    ds_read_b64_tr_b16 v[178:179], v252 offset:20672
    ds_read_b64_tr_b16 v[180:181], v252 offset:19552
    ds_read_b64_tr_b16 v[182:183], v252 offset:20704
    ds_read_b64_tr_b16 v[184:185], v252 offset:19584
    ds_read_b64_tr_b16 v[186:187], v252 offset:20736
    ds_read_b64_tr_b16 v[188:189], v252 offset:19616
    ds_read_b64_tr_b16 v[190:191], v252 offset:20768
    ds_read_b64_tr_b16 v[192:193], v252 offset:19648
    ds_read_b64_tr_b16 v[194:195], v252 offset:20800
    ds_read_b64_tr_b16 v[196:197], v252 offset:19680
    ds_read_b64_tr_b16 v[198:199], v252 offset:20832
    ds_read_b64_tr_b16 v[200:201], v252 offset:19712
    ds_read_b64_tr_b16 v[202:203], v252 offset:20864
    s_waitcnt vmcnt(0)
    s_waitcnt lgkmcnt(15)
    v_mfma_f32_16x16x32_bf16 v[8:11], v[168:171], v[112:115], v[8:11]
    v_mfma_f32_16x16x32_bf16 v[44:47], v[168:171], v[116:119], v[44:47]
    ds_read_b64_tr_b16 v[204:205], v252 offset:29184
    ds_read_b64_tr_b16 v[206:207], v252 offset:30336
    s_waitcnt lgkmcnt(15)
    v_mfma_f32_16x16x32_bf16 v[12:15], v[172:175], v[112:115], v[12:15]
    v_mfma_f32_16x16x32_bf16 v[48:51], v[172:175], v[116:119], v[48:51]
    ds_read_b64_tr_b16 v[208:209], v252 offset:29216
    ds_read_b64_tr_b16 v[210:211], v252 offset:30368
    s_waitcnt lgkmcnt(15)
    v_mfma_f32_16x16x32_bf16 v[16:19], v[176:179], v[112:115], v[16:19]
    v_mfma_f32_16x16x32_bf16 v[52:55], v[176:179], v[116:119], v[52:55]
    ds_read_b64_tr_b16 v[212:213], v252 offset:29248
    ds_read_b64_tr_b16 v[214:215], v252 offset:30400
    s_waitcnt lgkmcnt(15)
    v_mfma_f32_16x16x32_bf16 v[20:23], v[180:183], v[112:115], v[20:23]
    v_mfma_f32_16x16x32_bf16 v[56:59], v[180:183], v[116:119], v[56:59]
    ds_read_b64_tr_b16 v[216:217], v252 offset:29280
    ds_read_b64_tr_b16 v[218:219], v252 offset:30432
    s_waitcnt lgkmcnt(15)
    v_mfma_f32_16x16x32_bf16 v[24:27], v[184:187], v[112:115], v[24:27]
    v_mfma_f32_16x16x32_bf16 v[60:63], v[184:187], v[116:119], v[60:63]
    ds_read_b64_tr_b16 v[220:221], v252 offset:29312
    ds_read_b64_tr_b16 v[222:223], v252 offset:30464
    s_waitcnt lgkmcnt(15)
    v_mfma_f32_16x16x32_bf16 v[28:31], v[188:191], v[112:115], v[28:31]
    v_mfma_f32_16x16x32_bf16 v[64:67], v[188:191], v[116:119], v[64:67]
    ds_read_b64_tr_b16 v[224:225], v252 offset:29344
    ds_read_b64_tr_b16 v[226:227], v252 offset:30496
    s_waitcnt lgkmcnt(15)
    v_mfma_f32_16x16x32_bf16 v[32:35], v[192:195], v[112:115], v[32:35]
    v_mfma_f32_16x16x32_bf16 v[68:71], v[192:195], v[116:119], v[68:71]
    ds_read_b64_tr_b16 v[228:229], v252 offset:29376
    ds_read_b64_tr_b16 v[230:231], v252 offset:30528
    s_waitcnt lgkmcnt(15)
    v_mfma_f32_16x16x32_bf16 v[36:39], v[196:199], v[112:115], v[36:39]
    v_mfma_f32_16x16x32_bf16 v[72:75], v[196:199], v[116:119], v[72:75]
    ds_read_b64_tr_b16 v[232:233], v252 offset:29408
    ds_read_b64_tr_b16 v[234:235], v252 offset:30560
    s_waitcnt lgkmcnt(15)
    v_mfma_f32_16x16x32_bf16 v[40:43], v[200:203], v[112:115], v[40:43]
    v_mfma_f32_16x16x32_bf16 v[76:79], v[200:203], v[116:119], v[76:79]
    ds_read_b64_tr_b16 v[236:237], v252 offset:29440
    ds_read_b64_tr_b16 v[238:239], v252 offset:30592
    s_waitcnt lgkmcnt(15)
    v_mfma_f32_16x16x32_bf16 v[8:11], v[204:207], v[120:123], v[8:11]
    v_mfma_f32_16x16x32_bf16 v[44:47], v[204:207], v[124:127], v[44:47]
    s_waitcnt lgkmcnt(14)
    v_mfma_f32_16x16x32_bf16 v[12:15], v[208:211], v[120:123], v[12:15]
    v_mfma_f32_16x16x32_bf16 v[48:51], v[208:211], v[124:127], v[48:51]
    s_waitcnt lgkmcnt(12)
    v_mfma_f32_16x16x32_bf16 v[16:19], v[212:215], v[120:123], v[16:19]
    v_mfma_f32_16x16x32_bf16 v[52:55], v[212:215], v[124:127], v[52:55]
    s_waitcnt lgkmcnt(10)
    v_mfma_f32_16x16x32_bf16 v[20:23], v[216:219], v[120:123], v[20:23]
    v_mfma_f32_16x16x32_bf16 v[56:59], v[216:219], v[124:127], v[56:59]
    s_waitcnt lgkmcnt(8)
    v_mfma_f32_16x16x32_bf16 v[24:27], v[220:223], v[120:123], v[24:27]
    v_mfma_f32_16x16x32_bf16 v[60:63], v[220:223], v[124:127], v[60:63]
    s_waitcnt lgkmcnt(6)
    v_mfma_f32_16x16x32_bf16 v[28:31], v[224:227], v[120:123], v[28:31]
    v_mfma_f32_16x16x32_bf16 v[64:67], v[224:227], v[124:127], v[64:67]
    s_waitcnt lgkmcnt(4)
    v_mfma_f32_16x16x32_bf16 v[32:35], v[228:231], v[120:123], v[32:35]
    v_mfma_f32_16x16x32_bf16 v[68:71], v[228:231], v[124:127], v[68:71]
    s_waitcnt lgkmcnt(2)
    v_mfma_f32_16x16x32_bf16 v[36:39], v[232:235], v[120:123], v[36:39]
    v_mfma_f32_16x16x32_bf16 v[72:75], v[232:235], v[124:127], v[72:75]
    s_waitcnt lgkmcnt(0)
    v_mfma_f32_16x16x32_bf16 v[40:43], v[236:239], v[120:123], v[40:43]
    v_mfma_f32_16x16x32_bf16 v[76:79], v[236:239], v[124:127], v[76:79]
    v_lshlrev_b32 v5, 5, v2
    v_add3_u32 v5, v5, s24, v3
    s_mov_b32 s25, 2304
    v_mul_lo_u32 v5, v5, s25
    v_lshlrev_b32 v6, 4, v4
    s_mul_i32 s28, s22, 576
    v_add3_u32 v253, v5, v6, s28
    s_mul_i32 s31, s20, 4718592
    v_add_u32 v253, s31, v253
    s_mov_b32 s29, 36864
    buffer_store_dwordx4 v[8:11], v253, s[16:19], 0 offen offset:0
    buffer_store_dwordx4 v[12:15], v253, s[16:19], 0 offen offset:64
    buffer_store_dwordx4 v[16:19], v253, s[16:19], 0 offen offset:128
    buffer_store_dwordx4 v[20:23], v253, s[16:19], 0 offen offset:192
    buffer_store_dwordx4 v[24:27], v253, s[16:19], 0 offen offset:256
    buffer_store_dwordx4 v[28:31], v253, s[16:19], 0 offen offset:320
    buffer_store_dwordx4 v[32:35], v253, s[16:19], 0 offen offset:384
    buffer_store_dwordx4 v[36:39], v253, s[16:19], 0 offen offset:448
    buffer_store_dwordx4 v[40:43], v253, s[16:19], 0 offen offset:512
    buffer_store_dwordx4 v[44:47], v253, s[16:19], s29 offen offset:0
    buffer_store_dwordx4 v[48:51], v253, s[16:19], s29 offen offset:64
    buffer_store_dwordx4 v[52:55], v253, s[16:19], s29 offen offset:128
    buffer_store_dwordx4 v[56:59], v253, s[16:19], s29 offen offset:192
    buffer_store_dwordx4 v[60:63], v253, s[16:19], s29 offen offset:256
    buffer_store_dwordx4 v[64:67], v253, s[16:19], s29 offen offset:320
    buffer_store_dwordx4 v[68:71], v253, s[16:19], s29 offen offset:384
    buffer_store_dwordx4 v[72:75], v253, s[16:19], s29 offen offset:448
    buffer_store_dwordx4 v[76:79], v253, s[16:19], s29 offen offset:512
gemm2_kernel_END:
    s_endpgm
.globl final_kernel
.p2align 8
.type final_kernel,@function
final_kernel:
    s_cmp_ge_u32 s2, 576
    s_cbranch_scc1 FIN_END
    s_load_dwordx2 s[4:5], s[0:1], 64
    s_load_dwordx2 s[6:7], s[0:1], 80
    s_waitcnt lgkmcnt(0)
    s_add_u32 s8, s6, 37748736
    s_addc_u32 s9, s7, 0
    s_and_b32 s9, s9, 0xffff
    s_mov_b32 s10, 18874368
    s_mov_b32 s11, 0x20000
    s_add_u32 s12, s6, 8388608
    s_addc_u32 s13, s7, 0
    s_and_b32 s13, s13, 0xffff
    s_mov_b32 s14, 2359296
    s_mov_b32 s15, 0x20000
    s_mov_b32 s16, s4
    s_and_b32 s17, s5, 0xffff
    s_mov_b32 s18, 2359296
    s_mov_b32 s19, 0x20000
    s_mov_b32 s20, s6
    s_and_b32 s21, s7, 0xffff
    s_mov_b32 s22, 13824
    s_mov_b32 s23, 0x20000
    s_lshl_b32 s3, s2, 8
    v_add_u32 v1, s3, v0
    v_lshlrev_b32 v2, 5, v1
    v_lshlrev_b32 v3, 4, v1
    s_mov_b32 s24, 0
    buffer_load_dwordx4 v[8:11], v2, s[8:11], s24 offen
    buffer_load_dwordx4 v[12:15], v2, s[8:11], s24 offen offset:16
    s_mov_b32 s24, 4718592
    buffer_load_dwordx4 v[16:19], v2, s[8:11], s24 offen
    buffer_load_dwordx4 v[20:23], v2, s[8:11], s24 offen offset:16
    s_mov_b32 s24, 9437184
    buffer_load_dwordx4 v[24:27], v2, s[8:11], s24 offen
    buffer_load_dwordx4 v[28:31], v2, s[8:11], s24 offen offset:16
    s_mov_b32 s24, 14155776
    buffer_load_dwordx4 v[32:35], v2, s[8:11], s24 offen
    buffer_load_dwordx4 v[36:39], v2, s[8:11], s24 offen offset:16
    buffer_load_dwordx4 v[40:43], v3, s[12:15], 0 offen
    s_mov_b32 s25, 954437177
    v_mul_hi_u32 v4, v1, s25
    v_lshrrev_b32 v4, 4, v4
    v_mul_u32_u24 v4, 72, v4
    v_sub_u32 v4, v1, v4
    v_lshlrev_b32 v4, 5, v4
    s_mov_b32 s26, 11520
    buffer_load_dwordx4 v[44:47], v4, s[20:23], s26 offen
    buffer_load_dwordx4 v[48:51], v4, s[20:23], s26 offen offset:16
    s_waitcnt vmcnt(0)
    v_add_f32 v8, v8, v16
    v_add_f32 v8, v8, v24
    v_add_f32 v8, v8, v32
    v_add_f32 v9, v9, v17
    v_add_f32 v9, v9, v25
    v_add_f32 v9, v9, v33
    v_add_f32 v10, v10, v18
    v_add_f32 v10, v10, v26
    v_add_f32 v10, v10, v34
    v_add_f32 v11, v11, v19
    v_add_f32 v11, v11, v27
    v_add_f32 v11, v11, v35
    v_add_f32 v12, v12, v20
    v_add_f32 v12, v12, v28
    v_add_f32 v12, v12, v36
    v_add_f32 v13, v13, v21
    v_add_f32 v13, v13, v29
    v_add_f32 v13, v13, v37
    v_add_f32 v14, v14, v22
    v_add_f32 v14, v14, v30
    v_add_f32 v14, v14, v38
    v_add_f32 v15, v15, v23
    v_add_f32 v15, v15, v31
    v_add_f32 v15, v15, v39
    v_cvt_pk_bf16_f32 v9, v8, v9
    v_lshlrev_b32 v8, 16, v9
    v_and_b32 v9, 0xffff0000, v9
    v_mul_f32 v8, v8, v44
    v_mul_f32 v9, v9, v45
    v_cvt_pk_bf16_f32 v9, v8, v9
    v_lshlrev_b32 v8, 16, v9
    v_and_b32 v9, 0xffff0000, v9
    v_lshlrev_b32 v5, 16, v40
    v_and_b32 v6, 0xffff0000, v40
    v_add_f32 v8, v5, v8
    v_add_f32 v9, v6, v9
    v_cvt_pk_bf16_f32 v40, v8, v9
    v_cvt_pk_bf16_f32 v11, v10, v11
    v_lshlrev_b32 v10, 16, v11
    v_and_b32 v11, 0xffff0000, v11
    v_mul_f32 v10, v10, v46
    v_mul_f32 v11, v11, v47
    v_cvt_pk_bf16_f32 v11, v10, v11
    v_lshlrev_b32 v10, 16, v11
    v_and_b32 v11, 0xffff0000, v11
    v_lshlrev_b32 v5, 16, v41
    v_and_b32 v6, 0xffff0000, v41
    v_add_f32 v10, v5, v10
    v_add_f32 v11, v6, v11
    v_cvt_pk_bf16_f32 v41, v10, v11
    v_cvt_pk_bf16_f32 v13, v12, v13
    v_lshlrev_b32 v12, 16, v13
    v_and_b32 v13, 0xffff0000, v13
    v_mul_f32 v12, v12, v48
    v_mul_f32 v13, v13, v49
    v_cvt_pk_bf16_f32 v13, v12, v13
    v_lshlrev_b32 v12, 16, v13
    v_and_b32 v13, 0xffff0000, v13
    v_lshlrev_b32 v5, 16, v42
    v_and_b32 v6, 0xffff0000, v42
    v_add_f32 v12, v5, v12
    v_add_f32 v13, v6, v13
    v_cvt_pk_bf16_f32 v42, v12, v13
    v_cvt_pk_bf16_f32 v15, v14, v15
    v_lshlrev_b32 v14, 16, v15
    v_and_b32 v15, 0xffff0000, v15
    v_mul_f32 v14, v14, v50
    v_mul_f32 v15, v15, v51
    v_cvt_pk_bf16_f32 v15, v14, v15
    v_lshlrev_b32 v14, 16, v15
    v_and_b32 v15, 0xffff0000, v15
    v_lshlrev_b32 v5, 16, v43
    v_and_b32 v6, 0xffff0000, v43
    v_add_f32 v14, v5, v14
    v_add_f32 v15, v6, v15
    v_cvt_pk_bf16_f32 v43, v14, v15
    buffer_store_dwordx4 v[40:43], v3, s[16:19], 0 offen
FIN_END:
    s_endpgm

.section .rodata,"a"
.p2align 6
.amdhsa_kernel prep_kernel
  .amdhsa_next_free_vgpr 96
  .amdhsa_next_free_sgpr 102
  .amdhsa_accum_offset 96
  .amdhsa_group_segment_fixed_size 0
  .amdhsa_kernarg_size 88
  .amdhsa_user_sgpr_count 2
  .amdhsa_user_sgpr_kernarg_segment_ptr 1
  .amdhsa_system_sgpr_workgroup_id_x 1
.end_amdhsa_kernel

.p2align 6
.amdhsa_kernel ln_rfft_kernel
  .amdhsa_next_free_vgpr 128
  .amdhsa_next_free_sgpr 102
  .amdhsa_accum_offset 128
  .amdhsa_group_segment_fixed_size 0
  .amdhsa_kernarg_size 88
  .amdhsa_user_sgpr_count 2
  .amdhsa_user_sgpr_kernarg_segment_ptr 1
  .amdhsa_system_sgpr_workgroup_id_x 1
.end_amdhsa_kernel

.p2align 6
.amdhsa_kernel col_fft_kernel
  .amdhsa_next_free_vgpr 68
  .amdhsa_next_free_sgpr 102
  .amdhsa_accum_offset 68
  .amdhsa_group_segment_fixed_size 0
  .amdhsa_kernarg_size 88
  .amdhsa_user_sgpr_count 2
  .amdhsa_user_sgpr_kernarg_segment_ptr 1
  .amdhsa_system_sgpr_workgroup_id_x 1
.end_amdhsa_kernel

.p2align 6
.amdhsa_kernel irfft_ln_kernel
  .amdhsa_next_free_vgpr 152
  .amdhsa_next_free_sgpr 102
  .amdhsa_accum_offset 152
  .amdhsa_group_segment_fixed_size 0
  .amdhsa_kernarg_size 88
  .amdhsa_user_sgpr_count 2
  .amdhsa_user_sgpr_kernarg_segment_ptr 1
  .amdhsa_system_sgpr_workgroup_id_x 1
.end_amdhsa_kernel

.p2align 6
.amdhsa_kernel gemm1_kernel
  .amdhsa_next_free_vgpr 256
  .amdhsa_next_free_sgpr 102
  .amdhsa_accum_offset 256
  .amdhsa_group_segment_fixed_size 0
  .amdhsa_kernarg_size 88
  .amdhsa_user_sgpr_count 2
  .amdhsa_user_sgpr_kernarg_segment_ptr 1
  .amdhsa_system_sgpr_workgroup_id_x 1
.end_amdhsa_kernel

.p2align 6
.amdhsa_kernel gemm2_kernel
  .amdhsa_next_free_vgpr 256
  .amdhsa_next_free_sgpr 102
  .amdhsa_accum_offset 256
  .amdhsa_group_segment_fixed_size 0
  .amdhsa_kernarg_size 88
  .amdhsa_user_sgpr_count 2
  .amdhsa_user_sgpr_kernarg_segment_ptr 1
  .amdhsa_system_sgpr_workgroup_id_x 1
.end_amdhsa_kernel

.p2align 6
.amdhsa_kernel final_kernel
  .amdhsa_next_free_vgpr 52
  .amdhsa_next_free_sgpr 102
  .amdhsa_accum_offset 52
  .amdhsa_group_segment_fixed_size 0
  .amdhsa_kernarg_size 88
  .amdhsa_user_sgpr_count 2
  .amdhsa_user_sgpr_kernarg_segment_ptr 1
  .amdhsa_system_sgpr_workgroup_id_x 1
.end_amdhsa_kernel
```
